```python
import torch

def _softmax(x, axis=-1):
    return torch.softmax(x, dim=axis)
def _gelu(x):
    return torch.nn.functional.gelu(x, approximate="tanh")
def _silu(x):
    return torch.nn.functional.silu(x)
def _sigmoid(x):
    return torch.sigmoid(x)
def _layernorm(x, axis=-1, eps=1e-5):
    m = x.mean(dim=axis, keepdim=True)
    v = x.var(dim=axis, keepdim=True, unbiased=False)
    return (x - m) / torch.sqrt(v + eps)
def _scatter_add(tgt, idx, src, axis=0):
    return tgt.clone().index_add_(axis, idx, src)
def _segment_sum(src, seg, n):
    out = torch.zeros((n,) + src.shape[1:], dtype=src.dtype)
    return out.index_add_(0, seg, src)
def _pad(x, pw):
    flat = tuple(v for pair in reversed(pw) for v in pair)
    return torch.nn.functional.pad(x, flat)

kernel_name = 'parallel_sum__linear_kernel_hedgehog__mixer_s_mlp__prompt'

def setup_inputs():

    _w = (lambda a: (lambda t: t.to(torch.bfloat16) if t.is_floating_point() else t)(torch.as_tensor(a)))
    def _A_setup():
        B, S, D, H = 1, 2048, 640, 32
        Dh = D // H
        return {
            "x": _w((lambda *s: torch.randn(*s, dtype=torch.bfloat16) * 0.05)(B, S, D)),
            "wqkv": _w((lambda *s: torch.randn(*s, dtype=torch.bfloat16) * 0.8)(D, 3 * D)),
            "w_phi": _w((lambda *s: torch.randn(*s, dtype=torch.bfloat16) * 0.8)(H, Dh, Dh) * (Dh ** -0.5)),
            "wo": _w((lambda *s: torch.randn(*s, dtype=torch.bfloat16) * 0.1)(D, D)),
        }
    _A_in = _A_setup()

    def _B_setup():
        B, S, D, F = 1, 2048, 640, 1728
        return {
            "x":  _w((lambda *s: torch.randn(*s, dtype=torch.bfloat16) * 0.05)(B, S, D)),
            "w1": _w((lambda *s: torch.randn(*s, dtype=torch.bfloat16) * 3.2)(D, D) * (D ** -0.5)),
            "w2": _w((lambda *s: torch.randn(*s, dtype=torch.bfloat16) * 3.2)(D, D) * (D ** -0.5)),
            "w3": _w((lambda *s: torch.randn(*s, dtype=torch.bfloat16) * 3.2)(D, F) * (D ** -0.5)),
            "w4": _w((lambda *s: torch.randn(*s, dtype=torch.bfloat16) * 3.2)(F, D) * (F ** -0.5)),
        }
    _B_in = _B_setup()

    return {
        "A_x": _A_in["x"],
        "A_wqkv": _A_in["wqkv"],
        "A_w_phi": _A_in["w_phi"],
        "A_wo": _A_in["wo"],
        "B_x": _B_in["x"],
        "B_w1": _B_in["w1"],
        "B_w2": _B_in["w2"],
        "B_w3": _B_in["w3"],
        "B_w4": _B_in["w4"],
    }

def reference(A_x, A_wqkv, A_w_phi, A_wo, B_x, B_w1, B_w2, B_w3, B_w4):
    def _A_ref(x, wqkv, w_phi, wo):
        B, S, D = x.shape
        H = 32; Dh = D // H
        qkv = (lambda x, *d: x.permute(*d))((x @ wqkv).reshape(B, S, 3, H, Dh), 2, 0, 3, 1, 4)
        q, k, v = qkv[0], qkv[1], qkv[2]
        pq = torch.einsum("bhsd,hdf->bhsf", q, w_phi)
        pk = torch.einsum("bhsd,hdf->bhsf", k, w_phi)
        phi_q = torch.concatenate([_softmax(pq, axis=-1), _softmax(-pq, axis=-1)], axis=-1)
        phi_k = torch.concatenate([_softmax(pk, axis=-1), _softmax(-pk, axis=-1)], axis=-1)
        kv = torch.einsum("bhsf,bhsd->bhfd", phi_k, v)
        z  = torch.einsum("bhsf->bhf", phi_k)
        num = torch.einsum("bhqf,bhfd->bhqd", phi_q, kv)
        den = torch.einsum("bhqf,bhf->bhq", phi_q, z)[..., None] + 1e-6
        o = num / den
        return (lambda x, *d: x.permute(*d))(o, 0, 2, 1, 3).reshape(B, S, D) @ wo

    def _B_ref(x, w1, w2, w3, w4):
        B, S, D = x.shape
        h = _gelu(_layernorm(x, axis=-1) @ w1)
        c = D // 4
        g0 = _pad(h[:, :, 0*c:1*c], ((0, 0), (1, 0), (0, 0)))[:, :S, :]
        g1 = _pad(h[:, :, 1*c:2*c], ((0, 0), (0, 1), (0, 0)))[:, 1:, :]
        g2 = _pad(h[:, :, 2*c:3*c], ((0, 0), (2, 0), (0, 0)))[:, :S, :]
        g3 = _pad(h[:, :, 3*c:   ], ((0, 0), (0, 2), (0, 0)))[:, 2:, :]
        hs = torch.concatenate([g0, g1, g2, g3], axis=-1) @ w2
        x1 = x + hs
        h2 = _gelu(_layernorm(x1, axis=-1) @ w3) @ w4
        return x1 + h2

    x = A_x
    xn = _layernorm(x, axis=-1)
    return x + _A_ref(xn, A_wqkv, A_w_phi, A_wo) + _B_ref(xn, B_w1, B_w2, B_w3, B_w4)
```

```asm
; @launch grid=(256,1,1) block=(512,1,1) lds=163840
.amdgcn_target "amdgcn-amd-amdhsa--gfx950"
.text
.globl parallel_sum__linear_kernel_hedgehog__mixer_s_mlp__prompt_kernel
.p2align 8
.type parallel_sum__linear_kernel_hedgehog__mixer_s_mlp__prompt_kernel,@function
parallel_sum__linear_kernel_hedgehog__mixer_s_mlp__prompt_kernel:
  s_cmp_ge_u32 s2, 0x100
  s_cbranch_scc1 L_exit
  s_load_dwordx8 s[60:67], s[0:1], 0
  s_load_dwordx8 s[68:75], s[0:1], 40
  s_load_dwordx4 s[76:79], s[0:1], 0x48
  s_load_dwordx2 s[80:81], s[0:1], 0x58
  s_and_b32 s3, s2, 7
  s_lshr_b32 s82, s2, 3
  s_lshr_b32 s4, s3, 1
  s_lshl_b32 s4, s4, 2
  s_lshr_b32 s83, s82, 3
  s_add_u32 s4, s4, s83
  s_and_b32 s5, s3, 1
  s_lshl_b32 s5, s5, 3
  s_and_b32 s83, s82, 7
  s_add_u32 s5, s5, s83
  v_lshrrev_b32 v4, 6, v0
  v_and_b32 v1, 63, v0
  v_readfirstlane_b32 s6, v4
  s_nop 3
  s_lshr_b32 s3, s6, 2
  s_and_b32 s6, s6, 3
  v_and_b32 v2, 15, v1
  v_lshrrev_b32 v3, 4, v1
  s_lshr_b32 s52, s5, 1
  s_and_b32 s53, s5, 1
  s_lshl_b32 s54, s6, 10
  s_cmp_eq_u32 s3, 0
  s_cbranch_scc1 L_compute
L_loader:
  s_setprio 2
  s_waitcnt lgkmcnt(0)
  s_mov_b32 s8, s60
  s_mov_b32 s9, s61
  s_mov_b32 s10, 0x280000
  s_mov_b32 s11, 0x20000
  s_mov_b32 s12, s62
  s_mov_b32 s13, s63
  s_mov_b32 s14, 0x258000
  s_mov_b32 s15, 0x20000
  s_mov_b32 s16, s68
  s_mov_b32 s17, s69
  s_mov_b32 s18, 0xc8000
  s_mov_b32 s19, 0x20000
  s_add_u32 s40, s4, s5
  s_mul_i32 s41, s40, 26
  s_lshr_b32 s41, s41, 8
  s_mul_i32 s41, s41, 10
  s_sub_u32 s40, s40, s41
  v_lshrrev_b32 v9, 3, v1
  v_and_b32 v10, 7, v1
  v_xor_b32 v10, v10, v9
  s_lshl_b32 s41, s4, 2
  s_add_u32 s41, s41, s6
  s_lshl_b32 s41, s41, 5
  v_add_u32 v9, s41, v9
  v_mul_u32_u24 v9, 0x500, v9
  v_lshl_add_u32 v5, v10, 4, v9
  v_add_u32 v6, 0x2800, v5
  v_add_u32 v7, 0x5000, v5
  v_add_u32 v8, 0x7800, v5
  s_lshl_b32 s42, s40, 7
  s_lshl_b32 s55, s6, 12
  s_add_u32 s55, s55, 0x19000
  s_add_u32 m0, s55, 0
  s_nop 0
  buffer_load_dwordx4 v5, s[8:11], s42 offen lds
  s_add_u32 m0, s55, 0x400
  s_nop 0
  buffer_load_dwordx4 v6, s[8:11], s42 offen lds
  s_add_u32 m0, s55, 0x800
  s_nop 0
  buffer_load_dwordx4 v7, s[8:11], s42 offen lds
  s_add_u32 m0, s55, 0xc00
  s_nop 0
  buffer_load_dwordx4 v8, s[8:11], s42 offen lds
  s_lshr_b32 s57, s6, 1
  s_and_b32 s58, s6, 1
  s_lshl_b32 s41, s53, 1
  s_add_u32 s41, s41, s57
  s_cmp_eq_u32 s41, 0
  s_cselect_b32 s88, s16, s12
  s_cselect_b32 s89, s17, s13
  s_cselect_b32 s90, s18, s14
  s_mov_b32 s91, 0x20000
  s_mov_b32 s59, 0xf00
  s_cselect_b32 s59, 0x500, s59
  s_sub_u32 s84, s41, 1
  s_max_i32 s84, s84, 0
  s_mul_i32 s84, s84, 0x500
  s_mul_i32 s41, s52, 0xa0
  s_add_u32 s84, s84, s41
  s_lshl_b32 s85, s58, 6
  v_add_u32 v16, s85, v1
  v_mul_u32_u24 v17, 0xcd, v16
  v_lshrrev_b32 v17, 11, v17
  v_mul_u32_u24 v20, 10, v17
  v_sub_u32 v18, v16, v20
  v_lshlrev_b32 v18, 4, v18
  v_and_b32 v19, 0xfff3, v17
  v_bfe_u32 v20, v17, 2, 1
  v_lshl_or_b32 v19, v20, 3, v19
  v_bfe_u32 v20, v17, 3, 1
  v_lshl_or_b32 v19, v20, 2, v19
  v_mul_u32_u24 v20, s59, v19
  v_add_u32 v11, v20, v18
  v_add_u32 v16, s85, v1
  v_add_u32 v16, 0x80, v16
  v_mul_u32_u24 v17, 0xcd, v16
  v_lshrrev_b32 v17, 11, v17
  v_mul_u32_u24 v20, 10, v17
  v_sub_u32 v18, v16, v20
  v_lshlrev_b32 v18, 4, v18
  v_and_b32 v19, 0xfff3, v17
  v_bfe_u32 v20, v17, 2, 1
  v_lshl_or_b32 v19, v20, 3, v19
  v_bfe_u32 v20, v17, 3, 1
  v_lshl_or_b32 v19, v20, 2, v19
  v_mul_u32_u24 v20, s59, v19
  v_add_u32 v12, v20, v18
  v_add_u32 v16, s85, v1
  v_add_u32 v16, 0x100, v16
  v_mul_u32_u24 v17, 0xcd, v16
  v_lshrrev_b32 v17, 11, v17
  v_mul_u32_u24 v20, 10, v17
  v_sub_u32 v18, v16, v20
  v_lshlrev_b32 v18, 4, v18
  v_and_b32 v19, 0xfff3, v17
  v_bfe_u32 v20, v17, 2, 1
  v_lshl_or_b32 v19, v20, 3, v19
  v_bfe_u32 v20, v17, 3, 1
  v_lshl_or_b32 v19, v20, 2, v19
  v_mul_u32_u24 v20, s59, v19
  v_add_u32 v13, v20, v18
  v_add_u32 v16, s85, v1
  v_add_u32 v16, 0x180, v16
  v_mul_u32_u24 v17, 0xcd, v16
  v_lshrrev_b32 v17, 11, v17
  v_mul_u32_u24 v20, 10, v17
  v_sub_u32 v18, v16, v20
  v_lshlrev_b32 v18, 4, v18
  v_and_b32 v19, 0xfff3, v17
  v_bfe_u32 v20, v17, 2, 1
  v_lshl_or_b32 v19, v20, 3, v19
  v_bfe_u32 v20, v17, 3, 1
  v_lshl_or_b32 v19, v20, 2, v19
  v_mul_u32_u24 v20, s59, v19
  v_add_u32 v14, v20, v18
  v_add_u32 v16, s85, v1
  v_add_u32 v16, 0x200, v16
  v_mul_u32_u24 v17, 0xcd, v16
  v_lshrrev_b32 v17, 11, v17
  v_mul_u32_u24 v20, 10, v17
  v_sub_u32 v18, v16, v20
  v_lshlrev_b32 v18, 4, v18
  v_and_b32 v19, 0xfff3, v17
  v_bfe_u32 v20, v17, 2, 1
  v_lshl_or_b32 v19, v20, 3, v19
  v_bfe_u32 v20, v17, 3, 1
  v_lshl_or_b32 v19, v20, 2, v19
  v_mul_u32_u24 v20, s59, v19
  v_add_u32 v15, v20, v18
  s_lshl_b32 s85, s59, 6
  s_mul_i32 s86, s59, 0x280
  s_mul_i32 s87, s40, s85
  s_add_u32 s86, s86, s84
  s_add_u32 s87, s87, s84
  s_mul_i32 s93, s57, 0x2800
  s_lshl_b32 s41, s58, 10
  s_add_u32 s93, s93, s41
  s_mul_i32 s94, s59, 0x280
  s_add_u32 m0, s93, 0
  s_nop 0
  buffer_load_dwordx4 v11, s[88:91], s87 offen lds
  s_add_u32 m0, s93, 0x800
  s_nop 0
  buffer_load_dwordx4 v12, s[88:91], s87 offen lds
  s_add_u32 m0, s93, 0x1000
  s_nop 0
  buffer_load_dwordx4 v13, s[88:91], s87 offen lds
  s_add_u32 m0, s93, 0x1800
  s_nop 0
  buffer_load_dwordx4 v14, s[88:91], s87 offen lds
  s_add_u32 m0, s93, 0x2000
  s_nop 0
  buffer_load_dwordx4 v15, s[88:91], s87 offen lds
  s_cmp_lg_u32 s6, 3
  s_cbranch_scc1 L_cp_1
  s_getpc_b64 s[96:97]
L_pcref:
  s_lshr_b32 s40, s2, 3
  s_and_b32 s40, s40, 31
  s_mul_i32 s40, s40, 18
  v_add_u32 v16, s40, v1
  v_lshlrev_b32 v16, 7, v16
  s_sub_u32 s96, s96, L_pcref-parallel_sum__linear_kernel_hedgehog__mixer_s_mlp__prompt_kernel
  s_subb_u32 s97, s97, 0
  s_mov_b64 exec, 0x3ffff
  v_cmp_gt_u32 vcc, L_code_end-parallel_sum__linear_kernel_hedgehog__mixer_s_mlp__prompt_kernel, v16
  s_nop 3
  s_and_b64 exec, exec, vcc
  s_cbranch_execz L_cq_2
  global_load_dword v4, v16, s[96:97]
L_cq_2:
  s_mov_b64 exec, -1
L_cp_1:
  s_add_u32 s43, s42, 0x80
  s_cmp_ge_u32 s43, 0x500
  s_cselect_b32 s56, 0x500, 0
  s_sub_u32 s43, s43, s56
  s_add_u32 m0, s55, 0x4000
  s_nop 0
  buffer_load_dwordx4 v5, s[8:11], s43 offen lds
  s_add_u32 m0, s55, 0x4400
  s_nop 0
  buffer_load_dwordx4 v6, s[8:11], s43 offen lds
  s_add_u32 m0, s55, 0x4800
  s_nop 0
  buffer_load_dwordx4 v7, s[8:11], s43 offen lds
  s_add_u32 m0, s55, 0x4c00
  s_nop 0
  buffer_load_dwordx4 v8, s[8:11], s43 offen lds
  s_add_u32 s92, s87, s85
  s_cmp_ge_u32 s92, s86
  s_cselect_b32 s56, s94, 0
  s_sub_u32 s92, s92, s56
  s_add_u32 m0, s93, 0x5000
  s_nop 0
  buffer_load_dwordx4 v11, s[88:91], s92 offen lds
  s_add_u32 m0, s93, 0x5800
  s_nop 0
  buffer_load_dwordx4 v12, s[88:91], s92 offen lds
  s_add_u32 m0, s93, 0x6000
  s_nop 0
  buffer_load_dwordx4 v13, s[88:91], s92 offen lds
  s_add_u32 m0, s93, 0x6800
  s_nop 0
  buffer_load_dwordx4 v14, s[88:91], s92 offen lds
  s_add_u32 m0, s93, 0x7000
  s_nop 0
  buffer_load_dwordx4 v15, s[88:91], s92 offen lds
  s_mov_b32 s20, s80
  s_mov_b32 s21, s81
  s_mov_b32 s22, 0x12d4000
  s_mov_b32 s23, 0x20000
  s_mov_b32 s44, s64
  s_mov_b32 s45, s65
  s_mov_b32 s46, 0x6400
  s_mov_b32 s47, 0x20000
  s_mov_b32 s36, s66
  s_mov_b32 s37, s67
  s_mov_b32 s38, 0xc8000
  s_mov_b32 s39, 0x20000
  s_mov_b32 s24, s70
  s_mov_b32 s25, s71
  s_mov_b32 s26, 0xc8000
  s_mov_b32 s27, 0x20000
  s_mov_b32 s28, s72
  s_mov_b32 s29, s73
  s_mov_b32 s30, 0x21c000
  s_mov_b32 s31, 0x20000
  s_mov_b32 s32, s74
  s_mov_b32 s33, s75
  s_mov_b32 s34, 0x21c000
  s_mov_b32 s35, 0x20000
  s_mov_b32 s48, s78
  s_mov_b32 s49, s79
  s_mov_b32 s50, 0x100
  s_mov_b32 s51, 0x20000
  s_waitcnt vmcnt(14)
  s_waitcnt vmcnt(9)
  s_barrier
  v_lshrrev_b32 v10, 1, v3
  v_lshlrev_b32 v10, 4, v10
  v_and_b32 v16, 1, v3
  v_lshl_add_u32 v10, v16, 2, v10
  v_bfe_u32 v16, v1, 2, 2
  v_add_u32 v10, v10, v16
  v_mul_u32_u24 v10, 0xa0, v10
  v_and_b32 v16, 3, v1
  v_lshl_add_u32 v10, v16, 3, v10
  s_mul_i32 s40, s57, 0x2800
  v_add_u32 v10, s40, v10
  s_lshl_b32 s40, s58, 6
  v_add_u32 v16, s40, v10
  v_add_u32 v17, 0xf000, v16
  s_mul_i32 s40, s58, 0x1400
  s_add_u32 s40, s40, 0x80
  v_add_u32 v18, s40, v10
  v_add_u32 v19, 0xf000, v18
  v_mov_b32 v20, 0x3f803f80
  v_mov_b32 v21, 0x3f803f80
  v_mov_b32 v22, 0x3f803f80
  v_mov_b32 v23, 0x3f803f80
  s_add_u32 s42, s43, 0x80
  s_cmp_ge_u32 s42, 0x500
  s_cselect_b32 s56, 0x500, 0
  s_sub_u32 s42, s42, s56
  s_add_u32 m0, s55, 0x8000
  s_nop 0
  buffer_load_dwordx4 v5, s[8:11], s42 offen lds
  s_add_u32 m0, s55, 0x8400
  ds_read_b64_tr_b16 v[24:25], v16 offset:0
  ds_read_b64_tr_b16 v[26:27], v16 offset:1280
  buffer_load_dwordx4 v6, s[8:11], s42 offen lds
  s_add_u32 m0, s55, 0x8800
  s_nop 0
  buffer_load_dwordx4 v7, s[8:11], s42 offen lds
  s_add_u32 m0, s55, 0x8c00
  ds_read_b64_tr_b16 v[28:29], v16 offset:32
  ds_read_b64_tr_b16 v[30:31], v16 offset:1312
  buffer_load_dwordx4 v8, s[8:11], s42 offen lds
  s_add_u32 s87, s92, s85
  s_cmp_ge_u32 s87, s86
  s_cselect_b32 s56, s94, 0
  s_sub_u32 s87, s87, s56
  s_add_u32 m0, s93, 0xa000
  s_nop 0
  buffer_load_dwordx4 v11, s[88:91], s87 offen lds
  ds_read_b64_tr_b16 v[32:33], v16 offset:5120
  ds_read_b64_tr_b16 v[34:35], v16 offset:6400
  s_add_u32 m0, s93, 0xa800
  s_nop 0
  buffer_load_dwordx4 v12, s[88:91], s87 offen lds
  s_add_u32 m0, s93, 0xb000
  s_nop 0
  buffer_load_dwordx4 v13, s[88:91], s87 offen lds
  ds_read_b64_tr_b16 v[36:37], v16 offset:5152
  ds_read_b64_tr_b16 v[38:39], v16 offset:6432
  s_add_u32 m0, s93, 0xb800
  s_nop 0
  buffer_load_dwordx4 v14, s[88:91], s87 offen lds
  s_add_u32 m0, s93, 0xc000
  s_nop 0
  buffer_load_dwordx4 v15, s[88:91], s87 offen lds
  ds_read_b64_tr_b16 v[40:41], v18 offset:0
  ds_read_b64_tr_b16 v[42:43], v18 offset:1280
  s_waitcnt lgkmcnt(8)
  v_mfma_f32_16x16x32_bf16 v[44:47], v[20:23], v[24:27], 0
  s_waitcnt lgkmcnt(6)
  v_mfma_f32_16x16x32_bf16 v[48:51], v[20:23], v[28:31], 0
  s_waitcnt lgkmcnt(4)
  v_mfma_f32_16x16x32_bf16 v[44:47], v[20:23], v[32:35], v[44:47]
  s_waitcnt lgkmcnt(2)
  v_mfma_f32_16x16x32_bf16 v[48:51], v[20:23], v[36:39], v[48:51]
  s_waitcnt lgkmcnt(0)
  v_mfma_f32_16x16x32_bf16 v[52:55], v[20:23], v[40:43], 0
  s_waitcnt lgkmcnt(0)
  v_mov_b32 v10, 0
  s_or_b32 s3, s2, s6
  s_cmp_lg_u32 s3, 0
  s_cbranch_scc1 L_e0_3
  buffer_load_dword v10, off, s[20:23], 0 sc1
L_e0_3:
  s_mov_b32 s40, 0xf00
  s_lshl_b32 s60, s2, 2
  s_add_u32 s60, s60, s6
  s_mul_i32 s61, s60, 7
  v_add_u32 v57, s61, v1
  v_cmp_gt_u32 s[62:63], 7, v1
  v_cmp_gt_u32 vcc, 0x1900, v57
  s_nop 3
  s_and_b64 s[62:63], s[62:63], vcc
  v_lshlrev_b32 v57, 7, v57
  v_mov_b32 v58, 0x40000000
  v_cndmask_b32 v57, v58, v57, s[62:63]
  s_mul_i32 s61, s60, 17
  v_add_u32 v58, s61, v1
  v_cmp_gt_u32 s[62:63], 17, v1
  v_cmp_gt_u32 vcc, 0x4380, v58
  s_nop 3
  s_and_b64 s[62:63], s[62:63], vcc
  v_lshlrev_b32 v58, 7, v58
  v_mov_b32 v59, 0x40000000
  v_cndmask_b32 v58, v59, v58, s[62:63]
  s_mul_i32 s61, s60, 17
  v_add_u32 v59, s61, v1
  v_cmp_gt_u32 s[62:63], 17, v1
  v_cmp_gt_u32 vcc, 0x4380, v59
  s_nop 3
  s_and_b64 s[62:63], s[62:63], vcc
  v_lshlrev_b32 v59, 7, v59
  v_mov_b32 v60, 0x40000000
  v_cndmask_b32 v59, v60, v59, s[62:63]
  s_mul_i32 s61, s60, 7
  v_add_u32 v60, s61, v1
  v_cmp_gt_u32 s[62:63], 7, v1
  v_cmp_gt_u32 vcc, 0x1900, v60
  s_nop 3
  s_and_b64 s[62:63], s[62:63], vcc
  v_lshlrev_b32 v60, 7, v60
  v_mov_b32 v61, 0x40000000
  v_cndmask_b32 v60, v61, v60, s[62:63]
  s_waitcnt vmcnt(14)
  s_waitcnt vmcnt(9)
  s_barrier
  s_add_u32 s43, s42, 0x80
  s_cmp_ge_u32 s43, 0x500
  s_cselect_b32 s56, 0x500, 0
  s_sub_u32 s43, s43, s56
  s_add_u32 m0, s55, 0
  s_nop 0
  buffer_load_dwordx4 v5, s[8:11], s43 offen lds
  s_add_u32 m0, s55, 0x400
  ds_read_b64_tr_b16 v[24:25], v16 offset:20480
  ds_read_b64_tr_b16 v[26:27], v16 offset:21760
  buffer_load_dwordx4 v6, s[8:11], s43 offen lds
  s_add_u32 m0, s55, 0x800
  s_nop 0
  buffer_load_dwordx4 v7, s[8:11], s43 offen lds
  s_add_u32 m0, s55, 0xc00
  ds_read_b64_tr_b16 v[28:29], v16 offset:20512
  ds_read_b64_tr_b16 v[30:31], v16 offset:21792
  buffer_load_dwordx4 v8, s[8:11], s43 offen lds
  s_add_u32 s92, s87, s85
  s_cmp_ge_u32 s92, s86
  s_cselect_b32 s56, s94, 0
  s_sub_u32 s92, s92, s56
  s_add_u32 m0, s93, 0xf000
  s_nop 0
  buffer_load_dwordx4 v11, s[88:91], s92 offen lds
  ds_read_b64_tr_b16 v[32:33], v16 offset:25600
  ds_read_b64_tr_b16 v[34:35], v16 offset:26880
  s_add_u32 m0, s93, 0xf800
  s_nop 0
  buffer_load_dwordx4 v12, s[88:91], s92 offen lds
  s_add_u32 m0, s93, 0x10000
  s_nop 0
  buffer_load_dwordx4 v13, s[88:91], s92 offen lds
  ds_read_b64_tr_b16 v[36:37], v16 offset:25632
  ds_read_b64_tr_b16 v[38:39], v16 offset:26912
  s_add_u32 m0, s93, 0x10800
  s_nop 0
  buffer_load_dwordx4 v14, s[88:91], s92 offen lds
  s_add_u32 m0, s93, 0x11000
  s_nop 0
  buffer_load_dwordx4 v15, s[88:91], s92 offen lds
  ds_read_b64_tr_b16 v[40:41], v18 offset:20480
  ds_read_b64_tr_b16 v[42:43], v18 offset:21760
  buffer_load_dword v56, v57, s[24:27], 0 offen
  s_waitcnt lgkmcnt(8)
  v_mfma_f32_16x16x32_bf16 v[44:47], v[20:23], v[24:27], v[44:47]
  s_waitcnt lgkmcnt(6)
  v_mfma_f32_16x16x32_bf16 v[48:51], v[20:23], v[28:31], v[48:51]
  s_waitcnt lgkmcnt(4)
  v_mfma_f32_16x16x32_bf16 v[44:47], v[20:23], v[32:35], v[44:47]
  s_waitcnt lgkmcnt(2)
  v_mfma_f32_16x16x32_bf16 v[48:51], v[20:23], v[36:39], v[48:51]
  s_waitcnt lgkmcnt(0)
  v_mfma_f32_16x16x32_bf16 v[52:55], v[20:23], v[40:43], v[52:55]
  s_waitcnt lgkmcnt(0)
  s_waitcnt vmcnt(15)
  s_waitcnt vmcnt(10)
  s_barrier
  s_add_u32 s42, s43, 0x80
  s_cmp_ge_u32 s42, 0x500
  s_cselect_b32 s56, 0x500, 0
  s_sub_u32 s42, s42, s56
  s_add_u32 m0, s55, 0x4000
  s_nop 0
  buffer_load_dwordx4 v5, s[8:11], s42 offen lds
  s_add_u32 m0, s55, 0x4400
  ds_read_b64_tr_b16 v[24:25], v16 offset:40960
  ds_read_b64_tr_b16 v[26:27], v16 offset:42240
  buffer_load_dwordx4 v6, s[8:11], s42 offen lds
  s_add_u32 m0, s55, 0x4800
  s_nop 0
  buffer_load_dwordx4 v7, s[8:11], s42 offen lds
  s_add_u32 m0, s55, 0x4c00
  ds_read_b64_tr_b16 v[28:29], v16 offset:40992
  ds_read_b64_tr_b16 v[30:31], v16 offset:42272
  buffer_load_dwordx4 v8, s[8:11], s42 offen lds
  s_add_u32 s87, s92, s85
  s_cmp_ge_u32 s87, s86
  s_cselect_b32 s56, s94, 0
  s_sub_u32 s87, s87, s56
  s_add_u32 m0, s93, 0x14000
  s_nop 0
  buffer_load_dwordx4 v11, s[88:91], s87 offen lds
  ds_read_b64_tr_b16 v[32:33], v16 offset:46080
  ds_read_b64_tr_b16 v[34:35], v16 offset:47360
  s_add_u32 m0, s93, 0x14800
  s_nop 0
  buffer_load_dwordx4 v12, s[88:91], s87 offen lds
  s_add_u32 m0, s93, 0x15000
  s_nop 0
  buffer_load_dwordx4 v13, s[88:91], s87 offen lds
  ds_read_b64_tr_b16 v[36:37], v16 offset:46112
  ds_read_b64_tr_b16 v[38:39], v16 offset:47392
  s_add_u32 m0, s93, 0x15800
  s_nop 0
  buffer_load_dwordx4 v14, s[88:91], s87 offen lds
  s_add_u32 m0, s93, 0x16000
  s_nop 0
  buffer_load_dwordx4 v15, s[88:91], s87 offen lds
  ds_read_b64_tr_b16 v[40:41], v18 offset:40960
  ds_read_b64_tr_b16 v[42:43], v18 offset:42240
  s_mul_i32 s41, s52, 0xc80
  v_lshlrev_b32 v9, 4, v1
  v_add_u32 v9, s54, v9
  s_add_u32 m0, s54, 0x25000
  s_nop 0
  buffer_load_dwordx4 v9, s[44:47], s41 offen lds
  s_waitcnt lgkmcnt(8)
  v_mfma_f32_16x16x32_bf16 v[44:47], v[20:23], v[24:27], v[44:47]
  s_waitcnt lgkmcnt(6)
  v_mfma_f32_16x16x32_bf16 v[48:51], v[20:23], v[28:31], v[48:51]
  s_waitcnt lgkmcnt(4)
  v_mfma_f32_16x16x32_bf16 v[44:47], v[20:23], v[32:35], v[44:47]
  s_waitcnt lgkmcnt(2)
  v_mfma_f32_16x16x32_bf16 v[48:51], v[20:23], v[36:39], v[48:51]
  s_waitcnt lgkmcnt(0)
  v_mfma_f32_16x16x32_bf16 v[52:55], v[20:23], v[40:43], v[52:55]
  s_waitcnt lgkmcnt(0)
  s_waitcnt vmcnt(16)
  s_waitcnt vmcnt(11)
  s_barrier
  s_add_u32 s43, s42, 0x80
  s_cmp_ge_u32 s43, 0x500
  s_cselect_b32 s56, 0x500, 0
  s_sub_u32 s43, s43, s56
  s_add_u32 m0, s55, 0x8000
  s_nop 0
  buffer_load_dwordx4 v5, s[8:11], s43 offen lds
  s_add_u32 m0, s55, 0x8400
  ds_read_b64_tr_b16 v[24:25], v17 offset:0
  ds_read_b64_tr_b16 v[26:27], v17 offset:1280
  buffer_load_dwordx4 v6, s[8:11], s43 offen lds
  s_add_u32 m0, s55, 0x8800
  s_nop 0
  buffer_load_dwordx4 v7, s[8:11], s43 offen lds
  s_add_u32 m0, s55, 0x8c00
  ds_read_b64_tr_b16 v[28:29], v17 offset:32
  ds_read_b64_tr_b16 v[30:31], v17 offset:1312
  buffer_load_dwordx4 v8, s[8:11], s43 offen lds
  s_add_u32 s92, s87, s85
  s_cmp_ge_u32 s92, s86
  s_cselect_b32 s56, s94, 0
  s_sub_u32 s92, s92, s56
  s_add_u32 m0, s93, 0
  s_nop 0
  buffer_load_dwordx4 v11, s[88:91], s92 offen lds
  ds_read_b64_tr_b16 v[32:33], v17 offset:5120
  ds_read_b64_tr_b16 v[34:35], v17 offset:6400
  s_add_u32 m0, s93, 0x800
  s_nop 0
  buffer_load_dwordx4 v12, s[88:91], s92 offen lds
  s_add_u32 m0, s93, 0x1000
  s_nop 0
  buffer_load_dwordx4 v13, s[88:91], s92 offen lds
  ds_read_b64_tr_b16 v[36:37], v17 offset:5152
  ds_read_b64_tr_b16 v[38:39], v17 offset:6432
  s_add_u32 m0, s93, 0x1800
  s_nop 0
  buffer_load_dwordx4 v14, s[88:91], s92 offen lds
  s_add_u32 m0, s93, 0x2000
  s_nop 0
  buffer_load_dwordx4 v15, s[88:91], s92 offen lds
  ds_read_b64_tr_b16 v[40:41], v19 offset:0
  ds_read_b64_tr_b16 v[42:43], v19 offset:1280
  buffer_load_dword v56, v58, s[28:31], 0 offen
  s_waitcnt lgkmcnt(8)
  v_mfma_f32_16x16x32_bf16 v[44:47], v[20:23], v[24:27], v[44:47]
  s_waitcnt lgkmcnt(6)
  v_mfma_f32_16x16x32_bf16 v[48:51], v[20:23], v[28:31], v[48:51]
  s_waitcnt lgkmcnt(4)
  v_mfma_f32_16x16x32_bf16 v[44:47], v[20:23], v[32:35], v[44:47]
  s_waitcnt lgkmcnt(2)
  v_mfma_f32_16x16x32_bf16 v[48:51], v[20:23], v[36:39], v[48:51]
  s_waitcnt lgkmcnt(0)
  v_mfma_f32_16x16x32_bf16 v[52:55], v[20:23], v[40:43], v[52:55]
  s_waitcnt lgkmcnt(0)
  s_waitcnt vmcnt(16)
  s_waitcnt vmcnt(11)
  s_barrier
  s_or_b32 s3, s2, s6
  s_cmp_lg_u32 s3, 0
  s_cbranch_scc1 L_e1_4
  v_add_u32 v10, 0x9e3779b8, v10
  v_or_b32 v10, 1, v10
  s_mov_b64 exec, 1
  buffer_store_dword v10, off, s[20:23], 0 sc1
  buffer_store_dword v10, off, s[48:51], 0 sc1
  s_mov_b64 exec, -1
  s_nop 1
L_e1_4:
  s_add_u32 s42, s43, 0x80
  s_cmp_ge_u32 s42, 0x500
  s_cselect_b32 s56, 0x500, 0
  s_sub_u32 s42, s42, s56
  s_add_u32 m0, s55, 0
  s_nop 0
  buffer_load_dwordx4 v5, s[8:11], s42 offen lds
  s_add_u32 m0, s55, 0x400
  ds_read_b64_tr_b16 v[24:25], v17 offset:20480
  ds_read_b64_tr_b16 v[26:27], v17 offset:21760
  buffer_load_dwordx4 v6, s[8:11], s42 offen lds
  s_add_u32 m0, s55, 0x800
  s_nop 0
  buffer_load_dwordx4 v7, s[8:11], s42 offen lds
  s_add_u32 m0, s55, 0xc00
  ds_read_b64_tr_b16 v[28:29], v17 offset:20512
  ds_read_b64_tr_b16 v[30:31], v17 offset:21792
  buffer_load_dwordx4 v8, s[8:11], s42 offen lds
  s_add_u32 s87, s92, s85
  s_cmp_ge_u32 s87, s86
  s_cselect_b32 s56, s94, 0
  s_sub_u32 s87, s87, s56
  s_add_u32 m0, s93, 0x5000
  s_nop 0
  buffer_load_dwordx4 v11, s[88:91], s87 offen lds
  ds_read_b64_tr_b16 v[32:33], v17 offset:25600
  ds_read_b64_tr_b16 v[34:35], v17 offset:26880
  s_add_u32 m0, s93, 0x5800
  s_nop 0
  buffer_load_dwordx4 v12, s[88:91], s87 offen lds
  s_add_u32 m0, s93, 0x6000
  s_nop 0
  buffer_load_dwordx4 v13, s[88:91], s87 offen lds
  ds_read_b64_tr_b16 v[36:37], v17 offset:25632
  ds_read_b64_tr_b16 v[38:39], v17 offset:26912
  s_add_u32 m0, s93, 0x6800
  s_nop 0
  buffer_load_dwordx4 v14, s[88:91], s87 offen lds
  s_add_u32 m0, s93, 0x7000
  s_nop 0
  buffer_load_dwordx4 v15, s[88:91], s87 offen lds
  ds_read_b64_tr_b16 v[40:41], v19 offset:20480
  ds_read_b64_tr_b16 v[42:43], v19 offset:21760
  s_waitcnt lgkmcnt(8)
  v_mfma_f32_16x16x32_bf16 v[44:47], v[20:23], v[24:27], v[44:47]
  s_waitcnt lgkmcnt(6)
  v_mfma_f32_16x16x32_bf16 v[48:51], v[20:23], v[28:31], v[48:51]
  s_waitcnt lgkmcnt(4)
  v_mfma_f32_16x16x32_bf16 v[44:47], v[20:23], v[32:35], v[44:47]
  s_waitcnt lgkmcnt(2)
  v_mfma_f32_16x16x32_bf16 v[48:51], v[20:23], v[36:39], v[48:51]
  s_waitcnt lgkmcnt(0)
  v_mfma_f32_16x16x32_bf16 v[52:55], v[20:23], v[40:43], v[52:55]
  s_waitcnt lgkmcnt(0)
  s_waitcnt vmcnt(15)
  s_waitcnt vmcnt(10)
  s_barrier
  s_add_u32 s43, s42, 0x80
  s_cmp_ge_u32 s43, 0x500
  s_cselect_b32 s56, 0x500, 0
  s_sub_u32 s43, s43, s56
  s_add_u32 m0, s55, 0x4000
  s_nop 0
  buffer_load_dwordx4 v5, s[8:11], s43 offen lds
  s_add_u32 m0, s55, 0x4400
  ds_read_b64_tr_b16 v[24:25], v16 offset:0
  ds_read_b64_tr_b16 v[26:27], v16 offset:1280
  buffer_load_dwordx4 v6, s[8:11], s43 offen lds
  s_add_u32 m0, s55, 0x4800
  s_nop 0
  buffer_load_dwordx4 v7, s[8:11], s43 offen lds
  s_add_u32 m0, s55, 0x4c00
  ds_read_b64_tr_b16 v[28:29], v16 offset:32
  ds_read_b64_tr_b16 v[30:31], v16 offset:1312
  buffer_load_dwordx4 v8, s[8:11], s43 offen lds
  s_add_u32 s92, s87, s85
  s_cmp_ge_u32 s92, s86
  s_cselect_b32 s56, s94, 0
  s_sub_u32 s92, s92, s56
  s_add_u32 m0, s93, 0xa000
  s_nop 0
  buffer_load_dwordx4 v11, s[88:91], s92 offen lds
  ds_read_b64_tr_b16 v[32:33], v16 offset:5120
  ds_read_b64_tr_b16 v[34:35], v16 offset:6400
  s_add_u32 m0, s93, 0xa800
  s_nop 0
  buffer_load_dwordx4 v12, s[88:91], s92 offen lds
  s_add_u32 m0, s93, 0xb000
  s_nop 0
  buffer_load_dwordx4 v13, s[88:91], s92 offen lds
  ds_read_b64_tr_b16 v[36:37], v16 offset:5152
  ds_read_b64_tr_b16 v[38:39], v16 offset:6432
  s_add_u32 m0, s93, 0xb800
  s_nop 0
  buffer_load_dwordx4 v14, s[88:91], s92 offen lds
  s_add_u32 m0, s93, 0xc000
  s_nop 0
  buffer_load_dwordx4 v15, s[88:91], s92 offen lds
  ds_read_b64_tr_b16 v[40:41], v18 offset:0
  ds_read_b64_tr_b16 v[42:43], v18 offset:1280
  buffer_load_dword v56, v59, s[32:35], 0 offen
  s_waitcnt lgkmcnt(8)
  v_mfma_f32_16x16x32_bf16 v[44:47], v[20:23], v[24:27], v[44:47]
  s_waitcnt lgkmcnt(6)
  v_mfma_f32_16x16x32_bf16 v[48:51], v[20:23], v[28:31], v[48:51]
  s_waitcnt lgkmcnt(4)
  v_mfma_f32_16x16x32_bf16 v[44:47], v[20:23], v[32:35], v[44:47]
  s_waitcnt lgkmcnt(2)
  v_mfma_f32_16x16x32_bf16 v[48:51], v[20:23], v[36:39], v[48:51]
  s_waitcnt lgkmcnt(0)
  v_mfma_f32_16x16x32_bf16 v[52:55], v[20:23], v[40:43], v[52:55]
  s_waitcnt lgkmcnt(0)
  s_waitcnt vmcnt(15)
  s_waitcnt vmcnt(10)
  s_barrier
  s_add_u32 s42, s43, 0x80
  s_cmp_ge_u32 s42, 0x500
  s_cselect_b32 s56, 0x500, 0
  s_sub_u32 s42, s42, s56
  s_add_u32 m0, s55, 0x8000
  s_nop 0
  buffer_load_dwordx4 v5, s[8:11], s42 offen lds
  s_add_u32 m0, s55, 0x8400
  ds_read_b64_tr_b16 v[24:25], v16 offset:20480
  ds_read_b64_tr_b16 v[26:27], v16 offset:21760
  buffer_load_dwordx4 v6, s[8:11], s42 offen lds
  s_add_u32 m0, s55, 0x8800
  s_nop 0
  buffer_load_dwordx4 v7, s[8:11], s42 offen lds
  s_add_u32 m0, s55, 0x8c00
  ds_read_b64_tr_b16 v[28:29], v16 offset:20512
  ds_read_b64_tr_b16 v[30:31], v16 offset:21792
  buffer_load_dwordx4 v8, s[8:11], s42 offen lds
  s_add_u32 s87, s92, s85
  s_cmp_ge_u32 s87, s86
  s_cselect_b32 s56, s94, 0
  s_sub_u32 s87, s87, s56
  s_add_u32 m0, s93, 0xf000
  s_nop 0
  buffer_load_dwordx4 v11, s[88:91], s87 offen lds
  ds_read_b64_tr_b16 v[32:33], v16 offset:25600
  ds_read_b64_tr_b16 v[34:35], v16 offset:26880
  s_add_u32 m0, s93, 0xf800
  s_nop 0
  buffer_load_dwordx4 v12, s[88:91], s87 offen lds
  s_add_u32 m0, s93, 0x10000
  s_nop 0
  buffer_load_dwordx4 v13, s[88:91], s87 offen lds
  ds_read_b64_tr_b16 v[36:37], v16 offset:25632
  ds_read_b64_tr_b16 v[38:39], v16 offset:26912
  s_add_u32 m0, s93, 0x10800
  s_nop 0
  buffer_load_dwordx4 v14, s[88:91], s87 offen lds
  s_add_u32 m0, s93, 0x11000
  s_nop 0
  buffer_load_dwordx4 v15, s[88:91], s87 offen lds
  ds_read_b64_tr_b16 v[40:41], v18 offset:20480
  ds_read_b64_tr_b16 v[42:43], v18 offset:21760
  s_waitcnt lgkmcnt(8)
  v_mfma_f32_16x16x32_bf16 v[44:47], v[20:23], v[24:27], v[44:47]
  s_waitcnt lgkmcnt(6)
  v_mfma_f32_16x16x32_bf16 v[48:51], v[20:23], v[28:31], v[48:51]
  s_waitcnt lgkmcnt(4)
  v_mfma_f32_16x16x32_bf16 v[44:47], v[20:23], v[32:35], v[44:47]
  s_waitcnt lgkmcnt(2)
  v_mfma_f32_16x16x32_bf16 v[48:51], v[20:23], v[36:39], v[48:51]
  s_waitcnt lgkmcnt(0)
  v_mfma_f32_16x16x32_bf16 v[52:55], v[20:23], v[40:43], v[52:55]
  s_waitcnt lgkmcnt(0)
  s_waitcnt vmcnt(15)
  s_waitcnt vmcnt(10)
  s_barrier
  s_add_u32 s43, s42, 0x80
  s_cmp_ge_u32 s43, 0x500
  s_cselect_b32 s56, 0x500, 0
  s_sub_u32 s43, s43, s56
  s_add_u32 m0, s55, 0
  s_nop 0
  buffer_load_dwordx4 v5, s[8:11], s43 offen lds
  s_add_u32 m0, s55, 0x400
  ds_read_b64_tr_b16 v[24:25], v16 offset:40960
  ds_read_b64_tr_b16 v[26:27], v16 offset:42240
  buffer_load_dwordx4 v6, s[8:11], s43 offen lds
  s_add_u32 m0, s55, 0x800
  s_nop 0
  buffer_load_dwordx4 v7, s[8:11], s43 offen lds
  s_add_u32 m0, s55, 0xc00
  ds_read_b64_tr_b16 v[28:29], v16 offset:40992
  ds_read_b64_tr_b16 v[30:31], v16 offset:42272
  buffer_load_dwordx4 v8, s[8:11], s43 offen lds
  s_add_u32 s92, s87, s85
  s_cmp_ge_u32 s92, s86
  s_cselect_b32 s56, s94, 0
  s_sub_u32 s92, s92, s56
  s_add_u32 m0, s93, 0x14000
  s_nop 0
  buffer_load_dwordx4 v11, s[88:91], s92 offen lds
  ds_read_b64_tr_b16 v[32:33], v16 offset:46080
  ds_read_b64_tr_b16 v[34:35], v16 offset:47360
  s_add_u32 m0, s93, 0x14800
  s_nop 0
  buffer_load_dwordx4 v12, s[88:91], s92 offen lds
  s_add_u32 m0, s93, 0x15000
  s_nop 0
  buffer_load_dwordx4 v13, s[88:91], s92 offen lds
  ds_read_b64_tr_b16 v[36:37], v16 offset:46112
  ds_read_b64_tr_b16 v[38:39], v16 offset:47392
  s_add_u32 m0, s93, 0x15800
  s_nop 0
  buffer_load_dwordx4 v14, s[88:91], s92 offen lds
  s_add_u32 m0, s93, 0x16000
  s_nop 0
  buffer_load_dwordx4 v15, s[88:91], s92 offen lds
  ds_read_b64_tr_b16 v[40:41], v18 offset:40960
  ds_read_b64_tr_b16 v[42:43], v18 offset:42240
  buffer_load_dword v56, v60, s[36:39], 0 offen
  s_waitcnt lgkmcnt(8)
  v_mfma_f32_16x16x32_bf16 v[44:47], v[20:23], v[24:27], v[44:47]
  s_waitcnt lgkmcnt(6)
  v_mfma_f32_16x16x32_bf16 v[48:51], v[20:23], v[28:31], v[48:51]
  s_waitcnt lgkmcnt(4)
  v_mfma_f32_16x16x32_bf16 v[44:47], v[20:23], v[32:35], v[44:47]
  s_waitcnt lgkmcnt(2)
  v_mfma_f32_16x16x32_bf16 v[48:51], v[20:23], v[36:39], v[48:51]
  s_waitcnt lgkmcnt(0)
  v_mfma_f32_16x16x32_bf16 v[52:55], v[20:23], v[40:43], v[52:55]
  s_waitcnt lgkmcnt(0)
  s_waitcnt vmcnt(15)
  s_waitcnt vmcnt(10)
  s_barrier
  ds_read_b64_tr_b16 v[24:25], v17 offset:0
  ds_read_b64_tr_b16 v[26:27], v17 offset:1280
  ds_read_b64_tr_b16 v[28:29], v17 offset:32
  ds_read_b64_tr_b16 v[30:31], v17 offset:1312
  ds_read_b64_tr_b16 v[32:33], v17 offset:5120
  ds_read_b64_tr_b16 v[34:35], v17 offset:6400
  ds_read_b64_tr_b16 v[36:37], v17 offset:5152
  ds_read_b64_tr_b16 v[38:39], v17 offset:6432
  ds_read_b64_tr_b16 v[40:41], v19 offset:0
  ds_read_b64_tr_b16 v[42:43], v19 offset:1280
  s_waitcnt lgkmcnt(8)
  v_mfma_f32_16x16x32_bf16 v[44:47], v[20:23], v[24:27], v[44:47]
  s_waitcnt lgkmcnt(6)
  v_mfma_f32_16x16x32_bf16 v[48:51], v[20:23], v[28:31], v[48:51]
  s_waitcnt lgkmcnt(4)
  v_mfma_f32_16x16x32_bf16 v[44:47], v[20:23], v[32:35], v[44:47]
  s_waitcnt lgkmcnt(2)
  v_mfma_f32_16x16x32_bf16 v[48:51], v[20:23], v[36:39], v[48:51]
  s_waitcnt lgkmcnt(0)
  v_mfma_f32_16x16x32_bf16 v[52:55], v[20:23], v[40:43], v[52:55]
  s_waitcnt lgkmcnt(0)
  s_waitcnt vmcnt(6)
  s_waitcnt vmcnt(1)
  s_barrier
  ds_read_b64_tr_b16 v[24:25], v17 offset:20480
  ds_read_b64_tr_b16 v[26:27], v17 offset:21760
  ds_read_b64_tr_b16 v[28:29], v17 offset:20512
  ds_read_b64_tr_b16 v[30:31], v17 offset:21792
  ds_read_b64_tr_b16 v[32:33], v17 offset:25600
  ds_read_b64_tr_b16 v[34:35], v17 offset:26880
  ds_read_b64_tr_b16 v[36:37], v17 offset:25632
  ds_read_b64_tr_b16 v[38:39], v17 offset:26912
  ds_read_b64_tr_b16 v[40:41], v19 offset:20480
  ds_read_b64_tr_b16 v[42:43], v19 offset:21760
  s_waitcnt lgkmcnt(8)
  v_mfma_f32_16x16x32_bf16 v[44:47], v[20:23], v[24:27], v[44:47]
  s_waitcnt lgkmcnt(6)
  v_mfma_f32_16x16x32_bf16 v[48:51], v[20:23], v[28:31], v[48:51]
  s_waitcnt lgkmcnt(4)
  v_mfma_f32_16x16x32_bf16 v[44:47], v[20:23], v[32:35], v[44:47]
  s_waitcnt lgkmcnt(2)
  v_mfma_f32_16x16x32_bf16 v[48:51], v[20:23], v[36:39], v[48:51]
  s_waitcnt lgkmcnt(0)
  v_mfma_f32_16x16x32_bf16 v[52:55], v[20:23], v[40:43], v[52:55]
  s_mul_i32 s40, s57, 0x180
  s_add_u32 s40, s40, 0x277c0
  v_lshl_add_u32 v57, v2, 2, s40
  s_lshl_b32 s40, s58, 7
  v_add_u32 v58, s40, v57
  s_lshl_b32 s40, s58, 6
  v_add_u32 v57, s40, v57
  s_mov_b64 exec, 0xffff
  ds_write_b32 v58, v44
  ds_write_b32 v58, v48 offset:64
  ds_write_b32 v57, v52 offset:256
  s_mov_b64 exec, -1
  s_waitcnt lgkmcnt(0)
  s_barrier
  s_setprio 0
  v_lshlrev_b32 v5, 4, v1
  s_lshl_b32 s8, s6, 6
  v_add_u32 v6, s8, v1
  v_mul_u32_u24 v7, 0x667, v6
  v_lshrrev_b32 v7, 14, v7
  v_mul_u32_u24 v58, 10, v7
  v_sub_u32 v8, v6, v58
  v_lshlrev_b32 v8, 4, v8
  v_and_b32 v57, 0xfff3, v7
  v_bfe_u32 v58, v7, 2, 1
  v_lshl_or_b32 v57, v58, 3, v57
  v_bfe_u32 v58, v7, 3, 1
  v_lshl_or_b32 v57, v58, 2, v57
  v_mul_u32_u24 v58, 0x500, v57
  v_add_u32 v11, v58, v8
  v_add_u32 v6, s8, v1
  v_add_u32 v6, 0x100, v6
  v_mul_u32_u24 v7, 0x667, v6
  v_lshrrev_b32 v7, 14, v7
  v_mul_u32_u24 v58, 10, v7
  v_sub_u32 v8, v6, v58
  v_lshlrev_b32 v8, 4, v8
  v_and_b32 v57, 0xfff3, v7
  v_bfe_u32 v58, v7, 2, 1
  v_lshl_or_b32 v57, v58, 3, v57
  v_bfe_u32 v58, v7, 3, 1
  v_lshl_or_b32 v57, v58, 2, v57
  v_mul_u32_u24 v58, 0x500, v57
  v_add_u32 v12, v58, v8
  v_add_u32 v6, s8, v1
  v_add_u32 v6, 0x200, v6
  v_mul_u32_u24 v7, 0x667, v6
  v_lshrrev_b32 v7, 14, v7
  v_mul_u32_u24 v58, 10, v7
  v_sub_u32 v8, v6, v58
  v_lshlrev_b32 v8, 4, v8
  v_and_b32 v57, 0xfff3, v7
  v_bfe_u32 v58, v7, 2, 1
  v_lshl_or_b32 v57, v58, 3, v57
  v_bfe_u32 v58, v7, 3, 1
  v_lshl_or_b32 v57, v58, 2, v57
  v_mul_u32_u24 v58, 0x500, v57
  v_add_u32 v13, v58, v8
  v_add_u32 v6, s8, v1
  v_add_u32 v6, 0x300, v6
  v_mul_u32_u24 v7, 0x667, v6
  v_lshrrev_b32 v7, 14, v7
  v_mul_u32_u24 v58, 10, v7
  v_sub_u32 v8, v6, v58
  v_lshlrev_b32 v8, 4, v8
  v_and_b32 v57, 0xfff3, v7
  v_bfe_u32 v58, v7, 2, 1
  v_lshl_or_b32 v57, v58, 3, v57
  v_bfe_u32 v58, v7, 3, 1
  v_lshl_or_b32 v57, v58, 2, v57
  v_mul_u32_u24 v58, 0x500, v57
  v_add_u32 v14, v58, v8
  v_add_u32 v6, s8, v1
  v_add_u32 v6, 0x400, v6
  v_mul_u32_u24 v7, 0x667, v6
  v_lshrrev_b32 v7, 14, v7
  v_mul_u32_u24 v58, 10, v7
  v_sub_u32 v8, v6, v58
  v_lshlrev_b32 v8, 4, v8
  v_and_b32 v57, 0xfff3, v7
  v_bfe_u32 v58, v7, 2, 1
  v_lshl_or_b32 v57, v58, 3, v57
  v_bfe_u32 v58, v7, 3, 1
  v_lshl_or_b32 v57, v58, 2, v57
  v_mul_u32_u24 v58, 0x500, v57
  v_add_u32 v15, v58, v8
  s_mul_i32 s8, s52, 0xa0
  s_add_u32 s9, s8, 0x28000
  s_add_u32 s10, s8, 0x50000
  s_add_u32 s11, s8, 0x78000
  s_add_u32 s12, s8, 0xa0000
  buffer_load_dword v10, off, s[48:51], 0 sc1
  s_add_u32 m0, s54, 0
  s_nop 0
  buffer_load_dwordx4 v11, s[24:27], s8 offen lds
  s_add_u32 m0, s54, 0x1000
  s_nop 0
  buffer_load_dwordx4 v12, s[24:27], s8 offen lds
  s_add_u32 m0, s54, 0x2000
  s_nop 0
  buffer_load_dwordx4 v13, s[24:27], s8 offen lds
  s_add_u32 m0, s54, 0x3000
  s_nop 0
  buffer_load_dwordx4 v14, s[24:27], s8 offen lds
  s_add_u32 m0, s54, 0x4000
  s_nop 0
  buffer_load_dwordx4 v15, s[24:27], s8 offen lds
  s_add_u32 m0, s54, 0x5000
  s_nop 0
  buffer_load_dwordx4 v11, s[24:27], s9 offen lds
  s_add_u32 m0, s54, 0x6000
  s_nop 0
  buffer_load_dwordx4 v12, s[24:27], s9 offen lds
  s_add_u32 m0, s54, 0x7000
  s_nop 0
  buffer_load_dwordx4 v13, s[24:27], s9 offen lds
  s_add_u32 m0, s54, 0x8000
  s_nop 0
  buffer_load_dwordx4 v14, s[24:27], s9 offen lds
  s_add_u32 m0, s54, 0x9000
  s_nop 0
  buffer_load_dwordx4 v15, s[24:27], s9 offen lds
  s_add_u32 m0, s54, 0xa000
  s_nop 0
  buffer_load_dwordx4 v11, s[24:27], s10 offen lds
  s_add_u32 m0, s54, 0xb000
  s_nop 0
  buffer_load_dwordx4 v12, s[24:27], s10 offen lds
  s_add_u32 m0, s54, 0xc000
  s_nop 0
  buffer_load_dwordx4 v13, s[24:27], s10 offen lds
  s_add_u32 m0, s54, 0xd000
  s_nop 0
  buffer_load_dwordx4 v14, s[24:27], s10 offen lds
  s_add_u32 m0, s54, 0xe000
  s_nop 0
  buffer_load_dwordx4 v15, s[24:27], s10 offen lds
  s_add_u32 m0, s54, 0xf000
  s_nop 0
  buffer_load_dwordx4 v11, s[24:27], s11 offen lds
  s_add_u32 m0, s54, 0x10000
  s_nop 0
  buffer_load_dwordx4 v12, s[24:27], s11 offen lds
  s_add_u32 m0, s54, 0x11000
  s_nop 0
  buffer_load_dwordx4 v13, s[24:27], s11 offen lds
  s_add_u32 m0, s54, 0x12000
  s_nop 0
  buffer_load_dwordx4 v14, s[24:27], s11 offen lds
  s_add_u32 m0, s54, 0x13000
  s_nop 0
  buffer_load_dwordx4 v15, s[24:27], s11 offen lds
  s_add_u32 m0, s54, 0x14000
  s_nop 0
  buffer_load_dwordx4 v11, s[24:27], s12 offen lds
  s_add_u32 m0, s54, 0x15000
  s_nop 0
  buffer_load_dwordx4 v12, s[24:27], s12 offen lds
  s_add_u32 m0, s54, 0x16000
  s_nop 0
  buffer_load_dwordx4 v13, s[24:27], s12 offen lds
  s_add_u32 m0, s54, 0x17000
  s_nop 0
  buffer_load_dwordx4 v14, s[24:27], s12 offen lds
  s_add_u32 m0, s54, 0x18000
  s_nop 0
  buffer_load_dwordx4 v15, s[24:27], s12 offen lds
  s_nop 7
  s_cmp_lg_u32 s53, 0
  s_cbranch_scc1 L_elb_7
  s_barrier
  s_waitcnt vmcnt(25)
  v_readfirstlane_b32 s7, v10
  s_mov_b32 s13, 0x40000
L_fl_10:
  s_nop 2
  s_cmp_lg_u32 s7, 0
  s_cbranch_scc1 L_fd_11
  buffer_load_dword v10, off, s[48:51], 0 sc1
  s_waitcnt vmcnt(0)
  v_readfirstlane_b32 s7, v10
  s_sub_u32 s13, s13, 1
  s_cmp_lg_u32 s13, 0
  s_cbranch_scc1 L_fl_10
L_fd_11:
L_fs_9:
  s_cmp_lg_u32 s6, 0
  s_cbranch_scc1 L_nf_12
  s_lshl_b32 s13, s4, 6
  s_lshl_b32 s14, s52, 2
  s_add_u32 s13, s13, s14
  s_add_u32 s13, s13, 0x1000
  v_mov_b32 v6, s7
  s_mov_b64 exec, 1
  buffer_store_dword v6, off, s[20:23], s13 sc1
  s_mov_b64 exec, -1
  s_nop 1
L_nf_12:
  s_mov_b32 s13, 0
  s_lshl_b32 s14, s13, 6
  v_add_u32 v6, s14, v1
  v_mul_u32_u24 v7, 0xcd, v6
  v_lshrrev_b32 v7, 11, v7
  v_mul_u32_u24 v63, 10, v7
  v_sub_u32 v8, v6, v63
  v_lshlrev_b32 v8, 4, v8
  v_and_b32 v62, 0xfff3, v7
  v_bfe_u32 v63, v7, 2, 1
  v_lshl_or_b32 v62, v63, 3, v62
  v_bfe_u32 v63, v7, 3, 1
  v_lshl_or_b32 v62, v63, 2, v62
  v_mul_u32_u24 v63, 0x500, v62
  v_add_u32 v57, v63, v8
  v_add_u32 v6, s14, v1
  v_add_u32 v6, 64, v6
  v_mul_u32_u24 v7, 0xcd, v6
  v_lshrrev_b32 v7, 11, v7
  v_mul_u32_u24 v63, 10, v7
  v_sub_u32 v8, v6, v63
  v_lshlrev_b32 v8, 4, v8
  v_and_b32 v62, 0xfff3, v7
  v_bfe_u32 v63, v7, 2, 1
  v_lshl_or_b32 v62, v63, 3, v62
  v_bfe_u32 v63, v7, 3, 1
  v_lshl_or_b32 v62, v63, 2, v62
  v_mul_u32_u24 v63, 0x500, v62
  v_add_u32 v58, v63, v8
  v_add_u32 v6, s14, v1
  v_add_u32 v6, 0x80, v6
  v_mul_u32_u24 v7, 0xcd, v6
  v_lshrrev_b32 v7, 11, v7
  v_mul_u32_u24 v63, 10, v7
  v_sub_u32 v8, v6, v63
  v_lshlrev_b32 v8, 4, v8
  v_and_b32 v62, 0xfff3, v7
  v_bfe_u32 v63, v7, 2, 1
  v_lshl_or_b32 v62, v63, 3, v62
  v_bfe_u32 v63, v7, 3, 1
  v_lshl_or_b32 v62, v63, 2, v62
  v_mul_u32_u24 v63, 0x500, v62
  v_add_u32 v59, v63, v8
  v_add_u32 v6, s14, v1
  v_add_u32 v6, 0xc0, v6
  v_mul_u32_u24 v7, 0xcd, v6
  v_lshrrev_b32 v7, 11, v7
  v_mul_u32_u24 v63, 10, v7
  v_sub_u32 v8, v6, v63
  v_lshlrev_b32 v8, 4, v8
  v_and_b32 v62, 0xfff3, v7
  v_bfe_u32 v63, v7, 2, 1
  v_lshl_or_b32 v62, v63, 3, v62
  v_bfe_u32 v63, v7, 3, 1
  v_lshl_or_b32 v62, v63, 2, v62
  v_mul_u32_u24 v63, 0x500, v62
  v_add_u32 v60, v63, v8
  v_add_u32 v6, s14, v1
  v_add_u32 v6, 0x100, v6
  v_mul_u32_u24 v7, 0xcd, v6
  v_lshrrev_b32 v7, 11, v7
  v_mul_u32_u24 v63, 10, v7
  v_sub_u32 v8, v6, v63
  v_lshlrev_b32 v8, 4, v8
  v_and_b32 v62, 0xfff3, v7
  v_bfe_u32 v63, v7, 2, 1
  v_lshl_or_b32 v62, v63, 3, v62
  v_bfe_u32 v63, v7, 3, 1
  v_lshl_or_b32 v62, v63, 2, v62
  v_mul_u32_u24 v63, 0x500, v62
  v_add_u32 v61, v63, v8
  s_lshl_b32 s13, s4, 1
  s_add_u32 s13, s13, s53
  s_lshl_b32 s17, s6, 5
  s_add_u32 s13, s13, s17
  s_cmp_ge_u32 s13, 37
  s_cselect_b32 s14, 1, 0
  s_mul_i32 s17, s14, 37
  s_sub_u32 s15, s13, s17
  s_cmp_lt_u32 s15, 27
  s_cselect_b32 s44, s32, s36
  s_cselect_b32 s45, s33, s37
  s_cselect_b32 s46, s34, s38
  s_mov_b32 s47, 0x20000
  s_mul_i32 s16, s14, 0x360
  s_mul_i32 s17, s14, 0x140
  s_sub_u32 s17, s17, 0x360
  s_cmp_lt_u32 s15, 27
  s_cselect_b32 s16, s16, s17
  s_lshl_b32 s17, s15, 5
  s_add_u32 s16, s16, s17
  s_mul_i32 s16, s16, 0x500
  s_mul_i32 s17, s52, 0xa0
  s_add_u32 s16, s16, s17
  s_cmp_lt_u32 s13, 0x4a
  s_cselect_b32 s16, s16, 0x40000000
  buffer_load_dwordx4 v[62:65], v57, s[44:47], s16 offen
  buffer_load_dwordx4 v[66:69], v58, s[44:47], s16 offen
  buffer_load_dwordx4 v[70:73], v59, s[44:47], s16 offen
  buffer_load_dwordx4 v[74:77], v60, s[44:47], s16 offen
  buffer_load_dwordx4 v[78:81], v61, s[44:47], s16 offen
  s_mul_i32 s16, s52, 0x4a
  s_add_u32 s16, s16, s13
  s_mul_i32 s16, s16, 0x1400
  s_add_u32 s16, s16, 0xfee000
  s_cmp_lt_u32 s13, 0x4a
  s_cselect_b32 s16, s16, 0x40000000
  s_add_u32 s17, s16, 0x1000
  s_waitcnt vmcnt(4)
  buffer_store_dwordx4 v[62:65], v5, s[20:23], s16 offen offset:0 sc1
  s_waitcnt vmcnt(4)
  buffer_store_dwordx4 v[66:69], v5, s[20:23], s16 offen offset:1024 sc1
  s_waitcnt vmcnt(4)
  buffer_store_dwordx4 v[70:73], v5, s[20:23], s16 offen offset:2048 sc1
  s_waitcnt vmcnt(4)
  buffer_store_dwordx4 v[74:77], v5, s[20:23], s16 offen offset:3072 sc1
  s_waitcnt vmcnt(4)
  buffer_store_dwordx4 v[78:81], v5, s[20:23], s17 offen sc1
  s_nop 1
  s_waitcnt lgkmcnt(0)
  s_nop 7
  s_branch L_ele_8
L_elb_7:
  s_waitcnt vmcnt(25)
  v_readfirstlane_b32 s7, v10
  s_mov_b32 s13, 0x40000
L_fl_14:
  s_nop 2
  s_cmp_lg_u32 s7, 0
  s_cbranch_scc1 L_fd_15
  buffer_load_dword v10, off, s[48:51], 0 sc1
  s_waitcnt vmcnt(0)
  v_readfirstlane_b32 s7, v10
  s_sub_u32 s13, s13, 1
  s_cmp_lg_u32 s13, 0
  s_cbranch_scc1 L_fl_14
L_fd_15:
L_fs_13:
  s_mov_b32 s13, 0
  s_lshl_b32 s14, s13, 6
  v_add_u32 v6, s14, v1
  v_mul_u32_u24 v7, 0xcd, v6
  v_lshrrev_b32 v7, 11, v7
  v_mul_u32_u24 v63, 10, v7
  v_sub_u32 v8, v6, v63
  v_lshlrev_b32 v8, 4, v8
  v_and_b32 v62, 0xfff3, v7
  v_bfe_u32 v63, v7, 2, 1
  v_lshl_or_b32 v62, v63, 3, v62
  v_bfe_u32 v63, v7, 3, 1
  v_lshl_or_b32 v62, v63, 2, v62
  v_mul_u32_u24 v63, 0x500, v62
  v_add_u32 v57, v63, v8
  v_add_u32 v6, s14, v1
  v_add_u32 v6, 64, v6
  v_mul_u32_u24 v7, 0xcd, v6
  v_lshrrev_b32 v7, 11, v7
  v_mul_u32_u24 v63, 10, v7
  v_sub_u32 v8, v6, v63
  v_lshlrev_b32 v8, 4, v8
  v_and_b32 v62, 0xfff3, v7
  v_bfe_u32 v63, v7, 2, 1
  v_lshl_or_b32 v62, v63, 3, v62
  v_bfe_u32 v63, v7, 3, 1
  v_lshl_or_b32 v62, v63, 2, v62
  v_mul_u32_u24 v63, 0x500, v62
  v_add_u32 v58, v63, v8
  v_add_u32 v6, s14, v1
  v_add_u32 v6, 0x80, v6
  v_mul_u32_u24 v7, 0xcd, v6
  v_lshrrev_b32 v7, 11, v7
  v_mul_u32_u24 v63, 10, v7
  v_sub_u32 v8, v6, v63
  v_lshlrev_b32 v8, 4, v8
  v_and_b32 v62, 0xfff3, v7
  v_bfe_u32 v63, v7, 2, 1
  v_lshl_or_b32 v62, v63, 3, v62
  v_bfe_u32 v63, v7, 3, 1
  v_lshl_or_b32 v62, v63, 2, v62
  v_mul_u32_u24 v63, 0x500, v62
  v_add_u32 v59, v63, v8
  v_add_u32 v6, s14, v1
  v_add_u32 v6, 0xc0, v6
  v_mul_u32_u24 v7, 0xcd, v6
  v_lshrrev_b32 v7, 11, v7
  v_mul_u32_u24 v63, 10, v7
  v_sub_u32 v8, v6, v63
  v_lshlrev_b32 v8, 4, v8
  v_and_b32 v62, 0xfff3, v7
  v_bfe_u32 v63, v7, 2, 1
  v_lshl_or_b32 v62, v63, 3, v62
  v_bfe_u32 v63, v7, 3, 1
  v_lshl_or_b32 v62, v63, 2, v62
  v_mul_u32_u24 v63, 0x500, v62
  v_add_u32 v60, v63, v8
  v_add_u32 v6, s14, v1
  v_add_u32 v6, 0x100, v6
  v_mul_u32_u24 v7, 0xcd, v6
  v_lshrrev_b32 v7, 11, v7
  v_mul_u32_u24 v63, 10, v7
  v_sub_u32 v8, v6, v63
  v_lshlrev_b32 v8, 4, v8
  v_and_b32 v62, 0xfff3, v7
  v_bfe_u32 v63, v7, 2, 1
  v_lshl_or_b32 v62, v63, 3, v62
  v_bfe_u32 v63, v7, 3, 1
  v_lshl_or_b32 v62, v63, 2, v62
  v_mul_u32_u24 v63, 0x500, v62
  v_add_u32 v61, v63, v8
  s_lshl_b32 s13, s4, 1
  s_add_u32 s13, s13, s53
  s_lshl_b32 s17, s6, 5
  s_add_u32 s13, s13, s17
  s_cmp_ge_u32 s13, 37
  s_cselect_b32 s14, 1, 0
  s_mul_i32 s17, s14, 37
  s_sub_u32 s15, s13, s17
  s_cmp_lt_u32 s15, 27
  s_cselect_b32 s44, s32, s36
  s_cselect_b32 s45, s33, s37
  s_cselect_b32 s46, s34, s38
  s_mov_b32 s47, 0x20000
  s_mul_i32 s16, s14, 0x360
  s_mul_i32 s17, s14, 0x140
  s_sub_u32 s17, s17, 0x360
  s_cmp_lt_u32 s15, 27
  s_cselect_b32 s16, s16, s17
  s_lshl_b32 s17, s15, 5
  s_add_u32 s16, s16, s17
  s_mul_i32 s16, s16, 0x500
  s_mul_i32 s17, s52, 0xa0
  s_add_u32 s16, s16, s17
  s_cmp_lt_u32 s13, 0x4a
  s_cselect_b32 s16, s16, 0x40000000
  buffer_load_dwordx4 v[62:65], v57, s[44:47], s16 offen
  buffer_load_dwordx4 v[66:69], v58, s[44:47], s16 offen
  buffer_load_dwordx4 v[70:73], v59, s[44:47], s16 offen
  buffer_load_dwordx4 v[74:77], v60, s[44:47], s16 offen
  buffer_load_dwordx4 v[78:81], v61, s[44:47], s16 offen
  s_mul_i32 s16, s52, 0x4a
  s_add_u32 s16, s16, s13
  s_mul_i32 s16, s16, 0x1400
  s_add_u32 s16, s16, 0xfee000
  s_cmp_lt_u32 s13, 0x4a
  s_cselect_b32 s16, s16, 0x40000000
  s_add_u32 s17, s16, 0x1000
  s_waitcnt vmcnt(4)
  buffer_store_dwordx4 v[62:65], v5, s[20:23], s16 offen offset:0 sc1
  s_waitcnt vmcnt(4)
  buffer_store_dwordx4 v[66:69], v5, s[20:23], s16 offen offset:1024 sc1
  s_waitcnt vmcnt(4)
  buffer_store_dwordx4 v[70:73], v5, s[20:23], s16 offen offset:2048 sc1
  s_waitcnt vmcnt(4)
  buffer_store_dwordx4 v[74:77], v5, s[20:23], s16 offen offset:3072 sc1
  s_waitcnt vmcnt(4)
  buffer_store_dwordx4 v[78:81], v5, s[20:23], s17 offen sc1
  s_nop 1
  s_waitcnt lgkmcnt(0)
  s_nop 7
L_ele_8:
  s_lshl_b32 s13, s6, 6
  v_add_u32 v6, s13, v1
  v_mul_u32_u24 v7, 0x925, v6
  v_lshrrev_b32 v7, 15, v7
  v_mul_u32_u24 v65, 14, v7
  v_sub_u32 v8, v6, v65
  v_lshlrev_b32 v8, 4, v8
  v_and_b32 v64, 0xfff3, v7
  v_bfe_u32 v65, v7, 2, 1
  v_lshl_or_b32 v64, v65, 3, v64
  v_bfe_u32 v65, v7, 3, 1
  v_lshl_or_b32 v64, v65, 2, v64
  v_mul_u32_u24 v65, 0xd80, v64
  v_add_u32 v57, v65, v8
  v_add_u32 v6, s13, v1
  v_add_u32 v6, 0x100, v6
  v_mul_u32_u24 v7, 0x925, v6
  v_lshrrev_b32 v7, 15, v7
  v_mul_u32_u24 v65, 14, v7
  v_sub_u32 v8, v6, v65
  v_lshlrev_b32 v8, 4, v8
  v_and_b32 v64, 0xfff3, v7
  v_bfe_u32 v65, v7, 2, 1
  v_lshl_or_b32 v64, v65, 3, v64
  v_bfe_u32 v65, v7, 3, 1
  v_lshl_or_b32 v64, v65, 2, v64
  v_mul_u32_u24 v65, 0xd80, v64
  v_add_u32 v58, v65, v8
  v_add_u32 v6, s13, v1
  v_add_u32 v6, 0x200, v6
  v_mul_u32_u24 v7, 0x925, v6
  v_lshrrev_b32 v7, 15, v7
  v_mul_u32_u24 v65, 14, v7
  v_sub_u32 v8, v6, v65
  v_lshlrev_b32 v8, 4, v8
  v_and_b32 v64, 0xfff3, v7
  v_bfe_u32 v65, v7, 2, 1
  v_lshl_or_b32 v64, v65, 3, v64
  v_bfe_u32 v65, v7, 3, 1
  v_lshl_or_b32 v64, v65, 2, v64
  v_mul_u32_u24 v65, 0xd80, v64
  v_add_u32 v59, v65, v8
  v_add_u32 v6, s13, v1
  v_add_u32 v6, 0x300, v6
  v_mul_u32_u24 v7, 0x925, v6
  v_lshrrev_b32 v7, 15, v7
  v_mul_u32_u24 v65, 14, v7
  v_sub_u32 v8, v6, v65
  v_lshlrev_b32 v8, 4, v8
  v_and_b32 v64, 0xfff3, v7
  v_bfe_u32 v65, v7, 2, 1
  v_lshl_or_b32 v64, v65, 3, v64
  v_bfe_u32 v65, v7, 3, 1
  v_lshl_or_b32 v64, v65, 2, v64
  v_mul_u32_u24 v65, 0xd80, v64
  v_add_u32 v60, v65, v8
  v_add_u32 v6, s13, v1
  v_add_u32 v6, 0x400, v6
  v_mul_u32_u24 v7, 0x925, v6
  v_lshrrev_b32 v7, 15, v7
  v_mul_u32_u24 v65, 14, v7
  v_sub_u32 v8, v6, v65
  v_lshlrev_b32 v8, 4, v8
  v_and_b32 v64, 0xfff3, v7
  v_bfe_u32 v65, v7, 2, 1
  v_lshl_or_b32 v64, v65, 3, v64
  v_bfe_u32 v65, v7, 3, 1
  v_lshl_or_b32 v64, v65, 2, v64
  v_mul_u32_u24 v65, 0xd80, v64
  v_add_u32 v61, v65, v8
  v_add_u32 v6, s13, v1
  v_add_u32 v6, 0x500, v6
  v_mul_u32_u24 v7, 0x925, v6
  v_lshrrev_b32 v7, 15, v7
  v_mul_u32_u24 v65, 14, v7
  v_sub_u32 v8, v6, v65
  v_lshlrev_b32 v8, 4, v8
  v_and_b32 v64, 0xfff3, v7
  v_bfe_u32 v65, v7, 2, 1
  v_lshl_or_b32 v64, v65, 3, v64
  v_bfe_u32 v65, v7, 3, 1
  v_lshl_or_b32 v64, v65, 2, v64
  v_mul_u32_u24 v65, 0xd80, v64
  v_add_u32 v62, v65, v8
  v_add_u32 v6, s13, v1
  v_add_u32 v6, 0x600, v6
  v_mul_u32_u24 v7, 0x925, v6
  v_lshrrev_b32 v7, 15, v7
  v_mul_u32_u24 v65, 14, v7
  v_sub_u32 v8, v6, v65
  v_lshlrev_b32 v8, 4, v8
  v_and_b32 v64, 0xfff3, v7
  v_bfe_u32 v65, v7, 2, 1
  v_lshl_or_b32 v64, v65, 3, v64
  v_bfe_u32 v65, v7, 3, 1
  v_lshl_or_b32 v64, v65, 2, v64
  v_mul_u32_u24 v65, 0xd80, v64
  v_add_u32 v63, v65, v8
  s_mul_i32 s13, s5, 7
  s_min_u32 s13, s13, 0x65
  s_lshl_b32 s14, s13, 5
  s_add_u32 s15, s14, 0x6c000
  s_add_u32 s16, s14, 0xd8000
  s_add_u32 s17, s14, 0x144000
  s_add_u32 s18, s14, 0x1b0000
  s_cmp_lg_u32 s6, 0
  s_cbranch_scc1 L_ps_16
  s_add_u32 s40, s4, 1
  s_min_u32 s40, s40, 15
  s_sub_u32 s42, s4, 1
  s_max_i32 s42, s42, 0
  s_cmp_eq_u32 s53, 0
  s_cselect_b32 s40, s42, s40
  s_lshl_b32 s40, s40, 6
  s_lshl_b32 s42, s4, 6
  v_mov_b32 v6, s42
  v_mov_b32 v8, s40
  v_cmp_eq_u32 vcc, 1, v3
  s_nop 1
  v_cndmask_b32 v6, v6, v8, vcc
  v_and_b32 v8, 7, v2
  v_lshl_add_u32 v6, v8, 2, v6
  s_mov_b32 s13, 0x1000
  s_mov_b32 s19, 0x40000
L_pl_17:
  buffer_load_dword v7, v6, s[20:23], s13 offen sc1
  s_waitcnt vmcnt(0)
  v_cmp_ne_u32 vcc, s7, v7
  s_sub_u32 s19, s19, 1
  s_nop 2
  s_cbranch_vccz L_pd_18
  s_cmp_lg_u32 s19, 0
  s_cbranch_scc1 L_pl_17
L_pd_18:
L_ps_16:
  s_waitcnt vmcnt(0)
  s_barrier
  s_cmp_lg_u32 s6, 0
  s_cbranch_scc1 L_nf_19
  s_lshl_b32 s13, s52, 7
  s_lshl_b32 s19, s4, 1
  s_add_u32 s19, s19, s53
  s_lshl_b32 s19, s19, 2
  s_add_u32 s13, s13, s19
  s_add_u32 s13, s13, 0x2800
  v_mov_b32 v6, s7
  s_mov_b64 exec, 1
  buffer_store_dword v6, off, s[20:23], s13 sc1
  s_mov_b64 exec, -1
  s_nop 1
L_nf_19:
  s_barrier
  s_add_u32 m0, s54, 0x19000
  s_nop 0
  buffer_load_dwordx4 v61, s[28:31], s17 offen lds
  s_add_u32 m0, s54, 0x1a000
  s_nop 0
  buffer_load_dwordx4 v62, s[28:31], s17 offen lds
  s_add_u32 m0, s54, 0x1b000
  s_nop 0
  buffer_load_dwordx4 v63, s[28:31], s17 offen lds
  s_add_u32 m0, s54, 0x1c000
  s_nop 0
  buffer_load_dwordx4 v57, s[28:31], s18 offen lds
  s_add_u32 m0, s54, 0x1d000
  s_nop 0
  buffer_load_dwordx4 v58, s[28:31], s18 offen lds
  s_add_u32 m0, s54, 0x1e000
  s_nop 0
  buffer_load_dwordx4 v59, s[28:31], s18 offen lds
  s_barrier
  s_nop 7
  s_cmp_lg_u32 s53, 0
  s_cbranch_scc1 L_qlb_22
  s_add_u32 m0, s54, 0
  s_nop 0
  buffer_load_dwordx4 v57, s[28:31], s14 offen lds
  s_add_u32 m0, s54, 0x1000
  s_nop 0
  buffer_load_dwordx4 v58, s[28:31], s14 offen lds
  s_add_u32 m0, s54, 0x2000
  s_nop 0
  buffer_load_dwordx4 v59, s[28:31], s14 offen lds
  s_add_u32 m0, s54, 0x3000
  s_nop 0
  buffer_load_dwordx4 v60, s[28:31], s14 offen lds
  s_add_u32 m0, s54, 0x4000
  s_nop 0
  buffer_load_dwordx4 v61, s[28:31], s14 offen lds
  s_add_u32 m0, s54, 0x5000
  s_nop 0
  buffer_load_dwordx4 v62, s[28:31], s14 offen lds
  s_add_u32 m0, s54, 0x6000
  s_nop 0
  buffer_load_dwordx4 v63, s[28:31], s14 offen lds
  s_add_u32 m0, s54, 0x7000
  s_nop 0
  buffer_load_dwordx4 v57, s[28:31], s15 offen lds
  s_add_u32 m0, s54, 0x8000
  s_nop 0
  buffer_load_dwordx4 v58, s[28:31], s15 offen lds
  s_add_u32 m0, s54, 0x9000
  s_nop 0
  buffer_load_dwordx4 v59, s[28:31], s15 offen lds
  s_barrier
  s_cmp_lg_u32 s6, 0
  s_cbranch_scc1 L_nf_24
  s_lshl_b32 s13, s4, 6
  s_lshl_b32 s19, s5, 2
  s_add_u32 s13, s13, s19
  s_add_u32 s13, s13, 0x1800
  v_mov_b32 v6, s7
  s_mov_b64 exec, 1
  buffer_store_dword v6, off, s[20:23], s13 sc1
  s_mov_b64 exec, -1
  s_nop 1
L_nf_24:
  s_add_u32 m0, s54, 0xa000
  s_nop 0
  buffer_load_dwordx4 v60, s[28:31], s15 offen lds
  s_add_u32 m0, s54, 0xb000
  s_nop 0
  buffer_load_dwordx4 v61, s[28:31], s15 offen lds
  s_add_u32 m0, s54, 0xc000
  s_nop 0
  buffer_load_dwordx4 v62, s[28:31], s15 offen lds
  s_add_u32 m0, s54, 0xd000
  s_nop 0
  buffer_load_dwordx4 v63, s[28:31], s15 offen lds
  s_add_u32 m0, s54, 0xe000
  s_nop 0
  buffer_load_dwordx4 v57, s[28:31], s16 offen lds
  s_add_u32 m0, s54, 0xf000
  s_nop 0
  buffer_load_dwordx4 v58, s[28:31], s16 offen lds
  s_add_u32 m0, s54, 0x10000
  s_nop 0
  buffer_load_dwordx4 v59, s[28:31], s16 offen lds
  s_add_u32 m0, s54, 0x11000
  s_nop 0
  buffer_load_dwordx4 v60, s[28:31], s16 offen lds
  s_add_u32 m0, s54, 0x12000
  s_nop 0
  buffer_load_dwordx4 v61, s[28:31], s16 offen lds
  s_add_u32 m0, s54, 0x13000
  s_nop 0
  buffer_load_dwordx4 v62, s[28:31], s16 offen lds
  s_add_u32 m0, s54, 0x14000
  s_nop 0
  buffer_load_dwordx4 v63, s[28:31], s16 offen lds
  s_add_u32 m0, s54, 0x15000
  s_nop 0
  buffer_load_dwordx4 v57, s[28:31], s17 offen lds
  s_add_u32 m0, s54, 0x16000
  s_nop 0
  buffer_load_dwordx4 v58, s[28:31], s17 offen lds
  s_add_u32 m0, s54, 0x17000
  s_nop 0
  buffer_load_dwordx4 v59, s[28:31], s17 offen lds
  s_add_u32 m0, s54, 0x18000
  s_nop 0
  buffer_load_dwordx4 v60, s[28:31], s17 offen lds
  s_waitcnt lgkmcnt(0)
  s_nop 7
  s_branch L_qle_23
L_qlb_22:
  s_add_u32 m0, s54, 0
  s_nop 0
  buffer_load_dwordx4 v57, s[28:31], s14 offen lds
  s_add_u32 m0, s54, 0x1000
  s_nop 0
  buffer_load_dwordx4 v58, s[28:31], s14 offen lds
  s_add_u32 m0, s54, 0x2000
  s_nop 0
  buffer_load_dwordx4 v59, s[28:31], s14 offen lds
  s_add_u32 m0, s54, 0x3000
  s_nop 0
  buffer_load_dwordx4 v60, s[28:31], s14 offen lds
  s_add_u32 m0, s54, 0x4000
  s_nop 0
  buffer_load_dwordx4 v61, s[28:31], s14 offen lds
  s_add_u32 m0, s54, 0x5000
  s_nop 0
  buffer_load_dwordx4 v62, s[28:31], s14 offen lds
  s_add_u32 m0, s54, 0x6000
  s_nop 0
  buffer_load_dwordx4 v63, s[28:31], s14 offen lds
  s_add_u32 m0, s54, 0x7000
  s_nop 0
  buffer_load_dwordx4 v57, s[28:31], s15 offen lds
  s_add_u32 m0, s54, 0x8000
  s_nop 0
  buffer_load_dwordx4 v58, s[28:31], s15 offen lds
  s_add_u32 m0, s54, 0x9000
  s_nop 0
  buffer_load_dwordx4 v59, s[28:31], s15 offen lds
  s_barrier
  s_cmp_lg_u32 s6, 0
  s_cbranch_scc1 L_nf_25
  s_lshl_b32 s13, s4, 6
  s_lshl_b32 s19, s5, 2
  s_add_u32 s13, s13, s19
  s_add_u32 s13, s13, 0x1800
  v_mov_b32 v6, s7
  s_mov_b64 exec, 1
  buffer_store_dword v6, off, s[20:23], s13 sc1
  s_mov_b64 exec, -1
  s_nop 1
L_nf_25:
  s_add_u32 m0, s54, 0xa000
  s_nop 0
  buffer_load_dwordx4 v60, s[28:31], s15 offen lds
  s_add_u32 m0, s54, 0xb000
  s_nop 0
  buffer_load_dwordx4 v61, s[28:31], s15 offen lds
  s_add_u32 m0, s54, 0xc000
  s_nop 0
  buffer_load_dwordx4 v62, s[28:31], s15 offen lds
  s_add_u32 m0, s54, 0xd000
  s_nop 0
  buffer_load_dwordx4 v63, s[28:31], s15 offen lds
  s_barrier
  s_add_u32 m0, s54, 0xe000
  s_nop 0
  buffer_load_dwordx4 v57, s[28:31], s16 offen lds
  s_add_u32 m0, s54, 0xf000
  s_nop 0
  buffer_load_dwordx4 v58, s[28:31], s16 offen lds
  s_add_u32 m0, s54, 0x10000
  s_nop 0
  buffer_load_dwordx4 v59, s[28:31], s16 offen lds
  s_add_u32 m0, s54, 0x11000
  s_nop 0
  buffer_load_dwordx4 v60, s[28:31], s16 offen lds
  s_barrier
  s_add_u32 m0, s54, 0x12000
  s_nop 0
  buffer_load_dwordx4 v61, s[28:31], s16 offen lds
  s_add_u32 m0, s54, 0x13000
  s_nop 0
  buffer_load_dwordx4 v62, s[28:31], s16 offen lds
  s_add_u32 m0, s54, 0x14000
  s_nop 0
  buffer_load_dwordx4 v63, s[28:31], s16 offen lds
  s_add_u32 m0, s54, 0x15000
  s_nop 0
  buffer_load_dwordx4 v57, s[28:31], s17 offen lds
  s_barrier
  s_add_u32 m0, s54, 0x16000
  s_nop 0
  buffer_load_dwordx4 v58, s[28:31], s17 offen lds
  s_add_u32 m0, s54, 0x17000
  s_nop 0
  buffer_load_dwordx4 v59, s[28:31], s17 offen lds
  s_add_u32 m0, s54, 0x18000
  s_nop 0
  buffer_load_dwordx4 v60, s[28:31], s17 offen lds
  s_barrier
  s_waitcnt lgkmcnt(0)
  s_nop 7
L_qle_23:
  s_and_b32 s13, s6, 1
  s_lshr_b32 s19, s6, 1
  s_mul_i32 s43, s19, 0x2800
  s_lshl_b32 s40, s13, 10
  s_add_u32 s43, s43, s40
  s_mul_i32 s44, s52, 0x4a
  s_mul_i32 s42, s19, 37
  s_add_u32 s44, s44, s42
  s_mul_i32 s44, s44, 0x1400
  s_add_u32 s44, s44, s40
  s_add_u32 s44, s44, 0xfee000
  v_lshrrev_b32 v6, 1, v3
  v_lshlrev_b32 v6, 4, v6
  v_and_b32 v7, 1, v3
  v_lshl_add_u32 v6, v7, 2, v6
  v_bfe_u32 v7, v1, 2, 2
  v_add_u32 v6, v6, v7
  v_mul_u32_u24 v6, 0xe0, v6
  v_and_b32 v7, 3, v1
  v_lshl_add_u32 v6, v7, 3, v6
  s_lshl_b32 s13, s6, 5
  v_add_u32 v6, s13, v6
  v_add_u32 v7, 0xe000, v6
  v_add_u32 v8, 0x1c000, v6
  v_mov_b32 v64, 0x3f803f80
  v_mov_b32 v65, 0x3f803f80
  v_mov_b32 v66, 0x3f803f80
  v_mov_b32 v67, 0x3f803f80
  s_add_u32 m0, s54, 0x1f000
  s_nop 0
  buffer_load_dwordx4 v60, s[28:31], s18 offen lds
  s_add_u32 m0, s54, 0x20000
  s_nop 0
  buffer_load_dwordx4 v61, s[28:31], s18 offen lds
  s_add_u32 m0, s54, 0x21000
  s_nop 0
  buffer_load_dwordx4 v62, s[28:31], s18 offen lds
  s_add_u32 m0, s54, 0x22000
  s_nop 0
  buffer_load_dwordx4 v63, s[28:31], s18 offen lds
  s_cmp_lg_u32 s6, 0
  s_cbranch_scc1 L_ps_26
  v_lshlrev_b32 v108, 2, v2
  s_lshl_b32 s13, s4, 6
  s_add_u32 s13, s13, 0x1800
  s_mov_b32 s19, 0x40000
L_pl_27:
  buffer_load_dword v109, v108, s[20:23], s13 offen sc1
  s_waitcnt vmcnt(0)
  v_cmp_ne_u32 vcc, s7, v109
  s_sub_u32 s19, s19, 1
  s_nop 2
  s_cbranch_vccz L_pd_28
  s_cmp_lg_u32 s19, 0
  s_cbranch_scc1 L_pl_27
L_pd_28:
L_ps_26:
  s_waitcnt vmcnt(0)
  s_barrier
  s_cmp_eq_u32 s53, 0
  s_cbranch_scc1 L_ko_29
  s_cmp_lg_u32 s6, 0
  s_cbranch_scc1 L_nf_30
  s_lshl_b32 s13, s52, 6
  s_lshl_b32 s19, s4, 2
  s_add_u32 s13, s13, s19
  s_add_u32 s13, s13, 0x1400
  v_mov_b32 v108, s7
  s_mov_b64 exec, 1
  buffer_store_dword v108, off, s[20:23], s13 sc1
  s_mov_b64 exec, -1
  s_nop 1
L_nf_30:
L_ko_29:
  s_setprio 2
  ds_read_b64_tr_b16 v[68:69], v6 offset:0
  ds_read_b64_tr_b16 v[70:71], v6 offset:1792
  ds_read_b64_tr_b16 v[72:73], v6 offset:128
  ds_read_b64_tr_b16 v[74:75], v6 offset:1920
  ds_read_b64_tr_b16 v[76:77], v6 offset:7168
  ds_read_b64_tr_b16 v[78:79], v6 offset:8960
  ds_read_b64_tr_b16 v[80:81], v6 offset:7296
  ds_read_b64_tr_b16 v[82:83], v6 offset:9088
  ds_read_b64_tr_b16 v[84:85], v6 offset:14336
  ds_read_b64_tr_b16 v[86:87], v6 offset:16128
  ds_read_b64_tr_b16 v[88:89], v6 offset:14464
  ds_read_b64_tr_b16 v[90:91], v6 offset:16256
  ds_read_b64_tr_b16 v[92:93], v6 offset:21504
  ds_read_b64_tr_b16 v[94:95], v6 offset:23296
  ds_read_b64_tr_b16 v[96:97], v6 offset:21632
  ds_read_b64_tr_b16 v[98:99], v6 offset:23424
  s_waitcnt lgkmcnt(14)
  v_mfma_f32_16x16x32_bf16 v[100:103], v[64:67], v[68:71], 0
  s_waitcnt lgkmcnt(12)
  v_mfma_f32_16x16x32_bf16 v[104:107], v[64:67], v[72:75], 0
  s_waitcnt lgkmcnt(10)
  v_mfma_f32_16x16x32_bf16 v[100:103], v[64:67], v[76:79], v[100:103]
  s_waitcnt lgkmcnt(8)
  v_mfma_f32_16x16x32_bf16 v[104:107], v[64:67], v[80:83], v[104:107]
  s_waitcnt lgkmcnt(6)
  v_mfma_f32_16x16x32_bf16 v[100:103], v[64:67], v[84:87], v[100:103]
  s_waitcnt lgkmcnt(4)
  v_mfma_f32_16x16x32_bf16 v[104:107], v[64:67], v[88:91], v[104:107]
  s_waitcnt lgkmcnt(2)
  v_mfma_f32_16x16x32_bf16 v[100:103], v[64:67], v[92:95], v[100:103]
  s_waitcnt lgkmcnt(0)
  v_mfma_f32_16x16x32_bf16 v[104:107], v[64:67], v[96:99], v[104:107]
  s_waitcnt lgkmcnt(0)
  ds_read_b64_tr_b16 v[68:69], v6 offset:28672
  ds_read_b64_tr_b16 v[70:71], v6 offset:30464
  ds_read_b64_tr_b16 v[72:73], v6 offset:28800
  ds_read_b64_tr_b16 v[74:75], v6 offset:30592
  ds_read_b64_tr_b16 v[76:77], v6 offset:35840
  ds_read_b64_tr_b16 v[78:79], v6 offset:37632
  ds_read_b64_tr_b16 v[80:81], v6 offset:35968
  ds_read_b64_tr_b16 v[82:83], v6 offset:37760
  ds_read_b64_tr_b16 v[84:85], v6 offset:43008
  ds_read_b64_tr_b16 v[86:87], v6 offset:44800
  ds_read_b64_tr_b16 v[88:89], v6 offset:43136
  ds_read_b64_tr_b16 v[90:91], v6 offset:44928
  ds_read_b64_tr_b16 v[92:93], v6 offset:50176
  ds_read_b64_tr_b16 v[94:95], v6 offset:51968
  ds_read_b64_tr_b16 v[96:97], v6 offset:50304
  ds_read_b64_tr_b16 v[98:99], v6 offset:52096
  s_waitcnt lgkmcnt(14)
  v_mfma_f32_16x16x32_bf16 v[100:103], v[64:67], v[68:71], v[100:103]
  s_waitcnt lgkmcnt(12)
  v_mfma_f32_16x16x32_bf16 v[104:107], v[64:67], v[72:75], v[104:107]
  s_waitcnt lgkmcnt(10)
  v_mfma_f32_16x16x32_bf16 v[100:103], v[64:67], v[76:79], v[100:103]
  s_waitcnt lgkmcnt(8)
  v_mfma_f32_16x16x32_bf16 v[104:107], v[64:67], v[80:83], v[104:107]
  s_waitcnt lgkmcnt(6)
  v_mfma_f32_16x16x32_bf16 v[100:103], v[64:67], v[84:87], v[100:103]
  s_waitcnt lgkmcnt(4)
  v_mfma_f32_16x16x32_bf16 v[104:107], v[64:67], v[88:91], v[104:107]
  s_waitcnt lgkmcnt(2)
  v_mfma_f32_16x16x32_bf16 v[100:103], v[64:67], v[92:95], v[100:103]
  s_waitcnt lgkmcnt(0)
  v_mfma_f32_16x16x32_bf16 v[104:107], v[64:67], v[96:99], v[104:107]
  s_waitcnt lgkmcnt(0)
  s_cmp_lg_u32 s6, 0
  s_cbranch_scc1 L_ps_31
  v_and_b32 v108, 31, v1
  v_lshlrev_b32 v108, 2, v108
  s_lshl_b32 s13, s52, 7
  s_add_u32 s13, s13, 0x2800
  s_mov_b32 s19, 0x40000
L_pl_32:
  buffer_load_dword v109, v108, s[20:23], s13 offen sc1
  s_waitcnt vmcnt(0)
  v_cmp_ne_u32 vcc, s7, v109
  s_sub_u32 s19, s19, 1
  s_nop 2
  s_cbranch_vccz L_pd_33
  s_cmp_lg_u32 s19, 0
  s_cbranch_scc1 L_pl_32
L_pd_33:
L_ps_31:
  s_barrier
  s_add_u32 s45, s44, 0
  s_add_u32 m0, s43, 0
  s_nop 0
  buffer_load_dwordx4 v5, s[20:23], s45 offen offset:0 sc1 lds
  buffer_load_dwordx4 v5, s[20:23], s45 offen offset:2048 sc1 lds
  s_add_u32 s45, s44, 0x1000
  s_add_u32 m0, s43, 0x1000
  s_nop 0
  buffer_load_dwordx4 v5, s[20:23], s45 offen offset:0 sc1 lds
  buffer_load_dwordx4 v5, s[20:23], s45 offen offset:2048 sc1 lds
  s_add_u32 s45, s44, 0x2000
  s_add_u32 m0, s43, 0x2000
  s_nop 0
  buffer_load_dwordx4 v5, s[20:23], s45 offen offset:0 sc1 lds
  ds_read_b64_tr_b16 v[68:69], v7 offset:0
  ds_read_b64_tr_b16 v[70:71], v7 offset:1792
  ds_read_b64_tr_b16 v[72:73], v7 offset:128
  ds_read_b64_tr_b16 v[74:75], v7 offset:1920
  ds_read_b64_tr_b16 v[76:77], v7 offset:7168
  ds_read_b64_tr_b16 v[78:79], v7 offset:8960
  ds_read_b64_tr_b16 v[80:81], v7 offset:7296
  ds_read_b64_tr_b16 v[82:83], v7 offset:9088
  ds_read_b64_tr_b16 v[84:85], v7 offset:14336
  ds_read_b64_tr_b16 v[86:87], v7 offset:16128
  ds_read_b64_tr_b16 v[88:89], v7 offset:14464
  ds_read_b64_tr_b16 v[90:91], v7 offset:16256
  ds_read_b64_tr_b16 v[92:93], v7 offset:21504
  ds_read_b64_tr_b16 v[94:95], v7 offset:23296
  ds_read_b64_tr_b16 v[96:97], v7 offset:21632
  ds_read_b64_tr_b16 v[98:99], v7 offset:23424
  s_waitcnt lgkmcnt(14)
  v_mfma_f32_16x16x32_bf16 v[100:103], v[64:67], v[68:71], v[100:103]
  s_waitcnt lgkmcnt(12)
  v_mfma_f32_16x16x32_bf16 v[104:107], v[64:67], v[72:75], v[104:107]
  s_waitcnt lgkmcnt(10)
  v_mfma_f32_16x16x32_bf16 v[100:103], v[64:67], v[76:79], v[100:103]
  s_waitcnt lgkmcnt(8)
  v_mfma_f32_16x16x32_bf16 v[104:107], v[64:67], v[80:83], v[104:107]
  s_waitcnt lgkmcnt(6)
  v_mfma_f32_16x16x32_bf16 v[100:103], v[64:67], v[84:87], v[100:103]
  s_waitcnt lgkmcnt(4)
  v_mfma_f32_16x16x32_bf16 v[104:107], v[64:67], v[88:91], v[104:107]
  s_waitcnt lgkmcnt(2)
  v_mfma_f32_16x16x32_bf16 v[100:103], v[64:67], v[92:95], v[100:103]
  s_waitcnt lgkmcnt(0)
  v_mfma_f32_16x16x32_bf16 v[104:107], v[64:67], v[96:99], v[104:107]
  s_waitcnt lgkmcnt(0)
  s_barrier
  s_add_u32 s46, s44, 0x2800
  s_add_u32 m0, s43, 0x5000
  s_nop 0
  buffer_load_dwordx4 v5, s[20:23], s46 offen offset:0 sc1 lds
  buffer_load_dwordx4 v5, s[20:23], s46 offen offset:2048 sc1 lds
  s_add_u32 s46, s44, 0x3800
  s_add_u32 m0, s43, 0x6000
  s_nop 0
  buffer_load_dwordx4 v5, s[20:23], s46 offen offset:0 sc1 lds
  buffer_load_dwordx4 v5, s[20:23], s46 offen offset:2048 sc1 lds
  s_add_u32 s46, s44, 0x4800
  s_add_u32 m0, s43, 0x7000
  s_nop 0
  buffer_load_dwordx4 v5, s[20:23], s46 offen offset:0 sc1 lds
  ds_read_b64_tr_b16 v[68:69], v7 offset:28672
  ds_read_b64_tr_b16 v[70:71], v7 offset:30464
  ds_read_b64_tr_b16 v[72:73], v7 offset:28800
  ds_read_b64_tr_b16 v[74:75], v7 offset:30592
  ds_read_b64_tr_b16 v[76:77], v7 offset:35840
  ds_read_b64_tr_b16 v[78:79], v7 offset:37632
  ds_read_b64_tr_b16 v[80:81], v7 offset:35968
  ds_read_b64_tr_b16 v[82:83], v7 offset:37760
  ds_read_b64_tr_b16 v[84:85], v7 offset:43008
  ds_read_b64_tr_b16 v[86:87], v7 offset:44800
  ds_read_b64_tr_b16 v[88:89], v7 offset:43136
  ds_read_b64_tr_b16 v[90:91], v7 offset:44928
  ds_read_b64_tr_b16 v[92:93], v7 offset:50176
  ds_read_b64_tr_b16 v[94:95], v7 offset:51968
  ds_read_b64_tr_b16 v[96:97], v7 offset:50304
  ds_read_b64_tr_b16 v[98:99], v7 offset:52096
  s_waitcnt lgkmcnt(14)
  v_mfma_f32_16x16x32_bf16 v[100:103], v[64:67], v[68:71], v[100:103]
  s_waitcnt lgkmcnt(12)
  v_mfma_f32_16x16x32_bf16 v[104:107], v[64:67], v[72:75], v[104:107]
  s_waitcnt lgkmcnt(10)
  v_mfma_f32_16x16x32_bf16 v[100:103], v[64:67], v[76:79], v[100:103]
  s_waitcnt lgkmcnt(8)
  v_mfma_f32_16x16x32_bf16 v[104:107], v[64:67], v[80:83], v[104:107]
  s_waitcnt lgkmcnt(6)
  v_mfma_f32_16x16x32_bf16 v[100:103], v[64:67], v[84:87], v[100:103]
  s_waitcnt lgkmcnt(4)
  v_mfma_f32_16x16x32_bf16 v[104:107], v[64:67], v[88:91], v[104:107]
  s_waitcnt lgkmcnt(2)
  v_mfma_f32_16x16x32_bf16 v[100:103], v[64:67], v[92:95], v[100:103]
  s_waitcnt lgkmcnt(0)
  v_mfma_f32_16x16x32_bf16 v[104:107], v[64:67], v[96:99], v[104:107]
  s_waitcnt lgkmcnt(0)
  v_mov_b32 v128, 0x40000000
  v_mov_b32 v129, 0x40000000
  s_cmp_eq_u32 s53, 0
  s_cbranch_scc1 L_kl_34
  v_lshlrev_b32 v130, 2, v2
  s_lshl_b32 s13, s52, 6
  s_add_u32 s13, s13, 0x1400
  s_mov_b32 s19, 0x40000
L_pl_36:
  buffer_load_dword v131, v130, s[20:23], s13 offen sc1
  s_waitcnt vmcnt(0)
  v_cmp_ne_u32 vcc, s7, v131
  s_sub_u32 s19, s19, 1
  s_nop 2
  s_cbranch_vccz L_pd_37
  s_cmp_lg_u32 s19, 0
  s_cbranch_scc1 L_pl_36
L_pd_37:
L_ps_35:
  s_lshl_b32 s13, s6, 4
  v_add_u32 v130, s13, v2
  s_mul_i32 s19, s4, 27
  v_add_u32 v131, s19, v130
  v_cmp_gt_u32 s[60:61], 27, v130
  v_cmp_gt_u32 vcc, 0x1a4, v131
  s_nop 3
  s_and_b64 s[60:61], s[60:61], vcc
  v_lshlrev_b32 v129, 4, v131
  v_mul_u32_u24 v130, 0x1a40, v3
  v_add_u32 v128, v130, v129
  v_mov_b32 v130, 0x40000000
  v_cndmask_b32 v128, v130, v128, s[60:61]
  v_lshl_add_u32 v129, v3, 3, v129
  v_cmp_gt_u32 vcc, 2, v3
  s_nop 3
  s_and_b64 s[60:61], s[60:61], vcc
  v_cndmask_b32 v129, v130, v129, s[60:61]
  v_and_b32 v130, 1, v2
  v_lshlrev_b32 v130, 4, v130
  v_mov_b32 v131, 0x3f80
  v_lshlrev_b32 v131, v130, v131
  v_lshrrev_b32 v130, 1, v2
  v_cmp_eq_u32 vcc, 0, v130
  s_nop 1
  v_cndmask_b32 v124, 0, v131, vcc
  v_cmp_eq_u32 vcc, 1, v130
  s_nop 1
  v_cndmask_b32 v125, 0, v131, vcc
  v_cmp_eq_u32 vcc, 2, v130
  s_nop 1
  v_cndmask_b32 v126, 0, v131, vcc
  v_cmp_eq_u32 vcc, 3, v130
  s_nop 1
  v_cndmask_b32 v127, 0, v131, vcc
  s_mul_i32 s13, s52, 0x1a400
  s_add_u32 s13, s13, 0x4000
  buffer_load_dwordx4 v[108:111], v128, s[20:23], s13 offen sc1
  s_add_u32 s13, s13, 0x6900
  buffer_load_dwordx4 v[112:115], v128, s[20:23], s13 offen sc1
  s_add_u32 s13, s13, 0x6900
  buffer_load_dwordx4 v[116:119], v128, s[20:23], s13 offen sc1
  s_add_u32 s13, s13, 0x6900
  buffer_load_dwordx4 v[120:123], v128, s[20:23], s13 offen sc1
L_kl_34:
  s_barrier
  s_cmp_eq_u32 s53, 0
  s_cbranch_scc1 L_kl_38
  s_waitcnt vmcnt(0)
  v_mfma_f32_16x16x32_bf16 v[130:133], v[124:127], v[108:111], 0
  v_mfma_f32_16x16x32_bf16 v[130:133], v[124:127], v[112:115], v[130:133]
  v_mfma_f32_16x16x32_bf16 v[130:133], v[124:127], v[116:119], v[130:133]
  v_mfma_f32_16x16x32_bf16 v[130:133], v[124:127], v[120:123], v[130:133]
  s_nop 7
  v_cvt_pk_bf16_f32 v134, v130, v131
  v_cvt_pk_bf16_f32 v135, v132, v133
  s_mul_i32 s13, s52, 0x1b00
  s_add_u32 s13, s13, 0xe0000
  buffer_store_dwordx2 v[134:135], v129, s[20:23], s13 offen sc1
  s_nop 1
L_kl_38:
  s_add_u32 s45, s44, 0x5000
  s_add_u32 m0, s43, 0xa000
  s_nop 0
  buffer_load_dwordx4 v5, s[20:23], s45 offen offset:0 sc1 lds
  buffer_load_dwordx4 v5, s[20:23], s45 offen offset:2048 sc1 lds
  s_add_u32 s45, s44, 0x6000
  s_add_u32 m0, s43, 0xb000
  s_nop 0
  buffer_load_dwordx4 v5, s[20:23], s45 offen offset:0 sc1 lds
  buffer_load_dwordx4 v5, s[20:23], s45 offen offset:2048 sc1 lds
  s_add_u32 s45, s44, 0x7000
  s_add_u32 m0, s43, 0xc000
  s_nop 0
  buffer_load_dwordx4 v5, s[20:23], s45 offen offset:0 sc1 lds
  ds_read_b64_tr_b16 v[68:69], v8 offset:0
  ds_read_b64_tr_b16 v[70:71], v8 offset:1792
  ds_read_b64_tr_b16 v[72:73], v8 offset:128
  ds_read_b64_tr_b16 v[74:75], v8 offset:1920
  ds_read_b64_tr_b16 v[76:77], v8 offset:7168
  ds_read_b64_tr_b16 v[78:79], v8 offset:8960
  ds_read_b64_tr_b16 v[80:81], v8 offset:7296
  ds_read_b64_tr_b16 v[82:83], v8 offset:9088
  ds_read_b64_tr_b16 v[84:85], v8 offset:14336
  ds_read_b64_tr_b16 v[86:87], v8 offset:16128
  ds_read_b64_tr_b16 v[88:89], v8 offset:14464
  ds_read_b64_tr_b16 v[90:91], v8 offset:16256
  ds_read_b64_tr_b16 v[92:93], v8 offset:21504
  ds_read_b64_tr_b16 v[94:95], v8 offset:23296
  ds_read_b64_tr_b16 v[96:97], v8 offset:21632
  ds_read_b64_tr_b16 v[98:99], v8 offset:23424
  s_waitcnt lgkmcnt(14)
  v_mfma_f32_16x16x32_bf16 v[100:103], v[64:67], v[68:71], v[100:103]
  s_waitcnt lgkmcnt(12)
  v_mfma_f32_16x16x32_bf16 v[104:107], v[64:67], v[72:75], v[104:107]
  s_waitcnt lgkmcnt(10)
  v_mfma_f32_16x16x32_bf16 v[100:103], v[64:67], v[76:79], v[100:103]
  s_waitcnt lgkmcnt(8)
  v_mfma_f32_16x16x32_bf16 v[104:107], v[64:67], v[80:83], v[104:107]
  s_waitcnt lgkmcnt(6)
  v_mfma_f32_16x16x32_bf16 v[100:103], v[64:67], v[84:87], v[100:103]
  s_waitcnt lgkmcnt(4)
  v_mfma_f32_16x16x32_bf16 v[104:107], v[64:67], v[88:91], v[104:107]
  s_waitcnt lgkmcnt(2)
  v_mfma_f32_16x16x32_bf16 v[100:103], v[64:67], v[92:95], v[100:103]
  s_waitcnt lgkmcnt(0)
  v_mfma_f32_16x16x32_bf16 v[104:107], v[64:67], v[96:99], v[104:107]
  s_lshl_b32 s13, s6, 6
  s_add_u32 s13, s13, 0x277c0
  v_lshl_add_u32 v108, v2, 2, s13
  s_mov_b64 exec, 0xffff
  s_nop 1
  ds_write_b32 v108, v100
  s_nop 0
  ds_write_b32 v108, v104 offset:256
  s_mov_b64 exec, -1
  s_waitcnt lgkmcnt(0)
  s_cmp_eq_u32 s53, 0
  s_cbranch_scc1 L_kl_39
  s_cmp_ge_u32 s6, 2
  s_cbranch_scc1 L_fk_40
  s_waitcnt vmcnt(5)
  s_lshl_b32 s13, s52, 7
  s_lshl_b32 s19, s4, 1
  s_add_u32 s19, s19, s6
  s_lshl_b32 s19, s19, 2
  s_add_u32 s13, s13, s19
  s_add_u32 s13, s13, 0x2c00
  v_mov_b32 v6, s7
  s_mov_b64 exec, 1
  buffer_store_dword v6, off, s[20:23], s13 sc1
  s_mov_b64 exec, -1
  s_nop 1
L_fk_40:
L_kl_39:
  s_add_u32 s46, s44, 0x7800
  s_add_u32 m0, s43, 0xf000
  s_nop 0
  buffer_load_dwordx4 v5, s[20:23], s46 offen offset:0 sc1 lds
  buffer_load_dwordx4 v5, s[20:23], s46 offen offset:2048 sc1 lds
  s_add_u32 s46, s44, 0x8800
  s_add_u32 m0, s43, 0x10000
  s_nop 0
  buffer_load_dwordx4 v5, s[20:23], s46 offen offset:0 sc1 lds
  buffer_load_dwordx4 v5, s[20:23], s46 offen offset:2048 sc1 lds
  s_add_u32 s46, s44, 0x9800
  s_add_u32 m0, s43, 0x11000
  s_nop 0
  buffer_load_dwordx4 v5, s[20:23], s46 offen offset:0 sc1 lds
  s_barrier
  s_add_u32 s45, s44, 0xa000
  s_add_u32 m0, s43, 0x14000
  s_nop 0
  buffer_load_dwordx4 v5, s[20:23], s45 offen offset:0 sc1 lds
  buffer_load_dwordx4 v5, s[20:23], s45 offen offset:2048 sc1 lds
  s_add_u32 s45, s44, 0xb000
  s_add_u32 m0, s43, 0x15000
  s_nop 0
  buffer_load_dwordx4 v5, s[20:23], s45 offen offset:0 sc1 lds
  buffer_load_dwordx4 v5, s[20:23], s45 offen offset:2048 sc1 lds
  s_add_u32 s45, s44, 0xc000
  s_add_u32 m0, s43, 0x16000
  s_nop 0
  buffer_load_dwordx4 v5, s[20:23], s45 offen offset:0 sc1 lds
  s_barrier
  s_setprio 0
  v_add_u32 v6, s43, v5
  v_add_u32 v7, 0xf000, v6
  v_add_u32 v8, 0x1e000, v6
  s_add_u32 s46, s44, 0xc800
  s_add_u32 m0, s43, 0x19000
  s_nop 0
  buffer_load_dwordx4 v5, s[20:23], s46 offen offset:0 sc1 lds
  buffer_load_dwordx4 v5, s[20:23], s46 offen offset:2048 sc1 lds
  s_add_u32 s46, s44, 0xd800
  s_add_u32 m0, s43, 0x1a000
  s_nop 0
  buffer_load_dwordx4 v5, s[20:23], s46 offen offset:0 sc1 lds
  buffer_load_dwordx4 v5, s[20:23], s46 offen offset:2048 sc1 lds
  s_add_u32 s46, s44, 0xe800
  s_add_u32 m0, s43, 0x1b000
  s_nop 0
  buffer_load_dwordx4 v5, s[20:23], s46 offen offset:0 sc1 lds
  s_add_u32 s45, s44, 0xf000
  s_add_u32 m0, s43, 0x1e000
  s_nop 0
  buffer_load_dwordx4 v5, s[20:23], s45 offen offset:0 sc1 lds
  buffer_load_dwordx4 v5, s[20:23], s45 offen offset:2048 sc1 lds
  s_add_u32 s45, s44, 0x10000
  s_add_u32 m0, s43, 0x1f000
  s_nop 0
  buffer_load_dwordx4 v5, s[20:23], s45 offen offset:0 sc1 lds
  buffer_load_dwordx4 v5, s[20:23], s45 offen offset:2048 sc1 lds
  s_add_u32 s45, s44, 0x11000
  s_add_u32 m0, s43, 0x20000
  s_nop 0
  buffer_load_dwordx4 v5, s[20:23], s45 offen offset:0 sc1 lds
  s_add_u32 s46, s44, 0x11800
  buffer_load_dwordx4 v[64:67], v5, s[20:23], s46 offen offset:0 sc1
  buffer_load_dwordx4 v[68:71], v5, s[20:23], s46 offen offset:2048 sc1
  s_add_u32 s46, s44, 0x12800
  buffer_load_dwordx4 v[72:75], v5, s[20:23], s46 offen offset:0 sc1
  buffer_load_dwordx4 v[76:79], v5, s[20:23], s46 offen offset:2048 sc1
  s_add_u32 s46, s44, 0x13800
  buffer_load_dwordx4 v[80:83], v5, s[20:23], s46 offen offset:0 sc1
  s_add_u32 s45, s44, 0x14000
  buffer_load_dwordx4 v[84:87], v5, s[20:23], s45 offen offset:0 sc1
  buffer_load_dwordx4 v[88:91], v5, s[20:23], s45 offen offset:2048 sc1
  s_add_u32 s45, s44, 0x15000
  buffer_load_dwordx4 v[92:95], v5, s[20:23], s45 offen offset:0 sc1
  buffer_load_dwordx4 v[96:99], v5, s[20:23], s45 offen offset:2048 sc1
  s_add_u32 s45, s44, 0x16000
  buffer_load_dwordx4 v[100:103], v5, s[20:23], s45 offen offset:0 sc1
  s_cmp_lg_u32 s53, 0
  s_cbranch_scc1 L_ql_41
  v_and_b32 v244, 31, v1
  v_lshlrev_b32 v244, 2, v244
  s_lshl_b32 s13, s52, 7
  s_add_u32 s13, s13, 0x2c00
  s_mov_b32 s19, 0x40000
L_pl_43:
  buffer_load_dword v245, v244, s[20:23], s13 offen sc1
  s_waitcnt vmcnt(0)
  v_cmp_ne_u32 vcc, s7, v245
  s_sub_u32 s19, s19, 1
  s_nop 2
  s_cbranch_vccz L_pd_44
  s_cmp_lg_u32 s19, 0
  s_cbranch_scc1 L_pl_43
L_pd_44:
L_ps_42:
  v_add_u32 v244, s54, v5
  v_add_u32 v245, 0x1000, v244
  v_mov_b32 v246, 0x40000000
  v_cmp_gt_u32 vcc, 0x1a40, v245
  s_nop 1
  v_cndmask_b32 v245, v246, v245, vcc
  s_mul_i32 s13, s52, 0x1b00
  s_add_u32 s13, s13, 0xe0000
  s_add_u32 m0, s54, 0x23000
  s_nop 0
  buffer_load_dwordx4 v244, s[20:23], s13 offen sc1 lds
  s_add_u32 m0, s54, 0x24000
  s_nop 0
  buffer_load_dwordx4 v245, s[20:23], s13 offen sc1 lds
L_ql_41:
  s_add_u32 s46, s44, 0x16800
  buffer_load_dwordx4 v[104:107], v5, s[20:23], s46 offen offset:0 sc1
  buffer_load_dwordx4 v[108:111], v5, s[20:23], s46 offen offset:2048 sc1
  s_add_u32 s46, s44, 0x17800
  buffer_load_dwordx4 v[112:115], v5, s[20:23], s46 offen offset:0 sc1
  buffer_load_dwordx4 v[116:119], v5, s[20:23], s46 offen offset:2048 sc1
  s_add_u32 s46, s44, 0x18800
  buffer_load_dwordx4 v[120:123], v5, s[20:23], s46 offen offset:0 sc1
  s_waitcnt vmcnt(5)
  s_barrier
  s_cmp_lg_u32 s6, 0
  s_cbranch_scc1 L_nf_45
  s_lshl_b32 s13, s4, 6
  s_lshl_b32 s19, s5, 2
  s_add_u32 s13, s13, s19
  s_add_u32 s13, s13, 0x1c00
  v_mov_b32 v244, s7
  s_mov_b64 exec, 1
  buffer_store_dword v244, off, s[20:23], s13 sc1
  s_mov_b64 exec, -1
  s_nop 1
L_nf_45:
  s_add_u32 s45, s44, 0x19000
  buffer_load_dwordx4 v[124:127], v5, s[20:23], s45 offen offset:0 sc1
  buffer_load_dwordx4 v[128:131], v5, s[20:23], s45 offen offset:2048 sc1
  s_add_u32 s45, s44, 0x1a000
  buffer_load_dwordx4 v[132:135], v5, s[20:23], s45 offen offset:0 sc1
  buffer_load_dwordx4 v[136:139], v5, s[20:23], s45 offen offset:2048 sc1
  s_add_u32 s45, s44, 0x1b000
  buffer_load_dwordx4 v[140:143], v5, s[20:23], s45 offen offset:0 sc1
  s_add_u32 s46, s44, 0x1b800
  buffer_load_dwordx4 v[144:147], v5, s[20:23], s46 offen offset:0 sc1
  buffer_load_dwordx4 v[148:151], v5, s[20:23], s46 offen offset:2048 sc1
  s_add_u32 s46, s44, 0x1c800
  buffer_load_dwordx4 v[152:155], v5, s[20:23], s46 offen offset:0 sc1
  buffer_load_dwordx4 v[156:159], v5, s[20:23], s46 offen offset:2048 sc1
  s_add_u32 s46, s44, 0x1d800
  buffer_load_dwordx4 v[160:163], v5, s[20:23], s46 offen offset:0 sc1
  s_add_u32 s45, s44, 0x1e000
  buffer_load_dwordx4 v[164:167], v5, s[20:23], s45 offen offset:0 sc1
  buffer_load_dwordx4 v[168:171], v5, s[20:23], s45 offen offset:2048 sc1
  s_add_u32 s45, s44, 0x1f000
  buffer_load_dwordx4 v[172:175], v5, s[20:23], s45 offen offset:0 sc1
  buffer_load_dwordx4 v[176:179], v5, s[20:23], s45 offen offset:2048 sc1
  s_add_u32 s45, s44, 0x20000
  buffer_load_dwordx4 v[180:183], v5, s[20:23], s45 offen offset:0 sc1
  s_add_u32 s46, s44, 0x20800
  buffer_load_dwordx4 v[184:187], v5, s[20:23], s46 offen offset:0 sc1
  buffer_load_dwordx4 v[188:191], v5, s[20:23], s46 offen offset:2048 sc1
  s_add_u32 s46, s44, 0x21800
  buffer_load_dwordx4 v[192:195], v5, s[20:23], s46 offen offset:0 sc1
  buffer_load_dwordx4 v[196:199], v5, s[20:23], s46 offen offset:2048 sc1
  s_add_u32 s46, s44, 0x22800
  buffer_load_dwordx4 v[200:203], v5, s[20:23], s46 offen offset:0 sc1
  s_add_u32 s45, s44, 0x23000
  buffer_load_dwordx4 v[204:207], v5, s[20:23], s45 offen offset:0 sc1
  buffer_load_dwordx4 v[208:211], v5, s[20:23], s45 offen offset:2048 sc1
  s_add_u32 s45, s44, 0x24000
  buffer_load_dwordx4 v[212:215], v5, s[20:23], s45 offen offset:0 sc1
  buffer_load_dwordx4 v[216:219], v5, s[20:23], s45 offen offset:2048 sc1
  s_add_u32 s45, s44, 0x25000
  buffer_load_dwordx4 v[220:223], v5, s[20:23], s45 offen offset:0 sc1
  s_add_u32 s46, s44, 0x25800
  buffer_load_dwordx4 v[224:227], v5, s[20:23], s46 offen offset:0 sc1
  buffer_load_dwordx4 v[228:231], v5, s[20:23], s46 offen offset:2048 sc1
  s_add_u32 s46, s44, 0x26800
  buffer_load_dwordx4 v[232:235], v5, s[20:23], s46 offen offset:0 sc1
  buffer_load_dwordx4 v[236:239], v5, s[20:23], s46 offen offset:2048 sc1
  s_add_u32 s46, s44, 0x27800
  buffer_load_dwordx4 v[240:243], v5, s[20:23], s46 offen offset:0 sc1
  s_cmp_lg_u32 s6, 0
  s_cbranch_scc1 L_ps_48
  v_lshlrev_b32 v244, 2, v2
  s_lshl_b32 s13, s4, 6
  s_add_u32 s13, s13, 0x1c00
  s_mov_b32 s19, 0x40000
L_pl_49:
  buffer_load_dword v245, v244, s[20:23], s13 offen sc1
  s_waitcnt vmcnt(0)
  v_cmp_ne_u32 vcc, s7, v245
  s_sub_u32 s19, s19, 1
  s_nop 2
  s_cbranch_vccz L_pd_50
  s_cmp_lg_u32 s19, 0
  s_cbranch_scc1 L_pl_49
L_pd_50:
L_ps_48:
  s_barrier
  s_barrier
  s_barrier
  ds_write_b128 v6, v[64:67] offset:0
  ds_write_b128 v6, v[68:71] offset:2048
  ds_write_b128 v6, v[72:75] offset:4096
  ds_write_b128 v6, v[76:79] offset:6144
  ds_write_b128 v6, v[80:83] offset:8192
  s_barrier
  s_cmp_lg_u32 s53, 0
  s_cbranch_scc1 L_no_51
  s_cmp_lg_u32 s6, 0
  s_cbranch_scc1 L_nf_52
  s_lshl_b32 s13, s4, 6
  s_lshl_b32 s19, s52, 2
  s_add_u32 s13, s13, s19
  s_add_u32 s13, s13, 0x2000
  v_mov_b32 v64, s7
  s_mov_b64 exec, 1
  buffer_store_dword v64, off, s[20:23], s13 sc1
  s_mov_b64 exec, -1
  s_nop 1
L_nf_52:
L_no_51:
  ds_write_b128 v6, v[84:87] offset:20480
  ds_write_b128 v6, v[88:91] offset:22528
  ds_write_b128 v6, v[92:95] offset:24576
  ds_write_b128 v6, v[96:99] offset:26624
  ds_write_b128 v6, v[100:103] offset:28672
  s_barrier
  s_waitcnt vmcnt(34)
  ds_write_b128 v6, v[104:107] offset:40960
  s_waitcnt vmcnt(33)
  ds_write_b128 v6, v[108:111] offset:43008
  s_waitcnt vmcnt(32)
  ds_write_b128 v6, v[112:115] offset:45056
  s_waitcnt vmcnt(31)
  ds_write_b128 v6, v[116:119] offset:47104
  s_waitcnt vmcnt(30)
  ds_write_b128 v6, v[120:123] offset:49152
  s_barrier
  s_waitcnt vmcnt(29)
  ds_write_b128 v7, v[124:127] offset:0
  s_waitcnt vmcnt(28)
  ds_write_b128 v7, v[128:131] offset:2048
  s_waitcnt vmcnt(27)
  ds_write_b128 v7, v[132:135] offset:4096
  s_waitcnt vmcnt(26)
  ds_write_b128 v7, v[136:139] offset:6144
  s_waitcnt vmcnt(25)
  ds_write_b128 v7, v[140:143] offset:8192
  s_barrier
  s_waitcnt vmcnt(24)
  ds_write_b128 v7, v[144:147] offset:20480
  s_waitcnt vmcnt(23)
  ds_write_b128 v7, v[148:151] offset:22528
  s_waitcnt vmcnt(22)
  ds_write_b128 v7, v[152:155] offset:24576
  s_waitcnt vmcnt(21)
  ds_write_b128 v7, v[156:159] offset:26624
  s_waitcnt vmcnt(20)
  ds_write_b128 v7, v[160:163] offset:28672
  s_waitcnt lgkmcnt(0)
  s_barrier
  s_waitcnt vmcnt(19)
  ds_write_b128 v7, v[164:167] offset:40960
  s_waitcnt vmcnt(18)
  ds_write_b128 v7, v[168:171] offset:43008
  s_waitcnt vmcnt(17)
  ds_write_b128 v7, v[172:175] offset:45056
  s_waitcnt vmcnt(16)
  ds_write_b128 v7, v[176:179] offset:47104
  s_waitcnt vmcnt(15)
  ds_write_b128 v7, v[180:183] offset:49152
  s_cmp_lg_u32 s6, 0
  s_cbranch_scc1 L_ps_53
  v_and_b32 v64, 7, v2
  v_lshlrev_b32 v64, 2, v64
  s_lshl_b32 s13, s4, 6
  s_add_u32 s13, s13, 0x2000
  s_mov_b32 s19, 0x40000
L_pl_54:
  buffer_load_dword v65, v64, s[20:23], s13 offen sc1
  s_waitcnt vmcnt(0)
  v_cmp_ne_u32 vcc, s7, v65
  s_sub_u32 s19, s19, 1
  s_nop 2
  s_cbranch_vccz L_pd_55
  s_cmp_lg_u32 s19, 0
  s_cbranch_scc1 L_pl_54
L_pd_55:
L_ps_53:
  s_waitcnt lgkmcnt(0)
  s_barrier
  s_waitcnt vmcnt(14)
  ds_write_b128 v8, v[184:187] offset:0
  s_waitcnt vmcnt(13)
  ds_write_b128 v8, v[188:191] offset:2048
  s_waitcnt vmcnt(12)
  ds_write_b128 v8, v[192:195] offset:4096
  s_waitcnt vmcnt(11)
  ds_write_b128 v8, v[196:199] offset:6144
  s_waitcnt vmcnt(10)
  ds_write_b128 v8, v[200:203] offset:8192
  s_waitcnt lgkmcnt(0)
  s_barrier
  s_waitcnt vmcnt(9)
  ds_write_b128 v6, v[204:207] offset:0
  s_waitcnt vmcnt(8)
  ds_write_b128 v6, v[208:211] offset:2048
  s_waitcnt vmcnt(7)
  ds_write_b128 v6, v[212:215] offset:4096
  s_waitcnt vmcnt(6)
  ds_write_b128 v6, v[216:219] offset:6144
  s_waitcnt vmcnt(5)
  ds_write_b128 v6, v[220:223] offset:8192
  s_waitcnt lgkmcnt(0)
  s_barrier
  s_waitcnt vmcnt(4)
  ds_write_b128 v6, v[224:227] offset:20480
  s_waitcnt vmcnt(3)
  ds_write_b128 v6, v[228:231] offset:22528
  s_waitcnt vmcnt(2)
  ds_write_b128 v6, v[232:235] offset:24576
  s_waitcnt vmcnt(1)
  ds_write_b128 v6, v[236:239] offset:26624
  s_waitcnt vmcnt(0)
  ds_write_b128 v6, v[240:243] offset:28672
  s_waitcnt lgkmcnt(0)
  s_barrier
  s_add_u32 s45, s44, 0x28000
  s_add_u32 m0, s43, 0xa000
  s_nop 0
  buffer_load_dwordx4 v5, s[20:23], s45 offen offset:0 sc1 lds
  buffer_load_dwordx4 v5, s[20:23], s45 offen offset:2048 sc1 lds
  s_add_u32 s45, s44, 0x29000
  s_add_u32 m0, s43, 0xb000
  s_nop 0
  buffer_load_dwordx4 v5, s[20:23], s45 offen offset:0 sc1 lds
  buffer_load_dwordx4 v5, s[20:23], s45 offen offset:2048 sc1 lds
  s_add_u32 s45, s44, 0x2a000
  s_add_u32 m0, s43, 0xc000
  s_nop 0
  buffer_load_dwordx4 v5, s[20:23], s45 offen offset:0 sc1 lds
  s_waitcnt lgkmcnt(0)
  s_barrier
  s_add_u32 s46, s44, 0x2a800
  s_add_u32 m0, s43, 0xf000
  s_nop 0
  buffer_load_dwordx4 v5, s[20:23], s46 offen offset:0 sc1 lds
  buffer_load_dwordx4 v5, s[20:23], s46 offen offset:2048 sc1 lds
  s_add_u32 s46, s44, 0x2b800
  s_add_u32 m0, s43, 0x10000
  s_nop 0
  buffer_load_dwordx4 v5, s[20:23], s46 offen offset:0 sc1 lds
  buffer_load_dwordx4 v5, s[20:23], s46 offen offset:2048 sc1 lds
  s_add_u32 s46, s44, 0x2c800
  s_add_u32 m0, s43, 0x11000
  s_nop 0
  buffer_load_dwordx4 v5, s[20:23], s46 offen offset:0 sc1 lds
  s_waitcnt lgkmcnt(0)
  s_barrier
  s_add_u32 s45, s44, 0x2d000
  s_add_u32 m0, s43, 0x14000
  s_nop 0
  buffer_load_dwordx4 v5, s[20:23], s45 offen offset:0 sc1 lds
  buffer_load_dwordx4 v5, s[20:23], s45 offen offset:2048 sc1 lds
  s_add_u32 s45, s44, 0x2e000
  s_add_u32 m0, s43, 0x15000
  s_nop 0
  buffer_load_dwordx4 v5, s[20:23], s45 offen offset:0 sc1 lds
  buffer_load_dwordx4 v5, s[20:23], s45 offen offset:2048 sc1 lds
  s_add_u32 s45, s44, 0x2f000
  s_add_u32 m0, s43, 0x16000
  s_nop 0
  buffer_load_dwordx4 v5, s[20:23], s45 offen offset:0 sc1 lds
  s_waitcnt lgkmcnt(0)
  s_barrier
  s_waitcnt lgkmcnt(0)
  s_barrier
  s_waitcnt vmcnt(10)
  s_barrier
  s_waitcnt vmcnt(5)
  s_barrier
  s_waitcnt vmcnt(0)
  s_barrier
  s_barrier
  s_waitcnt vmcnt(0) lgkmcnt(0)
  s_endpgm
L_compute:
  s_nop 7
  s_waitcnt lgkmcnt(0)
  s_waitcnt lgkmcnt(0)
  s_mov_b32 s8, s60
  s_mov_b32 s9, s61
  s_mov_b32 s10, 0x280000
  s_mov_b32 s11, 0x20000
  s_mov_b32 s20, s80
  s_mov_b32 s21, s81
  s_mov_b32 s22, 0x12d4000
  s_mov_b32 s23, 0x20000
  s_mov_b32 s40, s76
  s_mov_b32 s41, s77
  s_mov_b32 s42, 0x280000
  s_mov_b32 s43, 0x20000
  s_mov_b32 s56, 0xffff
  s_mov_b32 s57, 0
  s_mov_b32 s58, 0xffff0000
  s_mov_b32 s59, 0
  s_mov_b32 s84, 0
  s_mov_b32 s85, 0xffff
  s_mov_b32 s86, 0
  s_mov_b32 s87, 0xffff0000
  s_mov_b32 s60, 0xbdd2d3e8
  s_mov_b32 s61, 0xbdd2d3e8
  v_mov_b32 v4, 0xc0135761
  v_mov_b32 v5, 1.0
  v_mov_b32 v6, 0x3f803f80
  v_mov_b32 v7, 0x3f803f80
  v_mov_b32 v8, 0x3f803f80
  v_mov_b32 v9, 0x3f803f80
  v_lshrrev_b32 v10, 1, v3
  v_lshlrev_b32 v10, 4, v10
  v_and_b32 v11, 1, v3
  v_lshl_add_u32 v10, v11, 2, v10
  v_bfe_u32 v11, v1, 2, 2
  v_add_u32 v10, v10, v11
  v_mul_u32_u24 v10, 0xa0, v10
  v_and_b32 v11, 3, v1
  v_lshl_add_u32 v10, v11, 3, v10
  v_add_u32 v11, 0xf000, v10
  s_lshl_b32 s55, s6, 12
  s_add_u32 s55, s55, 0x19000
  v_and_b32 v12, 7, v2
  v_xor_b32 v12, v12, v3
  v_lshlrev_b32 v12, 4, v12
  v_lshl_add_u32 v12, v2, 7, v12
  v_add_u32 v14, s55, v12
  v_xor_b32 v15, 64, v14
  v_mov_b32 v13, 0
  v_lshlrev_b32 v12, 2, v2
  v_add_u32 v12, 0x26000, v12
  ds_write_b32 v12, v13
  s_mul_i32 s62, s5, 7
  s_min_u32 s62, s62, 0x65
  s_and_b32 s63, s6, 1
  s_lshr_b32 s64, s6, 1
  s_lshl_b32 s65, s4, 1
  s_add_u32 s65, s65, s53
  s_lshl_b32 s65, s65, 1
  s_add_u32 s65, s65, s63
  s_lshl_b32 s65, s65, 1
  s_add_u32 s66, s65, s64
  s_lshl_b32 s66, s66, 4
  s_mul_i32 s67, s52, 0xa0
  v_add_u32 v185, 0, v1
  v_mul_u32_u24 v186, 0xcd, v185
  v_lshrrev_b32 v186, 11, v186
  v_mul_u32_u24 v187, 10, v186
  v_sub_u32 v187, v185, v187
  v_add_u32 v186, s66, v186
  v_mul_u32_u24 v186, 0x500, v186
  v_lshl_add_u32 v12, v187, 4, v186
  v_add_u32 v12, s67, v12
  v_add_u32 v185, 64, v1
  v_mul_u32_u24 v186, 0xcd, v185
  v_lshrrev_b32 v186, 11, v186
  v_mul_u32_u24 v187, 10, v186
  v_sub_u32 v187, v185, v187
  v_add_u32 v186, s66, v186
  v_mul_u32_u24 v186, 0x500, v186
  v_lshl_add_u32 v13, v187, 4, v186
  v_add_u32 v13, s67, v13
  v_add_u32 v185, 0x80, v1
  v_mul_u32_u24 v186, 0xcd, v185
  v_lshrrev_b32 v186, 11, v186
  v_mul_u32_u24 v187, 10, v186
  v_sub_u32 v187, v185, v187
  v_add_u32 v186, s66, v186
  v_mul_u32_u24 v186, 0x500, v186
  v_lshl_add_u32 v184, v187, 4, v186
  v_add_u32 v184, s67, v184
  v_mov_b32 v187, 0x40000000
  v_cmp_gt_u32 vcc, 32, v1
  s_nop 1
  v_cndmask_b32 v184, v187, v184, vcc
  s_add_u32 s66, s64, 1
  s_lshl_b32 s67, s65, 4
  s_add_u32 s67, s67, 16
  s_sub_u32 s67, s67, s66
  v_add_u32 v187, s67, v2
  v_lshrrev_b32 v188, 4, v187
  v_mul_u32_u24 v188, 0x5000, v188
  v_and_b32 v187, 15, v187
  v_lshl_add_u32 v188, v187, 4, v188
  v_lshl_add_u32 v185, v3, 8, v188
  s_add_u32 s66, s64, 1
  s_lshl_b32 s67, s65, 4
  s_add_u32 s67, s67, 16
  s_add_u32 s67, s67, s66
  v_add_u32 v187, s67, v2
  v_lshrrev_b32 v188, 4, v187
  v_mul_u32_u24 v188, 0x5000, v188
  v_and_b32 v187, 15, v187
  v_lshl_add_u32 v188, v187, 4, v188
  v_lshl_add_u32 v186, v3, 8, v188
  v_and_b32 v190, 1, v3
  v_lshlrev_b32 v190, 1, v190
  v_lshrrev_b32 v189, 1, v3
  v_add_u32 v189, v189, v190
  v_lshlrev_b32 v189, 8, v189
  v_lshl_add_u32 v189, v2, 4, v189
  v_lshlrev_b32 v190, 4, v1
  s_waitcnt lgkmcnt(0)
  s_barrier
  ds_read_b128 v[16:19], v14 offset:0
  ds_read_b128 v[24:27], v15 offset:0
  ds_read_b128 v[20:23], v14 offset:2048
  ds_read_b128 v[28:31], v15 offset:2048
  ds_read_b64_tr_b16 v[48:49], v10 offset:0
  ds_read_b64_tr_b16 v[50:51], v10 offset:1280
  ds_read_b64_tr_b16 v[52:53], v10 offset:32
  ds_read_b64_tr_b16 v[54:55], v10 offset:1312
  ds_read_b64_tr_b16 v[56:57], v10 offset:64
  ds_read_b64_tr_b16 v[58:59], v10 offset:1344
  ds_read_b64_tr_b16 v[60:61], v10 offset:96
  ds_read_b64_tr_b16 v[62:63], v10 offset:1376
  ds_read_b64_tr_b16 v[64:65], v10 offset:128
  ds_read_b64_tr_b16 v[66:67], v10 offset:1408
  ds_read_b64_tr_b16 v[68:69], v10 offset:10240
  ds_read_b64_tr_b16 v[70:71], v10 offset:11520
  ds_read_b64_tr_b16 v[72:73], v10 offset:10272
  ds_read_b64_tr_b16 v[74:75], v10 offset:11552
  ds_read_b64_tr_b16 v[76:77], v10 offset:10304
  ds_read_b64_tr_b16 v[78:79], v10 offset:11584
  ds_read_b64_tr_b16 v[80:81], v10 offset:10336
  ds_read_b64_tr_b16 v[82:83], v10 offset:11616
  ds_read_b64_tr_b16 v[84:85], v10 offset:10368
  ds_read_b64_tr_b16 v[86:87], v10 offset:11648
  s_waitcnt lgkmcnt(15)
  v_mfma_f32_16x16x32_bf16 v[168:171], v[6:9], v[16:19], 0
  v_mfma_f32_16x16x32_bf16 v[176:179], v[16:19], v[16:19], 0
  v_mfma_f32_16x16x32_bf16 v[172:175], v[6:9], v[20:23], 0
  v_mfma_f32_16x16x32_bf16 v[180:183], v[20:23], v[20:23], 0
  s_waitcnt lgkmcnt(14)
  v_mfma_f32_16x16x32_bf16 v[88:91], v[48:51], v[16:19], 0
  v_mfma_f32_16x16x32_bf16 v[92:95], v[48:51], v[20:23], 0
  v_mfma_f32_16x16x32_bf16 v[96:99], v[52:55], v[16:19], 0
  ds_read_b64_tr_b16 v[48:49], v10 offset:5120
  v_mfma_f32_16x16x32_bf16 v[100:103], v[52:55], v[20:23], 0
  ds_read_b64_tr_b16 v[50:51], v10 offset:6400
  v_mfma_f32_16x16x32_bf16 v[104:107], v[56:59], v[16:19], 0
  ds_read_b64_tr_b16 v[52:53], v10 offset:5152
  v_mfma_f32_16x16x32_bf16 v[108:111], v[56:59], v[20:23], 0
  ds_read_b64_tr_b16 v[54:55], v10 offset:6432
  s_waitcnt lgkmcnt(12)
  v_mfma_f32_16x16x32_bf16 v[112:115], v[60:63], v[16:19], 0
  ds_read_b64_tr_b16 v[56:57], v10 offset:5184
  v_mfma_f32_16x16x32_bf16 v[116:119], v[60:63], v[20:23], 0
  ds_read_b64_tr_b16 v[58:59], v10 offset:6464
  v_mfma_f32_16x16x32_bf16 v[120:123], v[64:67], v[16:19], 0
  ds_read_b64_tr_b16 v[60:61], v10 offset:5216
  v_mfma_f32_16x16x32_bf16 v[124:127], v[64:67], v[20:23], 0
  ds_read_b64_tr_b16 v[62:63], v10 offset:6496
  v_mfma_f32_16x16x32_bf16 v[128:131], v[68:71], v[16:19], 0
  ds_read_b64_tr_b16 v[64:65], v10 offset:5248
  v_mfma_f32_16x16x32_bf16 v[132:135], v[68:71], v[20:23], 0
  ds_read_b64_tr_b16 v[66:67], v10 offset:6528
  s_waitcnt lgkmcnt(12)
  v_mfma_f32_16x16x32_bf16 v[136:139], v[72:75], v[16:19], 0
  ds_read_b64_tr_b16 v[68:69], v10 offset:15360
  v_mfma_f32_16x16x32_bf16 v[140:143], v[72:75], v[20:23], 0
  ds_read_b64_tr_b16 v[70:71], v10 offset:16640
  v_mfma_f32_16x16x32_bf16 v[144:147], v[76:79], v[16:19], 0
  ds_read_b64_tr_b16 v[72:73], v10 offset:15392
  v_mfma_f32_16x16x32_bf16 v[148:151], v[76:79], v[20:23], 0
  ds_read_b64_tr_b16 v[74:75], v10 offset:16672
  v_mfma_f32_16x16x32_bf16 v[152:155], v[80:83], v[16:19], 0
  ds_read_b64_tr_b16 v[76:77], v10 offset:15424
  v_mfma_f32_16x16x32_bf16 v[156:159], v[80:83], v[20:23], 0
  ds_read_b64_tr_b16 v[78:79], v10 offset:16704
  s_waitcnt lgkmcnt(15)
  v_mfma_f32_16x16x32_bf16 v[160:163], v[84:87], v[16:19], 0
  ds_read_b64_tr_b16 v[80:81], v10 offset:15456
  v_mfma_f32_16x16x32_bf16 v[164:167], v[84:87], v[20:23], 0
  ds_read_b64_tr_b16 v[82:83], v10 offset:16736
  s_barrier
  v_mfma_f32_16x16x32_bf16 v[168:171], v[6:9], v[24:27], v[168:171]
  ds_read_b128 v[32:35], v14 offset:16384
  v_mfma_f32_16x16x32_bf16 v[176:179], v[24:27], v[24:27], v[176:179]
  ds_read_b128 v[40:43], v15 offset:16384
  v_mfma_f32_16x16x32_bf16 v[172:175], v[6:9], v[28:31], v[172:175]
  ds_read_b128 v[36:39], v14 offset:18432
  v_mfma_f32_16x16x32_bf16 v[180:183], v[28:31], v[28:31], v[180:183]
  ds_read_b128 v[44:47], v15 offset:18432
  s_waitcnt lgkmcnt(15)
  v_mfma_f32_16x16x32_bf16 v[88:91], v[48:51], v[24:27], v[88:91]
  ds_read_b64_tr_b16 v[84:85], v10 offset:15488
  v_mfma_f32_16x16x32_bf16 v[92:95], v[48:51], v[28:31], v[92:95]
  ds_read_b64_tr_b16 v[86:87], v10 offset:16768
  v_mfma_f32_16x16x32_bf16 v[96:99], v[52:55], v[24:27], v[96:99]
  ds_read_b64_tr_b16 v[48:49], v10 offset:20480
  v_mfma_f32_16x16x32_bf16 v[100:103], v[52:55], v[28:31], v[100:103]
  ds_read_b64_tr_b16 v[50:51], v10 offset:21760
  v_mfma_f32_16x16x32_bf16 v[104:107], v[56:59], v[24:27], v[104:107]
  ds_read_b64_tr_b16 v[52:53], v10 offset:20512
  v_mfma_f32_16x16x32_bf16 v[108:111], v[56:59], v[28:31], v[108:111]
  ds_read_b64_tr_b16 v[54:55], v10 offset:21792
  s_waitcnt lgkmcnt(15)
  v_mfma_f32_16x16x32_bf16 v[112:115], v[60:63], v[24:27], v[112:115]
  ds_read_b64_tr_b16 v[56:57], v10 offset:20544
  v_mfma_f32_16x16x32_bf16 v[116:119], v[60:63], v[28:31], v[116:119]
  ds_read_b64_tr_b16 v[58:59], v10 offset:21824
  v_mfma_f32_16x16x32_bf16 v[120:123], v[64:67], v[24:27], v[120:123]
  ds_read_b64_tr_b16 v[60:61], v10 offset:20576
  v_mfma_f32_16x16x32_bf16 v[124:127], v[64:67], v[28:31], v[124:127]
  ds_read_b64_tr_b16 v[62:63], v10 offset:21856
  v_mfma_f32_16x16x32_bf16 v[128:131], v[68:71], v[24:27], v[128:131]
  ds_read_b64_tr_b16 v[64:65], v10 offset:20608
  v_mfma_f32_16x16x32_bf16 v[132:135], v[68:71], v[28:31], v[132:135]
  ds_read_b64_tr_b16 v[66:67], v10 offset:21888
  s_waitcnt lgkmcnt(15)
  v_mfma_f32_16x16x32_bf16 v[136:139], v[72:75], v[24:27], v[136:139]
  ds_read_b64_tr_b16 v[68:69], v10 offset:30720
  v_mfma_f32_16x16x32_bf16 v[140:143], v[72:75], v[28:31], v[140:143]
  ds_read_b64_tr_b16 v[70:71], v10 offset:32000
  v_mfma_f32_16x16x32_bf16 v[144:147], v[76:79], v[24:27], v[144:147]
  ds_read_b64_tr_b16 v[72:73], v10 offset:30752
  v_mfma_f32_16x16x32_bf16 v[148:151], v[76:79], v[28:31], v[148:151]
  ds_read_b64_tr_b16 v[74:75], v10 offset:32032
  v_mfma_f32_16x16x32_bf16 v[152:155], v[80:83], v[24:27], v[152:155]
  ds_read_b64_tr_b16 v[76:77], v10 offset:30784
  v_mfma_f32_16x16x32_bf16 v[156:159], v[80:83], v[28:31], v[156:159]
  ds_read_b64_tr_b16 v[78:79], v10 offset:32064
  s_waitcnt lgkmcnt(15)
  v_mfma_f32_16x16x32_bf16 v[160:163], v[84:87], v[24:27], v[160:163]
  ds_read_b64_tr_b16 v[80:81], v10 offset:30816
  v_mfma_f32_16x16x32_bf16 v[164:167], v[84:87], v[28:31], v[164:167]
  ds_read_b64_tr_b16 v[82:83], v10 offset:32096
  v_mfma_f32_16x16x32_bf16 v[168:171], v[6:9], v[32:35], v[168:171]
  v_mfma_f32_16x16x32_bf16 v[176:179], v[32:35], v[32:35], v[176:179]
  v_mfma_f32_16x16x32_bf16 v[172:175], v[6:9], v[36:39], v[172:175]
  v_mfma_f32_16x16x32_bf16 v[180:183], v[36:39], v[36:39], v[180:183]
  s_waitcnt lgkmcnt(12)
  v_mfma_f32_16x16x32_bf16 v[88:91], v[48:51], v[32:35], v[88:91]
  ds_read_b64_tr_b16 v[84:85], v10 offset:30848
  v_mfma_f32_16x16x32_bf16 v[92:95], v[48:51], v[36:39], v[92:95]
  ds_read_b64_tr_b16 v[86:87], v10 offset:32128
  v_mfma_f32_16x16x32_bf16 v[96:99], v[52:55], v[32:35], v[96:99]
  ds_read_b64_tr_b16 v[48:49], v10 offset:25600
  v_mfma_f32_16x16x32_bf16 v[100:103], v[52:55], v[36:39], v[100:103]
  ds_read_b64_tr_b16 v[50:51], v10 offset:26880
  v_mfma_f32_16x16x32_bf16 v[104:107], v[56:59], v[32:35], v[104:107]
  ds_read_b64_tr_b16 v[52:53], v10 offset:25632
  v_mfma_f32_16x16x32_bf16 v[108:111], v[56:59], v[36:39], v[108:111]
  ds_read_b64_tr_b16 v[54:55], v10 offset:26912
  s_waitcnt lgkmcnt(12)
  v_mfma_f32_16x16x32_bf16 v[112:115], v[60:63], v[32:35], v[112:115]
  ds_read_b64_tr_b16 v[56:57], v10 offset:25664
  v_mfma_f32_16x16x32_bf16 v[116:119], v[60:63], v[36:39], v[116:119]
  ds_read_b64_tr_b16 v[58:59], v10 offset:26944
  v_mfma_f32_16x16x32_bf16 v[120:123], v[64:67], v[32:35], v[120:123]
  ds_read_b64_tr_b16 v[60:61], v10 offset:25696
  v_mfma_f32_16x16x32_bf16 v[124:127], v[64:67], v[36:39], v[124:127]
  ds_read_b64_tr_b16 v[62:63], v10 offset:26976
  v_mfma_f32_16x16x32_bf16 v[128:131], v[68:71], v[32:35], v[128:131]
  ds_read_b64_tr_b16 v[64:65], v10 offset:25728
  v_mfma_f32_16x16x32_bf16 v[132:135], v[68:71], v[36:39], v[132:135]
  ds_read_b64_tr_b16 v[66:67], v10 offset:27008
  s_waitcnt lgkmcnt(12)
  v_mfma_f32_16x16x32_bf16 v[136:139], v[72:75], v[32:35], v[136:139]
  ds_read_b64_tr_b16 v[68:69], v10 offset:35840
  v_mfma_f32_16x16x32_bf16 v[140:143], v[72:75], v[36:39], v[140:143]
  ds_read_b64_tr_b16 v[70:71], v10 offset:37120
  v_mfma_f32_16x16x32_bf16 v[144:147], v[76:79], v[32:35], v[144:147]
  ds_read_b64_tr_b16 v[72:73], v10 offset:35872
  v_mfma_f32_16x16x32_bf16 v[148:151], v[76:79], v[36:39], v[148:151]
  ds_read_b64_tr_b16 v[74:75], v10 offset:37152
  v_mfma_f32_16x16x32_bf16 v[152:155], v[80:83], v[32:35], v[152:155]
  ds_read_b64_tr_b16 v[76:77], v10 offset:35904
  v_mfma_f32_16x16x32_bf16 v[156:159], v[80:83], v[36:39], v[156:159]
  ds_read_b64_tr_b16 v[78:79], v10 offset:37184
  s_waitcnt lgkmcnt(15)
  v_mfma_f32_16x16x32_bf16 v[160:163], v[84:87], v[32:35], v[160:163]
  ds_read_b64_tr_b16 v[80:81], v10 offset:35936
  v_mfma_f32_16x16x32_bf16 v[164:167], v[84:87], v[36:39], v[164:167]
  ds_read_b64_tr_b16 v[82:83], v10 offset:37216
  s_barrier
  v_mfma_f32_16x16x32_bf16 v[168:171], v[6:9], v[40:43], v[168:171]
  ds_read_b128 v[16:19], v14 offset:32768
  v_mfma_f32_16x16x32_bf16 v[176:179], v[40:43], v[40:43], v[176:179]
  ds_read_b128 v[24:27], v15 offset:32768
  v_mfma_f32_16x16x32_bf16 v[172:175], v[6:9], v[44:47], v[172:175]
  ds_read_b128 v[20:23], v14 offset:34816
  v_mfma_f32_16x16x32_bf16 v[180:183], v[44:47], v[44:47], v[180:183]
  ds_read_b128 v[28:31], v15 offset:34816
  s_waitcnt lgkmcnt(15)
  v_mfma_f32_16x16x32_bf16 v[88:91], v[48:51], v[40:43], v[88:91]
  ds_read_b64_tr_b16 v[84:85], v10 offset:35968
  v_mfma_f32_16x16x32_bf16 v[92:95], v[48:51], v[44:47], v[92:95]
  ds_read_b64_tr_b16 v[86:87], v10 offset:37248
  v_mfma_f32_16x16x32_bf16 v[96:99], v[52:55], v[40:43], v[96:99]
  ds_read_b64_tr_b16 v[48:49], v10 offset:40960
  v_mfma_f32_16x16x32_bf16 v[100:103], v[52:55], v[44:47], v[100:103]
  ds_read_b64_tr_b16 v[50:51], v10 offset:42240
  v_mfma_f32_16x16x32_bf16 v[104:107], v[56:59], v[40:43], v[104:107]
  ds_read_b64_tr_b16 v[52:53], v10 offset:40992
  v_mfma_f32_16x16x32_bf16 v[108:111], v[56:59], v[44:47], v[108:111]
  ds_read_b64_tr_b16 v[54:55], v10 offset:42272
  s_waitcnt lgkmcnt(15)
  v_mfma_f32_16x16x32_bf16 v[112:115], v[60:63], v[40:43], v[112:115]
  ds_read_b64_tr_b16 v[56:57], v10 offset:41024
  v_mfma_f32_16x16x32_bf16 v[116:119], v[60:63], v[44:47], v[116:119]
  ds_read_b64_tr_b16 v[58:59], v10 offset:42304
  v_mfma_f32_16x16x32_bf16 v[120:123], v[64:67], v[40:43], v[120:123]
  ds_read_b64_tr_b16 v[60:61], v10 offset:41056
  v_mfma_f32_16x16x32_bf16 v[124:127], v[64:67], v[44:47], v[124:127]
  ds_read_b64_tr_b16 v[62:63], v10 offset:42336
  v_mfma_f32_16x16x32_bf16 v[128:131], v[68:71], v[40:43], v[128:131]
  ds_read_b64_tr_b16 v[64:65], v10 offset:41088
  v_mfma_f32_16x16x32_bf16 v[132:135], v[68:71], v[44:47], v[132:135]
  ds_read_b64_tr_b16 v[66:67], v10 offset:42368
  s_waitcnt lgkmcnt(15)
  v_mfma_f32_16x16x32_bf16 v[136:139], v[72:75], v[40:43], v[136:139]
  ds_read_b64_tr_b16 v[68:69], v10 offset:51200
  v_mfma_f32_16x16x32_bf16 v[140:143], v[72:75], v[44:47], v[140:143]
  ds_read_b64_tr_b16 v[70:71], v10 offset:52480
  v_mfma_f32_16x16x32_bf16 v[144:147], v[76:79], v[40:43], v[144:147]
  ds_read_b64_tr_b16 v[72:73], v10 offset:51232
  v_mfma_f32_16x16x32_bf16 v[148:151], v[76:79], v[44:47], v[148:151]
  ds_read_b64_tr_b16 v[74:75], v10 offset:52512
  v_mfma_f32_16x16x32_bf16 v[152:155], v[80:83], v[40:43], v[152:155]
  ds_read_b64_tr_b16 v[76:77], v10 offset:51264
  v_mfma_f32_16x16x32_bf16 v[156:159], v[80:83], v[44:47], v[156:159]
  ds_read_b64_tr_b16 v[78:79], v10 offset:52544
  s_waitcnt lgkmcnt(15)
  v_mfma_f32_16x16x32_bf16 v[160:163], v[84:87], v[40:43], v[160:163]
  ds_read_b64_tr_b16 v[80:81], v10 offset:51296
  v_mfma_f32_16x16x32_bf16 v[164:167], v[84:87], v[44:47], v[164:167]
  ds_read_b64_tr_b16 v[82:83], v10 offset:52576
  v_mfma_f32_16x16x32_bf16 v[168:171], v[6:9], v[16:19], v[168:171]
  v_mfma_f32_16x16x32_bf16 v[176:179], v[16:19], v[16:19], v[176:179]
  v_mfma_f32_16x16x32_bf16 v[172:175], v[6:9], v[20:23], v[172:175]
  v_mfma_f32_16x16x32_bf16 v[180:183], v[20:23], v[20:23], v[180:183]
  s_waitcnt lgkmcnt(12)
  v_mfma_f32_16x16x32_bf16 v[88:91], v[48:51], v[16:19], v[88:91]
  ds_read_b64_tr_b16 v[84:85], v10 offset:51328
  v_mfma_f32_16x16x32_bf16 v[92:95], v[48:51], v[20:23], v[92:95]
  ds_read_b64_tr_b16 v[86:87], v10 offset:52608
  v_mfma_f32_16x16x32_bf16 v[96:99], v[52:55], v[16:19], v[96:99]
  ds_read_b64_tr_b16 v[48:49], v10 offset:46080
  v_mfma_f32_16x16x32_bf16 v[100:103], v[52:55], v[20:23], v[100:103]
  ds_read_b64_tr_b16 v[50:51], v10 offset:47360
  v_mfma_f32_16x16x32_bf16 v[104:107], v[56:59], v[16:19], v[104:107]
  ds_read_b64_tr_b16 v[52:53], v10 offset:46112
  v_mfma_f32_16x16x32_bf16 v[108:111], v[56:59], v[20:23], v[108:111]
  ds_read_b64_tr_b16 v[54:55], v10 offset:47392
  s_waitcnt lgkmcnt(12)
  v_mfma_f32_16x16x32_bf16 v[112:115], v[60:63], v[16:19], v[112:115]
  ds_read_b64_tr_b16 v[56:57], v10 offset:46144
  v_mfma_f32_16x16x32_bf16 v[116:119], v[60:63], v[20:23], v[116:119]
  ds_read_b64_tr_b16 v[58:59], v10 offset:47424
  v_mfma_f32_16x16x32_bf16 v[120:123], v[64:67], v[16:19], v[120:123]
  ds_read_b64_tr_b16 v[60:61], v10 offset:46176
  v_mfma_f32_16x16x32_bf16 v[124:127], v[64:67], v[20:23], v[124:127]
  ds_read_b64_tr_b16 v[62:63], v10 offset:47456
  v_mfma_f32_16x16x32_bf16 v[128:131], v[68:71], v[16:19], v[128:131]
  ds_read_b64_tr_b16 v[64:65], v10 offset:46208
  v_mfma_f32_16x16x32_bf16 v[132:135], v[68:71], v[20:23], v[132:135]
  ds_read_b64_tr_b16 v[66:67], v10 offset:47488
  s_waitcnt lgkmcnt(12)
  v_mfma_f32_16x16x32_bf16 v[136:139], v[72:75], v[16:19], v[136:139]
  ds_read_b64_tr_b16 v[68:69], v10 offset:56320
  v_mfma_f32_16x16x32_bf16 v[140:143], v[72:75], v[20:23], v[140:143]
  ds_read_b64_tr_b16 v[70:71], v10 offset:57600
  v_mfma_f32_16x16x32_bf16 v[144:147], v[76:79], v[16:19], v[144:147]
  ds_read_b64_tr_b16 v[72:73], v10 offset:56352
  v_mfma_f32_16x16x32_bf16 v[148:151], v[76:79], v[20:23], v[148:151]
  ds_read_b64_tr_b16 v[74:75], v10 offset:57632
  v_mfma_f32_16x16x32_bf16 v[152:155], v[80:83], v[16:19], v[152:155]
  ds_read_b64_tr_b16 v[76:77], v10 offset:56384
  v_mfma_f32_16x16x32_bf16 v[156:159], v[80:83], v[20:23], v[156:159]
  ds_read_b64_tr_b16 v[78:79], v10 offset:57664
  s_waitcnt lgkmcnt(15)
  v_mfma_f32_16x16x32_bf16 v[160:163], v[84:87], v[16:19], v[160:163]
  ds_read_b64_tr_b16 v[80:81], v10 offset:56416
  v_mfma_f32_16x16x32_bf16 v[164:167], v[84:87], v[20:23], v[164:167]
  ds_read_b64_tr_b16 v[82:83], v10 offset:57696
  s_barrier
  v_mfma_f32_16x16x32_bf16 v[168:171], v[6:9], v[24:27], v[168:171]
  ds_read_b128 v[32:35], v14 offset:0
  v_mfma_f32_16x16x32_bf16 v[176:179], v[24:27], v[24:27], v[176:179]
  ds_read_b128 v[40:43], v15 offset:0
  v_mfma_f32_16x16x32_bf16 v[172:175], v[6:9], v[28:31], v[172:175]
  ds_read_b128 v[36:39], v14 offset:2048
  v_mfma_f32_16x16x32_bf16 v[180:183], v[28:31], v[28:31], v[180:183]
  ds_read_b128 v[44:47], v15 offset:2048
  s_waitcnt lgkmcnt(15)
  v_mfma_f32_16x16x32_bf16 v[88:91], v[48:51], v[24:27], v[88:91]
  ds_read_b64_tr_b16 v[84:85], v10 offset:56448
  v_mfma_f32_16x16x32_bf16 v[92:95], v[48:51], v[28:31], v[92:95]
  ds_read_b64_tr_b16 v[86:87], v10 offset:57728
  v_mfma_f32_16x16x32_bf16 v[96:99], v[52:55], v[24:27], v[96:99]
  ds_read_b64_tr_b16 v[48:49], v11 offset:0
  v_mfma_f32_16x16x32_bf16 v[100:103], v[52:55], v[28:31], v[100:103]
  ds_read_b64_tr_b16 v[50:51], v11 offset:1280
  v_mfma_f32_16x16x32_bf16 v[104:107], v[56:59], v[24:27], v[104:107]
  ds_read_b64_tr_b16 v[52:53], v11 offset:32
  v_mfma_f32_16x16x32_bf16 v[108:111], v[56:59], v[28:31], v[108:111]
  ds_read_b64_tr_b16 v[54:55], v11 offset:1312
  s_waitcnt lgkmcnt(15)
  v_mfma_f32_16x16x32_bf16 v[112:115], v[60:63], v[24:27], v[112:115]
  ds_read_b64_tr_b16 v[56:57], v11 offset:64
  v_mfma_f32_16x16x32_bf16 v[116:119], v[60:63], v[28:31], v[116:119]
  ds_read_b64_tr_b16 v[58:59], v11 offset:1344
  v_mfma_f32_16x16x32_bf16 v[120:123], v[64:67], v[24:27], v[120:123]
  ds_read_b64_tr_b16 v[60:61], v11 offset:96
  v_mfma_f32_16x16x32_bf16 v[124:127], v[64:67], v[28:31], v[124:127]
  ds_read_b64_tr_b16 v[62:63], v11 offset:1376
  v_mfma_f32_16x16x32_bf16 v[128:131], v[68:71], v[24:27], v[128:131]
  ds_read_b64_tr_b16 v[64:65], v11 offset:128
  v_mfma_f32_16x16x32_bf16 v[132:135], v[68:71], v[28:31], v[132:135]
  ds_read_b64_tr_b16 v[66:67], v11 offset:1408
  s_waitcnt lgkmcnt(15)
  v_mfma_f32_16x16x32_bf16 v[136:139], v[72:75], v[24:27], v[136:139]
  ds_read_b64_tr_b16 v[68:69], v11 offset:10240
  v_mfma_f32_16x16x32_bf16 v[140:143], v[72:75], v[28:31], v[140:143]
  ds_read_b64_tr_b16 v[70:71], v11 offset:11520
  v_mfma_f32_16x16x32_bf16 v[144:147], v[76:79], v[24:27], v[144:147]
  ds_read_b64_tr_b16 v[72:73], v11 offset:10272
  v_mfma_f32_16x16x32_bf16 v[148:151], v[76:79], v[28:31], v[148:151]
  ds_read_b64_tr_b16 v[74:75], v11 offset:11552
  v_mfma_f32_16x16x32_bf16 v[152:155], v[80:83], v[24:27], v[152:155]
  ds_read_b64_tr_b16 v[76:77], v11 offset:10304
  v_mfma_f32_16x16x32_bf16 v[156:159], v[80:83], v[28:31], v[156:159]
  ds_read_b64_tr_b16 v[78:79], v11 offset:11584
  s_waitcnt lgkmcnt(15)
  v_mfma_f32_16x16x32_bf16 v[160:163], v[84:87], v[24:27], v[160:163]
  ds_read_b64_tr_b16 v[80:81], v11 offset:10336
  v_mfma_f32_16x16x32_bf16 v[164:167], v[84:87], v[28:31], v[164:167]
  ds_read_b64_tr_b16 v[82:83], v11 offset:11616
  v_mfma_f32_16x16x32_bf16 v[168:171], v[6:9], v[32:35], v[168:171]
  v_mfma_f32_16x16x32_bf16 v[176:179], v[32:35], v[32:35], v[176:179]
  v_mfma_f32_16x16x32_bf16 v[172:175], v[6:9], v[36:39], v[172:175]
  v_mfma_f32_16x16x32_bf16 v[180:183], v[36:39], v[36:39], v[180:183]
  s_waitcnt lgkmcnt(12)
  v_mfma_f32_16x16x32_bf16 v[88:91], v[48:51], v[32:35], v[88:91]
  ds_read_b64_tr_b16 v[84:85], v11 offset:10368
  v_mfma_f32_16x16x32_bf16 v[92:95], v[48:51], v[36:39], v[92:95]
  ds_read_b64_tr_b16 v[86:87], v11 offset:11648
  v_mfma_f32_16x16x32_bf16 v[96:99], v[52:55], v[32:35], v[96:99]
  ds_read_b64_tr_b16 v[48:49], v11 offset:5120
  v_mfma_f32_16x16x32_bf16 v[100:103], v[52:55], v[36:39], v[100:103]
  ds_read_b64_tr_b16 v[50:51], v11 offset:6400
  v_mfma_f32_16x16x32_bf16 v[104:107], v[56:59], v[32:35], v[104:107]
  ds_read_b64_tr_b16 v[52:53], v11 offset:5152
  v_mfma_f32_16x16x32_bf16 v[108:111], v[56:59], v[36:39], v[108:111]
  ds_read_b64_tr_b16 v[54:55], v11 offset:6432
  s_waitcnt lgkmcnt(12)
  v_mfma_f32_16x16x32_bf16 v[112:115], v[60:63], v[32:35], v[112:115]
  ds_read_b64_tr_b16 v[56:57], v11 offset:5184
  v_mfma_f32_16x16x32_bf16 v[116:119], v[60:63], v[36:39], v[116:119]
  ds_read_b64_tr_b16 v[58:59], v11 offset:6464
  v_mfma_f32_16x16x32_bf16 v[120:123], v[64:67], v[32:35], v[120:123]
  ds_read_b64_tr_b16 v[60:61], v11 offset:5216
  v_mfma_f32_16x16x32_bf16 v[124:127], v[64:67], v[36:39], v[124:127]
  ds_read_b64_tr_b16 v[62:63], v11 offset:6496
  v_mfma_f32_16x16x32_bf16 v[128:131], v[68:71], v[32:35], v[128:131]
  ds_read_b64_tr_b16 v[64:65], v11 offset:5248
  v_mfma_f32_16x16x32_bf16 v[132:135], v[68:71], v[36:39], v[132:135]
  ds_read_b64_tr_b16 v[66:67], v11 offset:6528
  s_waitcnt lgkmcnt(12)
  v_mfma_f32_16x16x32_bf16 v[136:139], v[72:75], v[32:35], v[136:139]
  ds_read_b64_tr_b16 v[68:69], v11 offset:15360
  v_mfma_f32_16x16x32_bf16 v[140:143], v[72:75], v[36:39], v[140:143]
  ds_read_b64_tr_b16 v[70:71], v11 offset:16640
  v_mfma_f32_16x16x32_bf16 v[144:147], v[76:79], v[32:35], v[144:147]
  ds_read_b64_tr_b16 v[72:73], v11 offset:15392
  v_mfma_f32_16x16x32_bf16 v[148:151], v[76:79], v[36:39], v[148:151]
  ds_read_b64_tr_b16 v[74:75], v11 offset:16672
  v_mfma_f32_16x16x32_bf16 v[152:155], v[80:83], v[32:35], v[152:155]
  ds_read_b64_tr_b16 v[76:77], v11 offset:15424
  v_mfma_f32_16x16x32_bf16 v[156:159], v[80:83], v[36:39], v[156:159]
  ds_read_b64_tr_b16 v[78:79], v11 offset:16704
  s_waitcnt lgkmcnt(15)
  v_mfma_f32_16x16x32_bf16 v[160:163], v[84:87], v[32:35], v[160:163]
  ds_read_b64_tr_b16 v[80:81], v11 offset:15456
  v_mfma_f32_16x16x32_bf16 v[164:167], v[84:87], v[36:39], v[164:167]
  ds_read_b64_tr_b16 v[82:83], v11 offset:16736
  s_barrier
  v_mfma_f32_16x16x32_bf16 v[168:171], v[6:9], v[40:43], v[168:171]
  ds_read_b128 v[16:19], v14 offset:16384
  v_mfma_f32_16x16x32_bf16 v[176:179], v[40:43], v[40:43], v[176:179]
  ds_read_b128 v[24:27], v15 offset:16384
  v_mfma_f32_16x16x32_bf16 v[172:175], v[6:9], v[44:47], v[172:175]
  ds_read_b128 v[20:23], v14 offset:18432
  v_mfma_f32_16x16x32_bf16 v[180:183], v[44:47], v[44:47], v[180:183]
  ds_read_b128 v[28:31], v15 offset:18432
  s_waitcnt lgkmcnt(15)
  v_mfma_f32_16x16x32_bf16 v[88:91], v[48:51], v[40:43], v[88:91]
  ds_read_b64_tr_b16 v[84:85], v11 offset:15488
  v_mfma_f32_16x16x32_bf16 v[92:95], v[48:51], v[44:47], v[92:95]
  ds_read_b64_tr_b16 v[86:87], v11 offset:16768
  v_mfma_f32_16x16x32_bf16 v[96:99], v[52:55], v[40:43], v[96:99]
  ds_read_b64_tr_b16 v[48:49], v11 offset:20480
  v_mfma_f32_16x16x32_bf16 v[100:103], v[52:55], v[44:47], v[100:103]
  ds_read_b64_tr_b16 v[50:51], v11 offset:21760
  v_mfma_f32_16x16x32_bf16 v[104:107], v[56:59], v[40:43], v[104:107]
  ds_read_b64_tr_b16 v[52:53], v11 offset:20512
  v_mfma_f32_16x16x32_bf16 v[108:111], v[56:59], v[44:47], v[108:111]
  ds_read_b64_tr_b16 v[54:55], v11 offset:21792
  s_waitcnt lgkmcnt(15)
  v_mfma_f32_16x16x32_bf16 v[112:115], v[60:63], v[40:43], v[112:115]
  ds_read_b64_tr_b16 v[56:57], v11 offset:20544
  v_mfma_f32_16x16x32_bf16 v[116:119], v[60:63], v[44:47], v[116:119]
  ds_read_b64_tr_b16 v[58:59], v11 offset:21824
  v_mfma_f32_16x16x32_bf16 v[120:123], v[64:67], v[40:43], v[120:123]
  ds_read_b64_tr_b16 v[60:61], v11 offset:20576
  v_mfma_f32_16x16x32_bf16 v[124:127], v[64:67], v[44:47], v[124:127]
  ds_read_b64_tr_b16 v[62:63], v11 offset:21856
  v_mfma_f32_16x16x32_bf16 v[128:131], v[68:71], v[40:43], v[128:131]
  ds_read_b64_tr_b16 v[64:65], v11 offset:20608
  v_mfma_f32_16x16x32_bf16 v[132:135], v[68:71], v[44:47], v[132:135]
  ds_read_b64_tr_b16 v[66:67], v11 offset:21888
  s_waitcnt lgkmcnt(15)
  v_mfma_f32_16x16x32_bf16 v[136:139], v[72:75], v[40:43], v[136:139]
  ds_read_b64_tr_b16 v[68:69], v11 offset:30720
  v_mfma_f32_16x16x32_bf16 v[140:143], v[72:75], v[44:47], v[140:143]
  ds_read_b64_tr_b16 v[70:71], v11 offset:32000
  v_mfma_f32_16x16x32_bf16 v[144:147], v[76:79], v[40:43], v[144:147]
  ds_read_b64_tr_b16 v[72:73], v11 offset:30752
  v_mfma_f32_16x16x32_bf16 v[148:151], v[76:79], v[44:47], v[148:151]
  ds_read_b64_tr_b16 v[74:75], v11 offset:32032
  v_mfma_f32_16x16x32_bf16 v[152:155], v[80:83], v[40:43], v[152:155]
  ds_read_b64_tr_b16 v[76:77], v11 offset:30784
  v_mfma_f32_16x16x32_bf16 v[156:159], v[80:83], v[44:47], v[156:159]
  ds_read_b64_tr_b16 v[78:79], v11 offset:32064
  s_waitcnt lgkmcnt(15)
  v_mfma_f32_16x16x32_bf16 v[160:163], v[84:87], v[40:43], v[160:163]
  ds_read_b64_tr_b16 v[80:81], v11 offset:30816
  v_mfma_f32_16x16x32_bf16 v[164:167], v[84:87], v[44:47], v[164:167]
  ds_read_b64_tr_b16 v[82:83], v11 offset:32096
  v_mfma_f32_16x16x32_bf16 v[168:171], v[6:9], v[16:19], v[168:171]
  v_mfma_f32_16x16x32_bf16 v[176:179], v[16:19], v[16:19], v[176:179]
  v_mfma_f32_16x16x32_bf16 v[172:175], v[6:9], v[20:23], v[172:175]
  v_mfma_f32_16x16x32_bf16 v[180:183], v[20:23], v[20:23], v[180:183]
  s_waitcnt lgkmcnt(12)
  v_mfma_f32_16x16x32_bf16 v[88:91], v[48:51], v[16:19], v[88:91]
  ds_read_b64_tr_b16 v[84:85], v11 offset:30848
  v_mfma_f32_16x16x32_bf16 v[92:95], v[48:51], v[20:23], v[92:95]
  ds_read_b64_tr_b16 v[86:87], v11 offset:32128
  v_mfma_f32_16x16x32_bf16 v[96:99], v[52:55], v[16:19], v[96:99]
  ds_read_b64_tr_b16 v[48:49], v11 offset:25600
  v_mfma_f32_16x16x32_bf16 v[100:103], v[52:55], v[20:23], v[100:103]
  ds_read_b64_tr_b16 v[50:51], v11 offset:26880
  v_mfma_f32_16x16x32_bf16 v[104:107], v[56:59], v[16:19], v[104:107]
  ds_read_b64_tr_b16 v[52:53], v11 offset:25632
  v_mfma_f32_16x16x32_bf16 v[108:111], v[56:59], v[20:23], v[108:111]
  ds_read_b64_tr_b16 v[54:55], v11 offset:26912
  s_waitcnt lgkmcnt(12)
  v_mfma_f32_16x16x32_bf16 v[112:115], v[60:63], v[16:19], v[112:115]
  ds_read_b64_tr_b16 v[56:57], v11 offset:25664
  v_mfma_f32_16x16x32_bf16 v[116:119], v[60:63], v[20:23], v[116:119]
  ds_read_b64_tr_b16 v[58:59], v11 offset:26944
  v_mfma_f32_16x16x32_bf16 v[120:123], v[64:67], v[16:19], v[120:123]
  ds_read_b64_tr_b16 v[60:61], v11 offset:25696
  v_mfma_f32_16x16x32_bf16 v[124:127], v[64:67], v[20:23], v[124:127]
  ds_read_b64_tr_b16 v[62:63], v11 offset:26976
  v_mfma_f32_16x16x32_bf16 v[128:131], v[68:71], v[16:19], v[128:131]
  ds_read_b64_tr_b16 v[64:65], v11 offset:25728
  v_mfma_f32_16x16x32_bf16 v[132:135], v[68:71], v[20:23], v[132:135]
  ds_read_b64_tr_b16 v[66:67], v11 offset:27008
  s_waitcnt lgkmcnt(12)
  v_mfma_f32_16x16x32_bf16 v[136:139], v[72:75], v[16:19], v[136:139]
  ds_read_b64_tr_b16 v[68:69], v11 offset:35840
  v_mfma_f32_16x16x32_bf16 v[140:143], v[72:75], v[20:23], v[140:143]
  ds_read_b64_tr_b16 v[70:71], v11 offset:37120
  v_mfma_f32_16x16x32_bf16 v[144:147], v[76:79], v[16:19], v[144:147]
  ds_read_b64_tr_b16 v[72:73], v11 offset:35872
  v_mfma_f32_16x16x32_bf16 v[148:151], v[76:79], v[20:23], v[148:151]
  ds_read_b64_tr_b16 v[74:75], v11 offset:37152
  v_mfma_f32_16x16x32_bf16 v[152:155], v[80:83], v[16:19], v[152:155]
  ds_read_b64_tr_b16 v[76:77], v11 offset:35904
  v_mfma_f32_16x16x32_bf16 v[156:159], v[80:83], v[20:23], v[156:159]
  ds_read_b64_tr_b16 v[78:79], v11 offset:37184
  s_waitcnt lgkmcnt(15)
  v_mfma_f32_16x16x32_bf16 v[160:163], v[84:87], v[16:19], v[160:163]
  ds_read_b64_tr_b16 v[80:81], v11 offset:35936
  v_mfma_f32_16x16x32_bf16 v[164:167], v[84:87], v[20:23], v[164:167]
  ds_read_b64_tr_b16 v[82:83], v11 offset:37216
  s_barrier
  v_mfma_f32_16x16x32_bf16 v[168:171], v[6:9], v[24:27], v[168:171]
  ds_read_b128 v[32:35], v14 offset:32768
  v_mfma_f32_16x16x32_bf16 v[176:179], v[24:27], v[24:27], v[176:179]
  ds_read_b128 v[40:43], v15 offset:32768
  v_mfma_f32_16x16x32_bf16 v[172:175], v[6:9], v[28:31], v[172:175]
  ds_read_b128 v[36:39], v14 offset:34816
  v_mfma_f32_16x16x32_bf16 v[180:183], v[28:31], v[28:31], v[180:183]
  ds_read_b128 v[44:47], v15 offset:34816
  s_waitcnt lgkmcnt(15)
  v_mfma_f32_16x16x32_bf16 v[88:91], v[48:51], v[24:27], v[88:91]
  ds_read_b64_tr_b16 v[84:85], v11 offset:35968
  v_mfma_f32_16x16x32_bf16 v[92:95], v[48:51], v[28:31], v[92:95]
  ds_read_b64_tr_b16 v[86:87], v11 offset:37248
  v_mfma_f32_16x16x32_bf16 v[96:99], v[52:55], v[24:27], v[96:99]
  ds_read_b64_tr_b16 v[48:49], v10 offset:0
  v_mfma_f32_16x16x32_bf16 v[100:103], v[52:55], v[28:31], v[100:103]
  ds_read_b64_tr_b16 v[50:51], v10 offset:1280
  v_mfma_f32_16x16x32_bf16 v[104:107], v[56:59], v[24:27], v[104:107]
  ds_read_b64_tr_b16 v[52:53], v10 offset:32
  v_mfma_f32_16x16x32_bf16 v[108:111], v[56:59], v[28:31], v[108:111]
  ds_read_b64_tr_b16 v[54:55], v10 offset:1312
  s_waitcnt lgkmcnt(15)
  v_mfma_f32_16x16x32_bf16 v[112:115], v[60:63], v[24:27], v[112:115]
  ds_read_b64_tr_b16 v[56:57], v10 offset:64
  v_mfma_f32_16x16x32_bf16 v[116:119], v[60:63], v[28:31], v[116:119]
  ds_read_b64_tr_b16 v[58:59], v10 offset:1344
  v_mfma_f32_16x16x32_bf16 v[120:123], v[64:67], v[24:27], v[120:123]
  ds_read_b64_tr_b16 v[60:61], v10 offset:96
  v_mfma_f32_16x16x32_bf16 v[124:127], v[64:67], v[28:31], v[124:127]
  ds_read_b64_tr_b16 v[62:63], v10 offset:1376
  v_mfma_f32_16x16x32_bf16 v[128:131], v[68:71], v[24:27], v[128:131]
  ds_read_b64_tr_b16 v[64:65], v10 offset:128
  v_mfma_f32_16x16x32_bf16 v[132:135], v[68:71], v[28:31], v[132:135]
  ds_read_b64_tr_b16 v[66:67], v10 offset:1408
  s_waitcnt lgkmcnt(15)
  v_mfma_f32_16x16x32_bf16 v[136:139], v[72:75], v[24:27], v[136:139]
  ds_read_b64_tr_b16 v[68:69], v10 offset:10240
  v_mfma_f32_16x16x32_bf16 v[140:143], v[72:75], v[28:31], v[140:143]
  ds_read_b64_tr_b16 v[70:71], v10 offset:11520
  v_mfma_f32_16x16x32_bf16 v[144:147], v[76:79], v[24:27], v[144:147]
  ds_read_b64_tr_b16 v[72:73], v10 offset:10272
  v_mfma_f32_16x16x32_bf16 v[148:151], v[76:79], v[28:31], v[148:151]
  ds_read_b64_tr_b16 v[74:75], v10 offset:11552
  v_mfma_f32_16x16x32_bf16 v[152:155], v[80:83], v[24:27], v[152:155]
  ds_read_b64_tr_b16 v[76:77], v10 offset:10304
  v_mfma_f32_16x16x32_bf16 v[156:159], v[80:83], v[28:31], v[156:159]
  ds_read_b64_tr_b16 v[78:79], v10 offset:11584
  s_waitcnt lgkmcnt(15)
  v_mfma_f32_16x16x32_bf16 v[160:163], v[84:87], v[24:27], v[160:163]
  ds_read_b64_tr_b16 v[80:81], v10 offset:10336
  v_mfma_f32_16x16x32_bf16 v[164:167], v[84:87], v[28:31], v[164:167]
  ds_read_b64_tr_b16 v[82:83], v10 offset:11616
  v_mfma_f32_16x16x32_bf16 v[168:171], v[6:9], v[32:35], v[168:171]
  v_mfma_f32_16x16x32_bf16 v[176:179], v[32:35], v[32:35], v[176:179]
  v_mfma_f32_16x16x32_bf16 v[172:175], v[6:9], v[36:39], v[172:175]
  v_mfma_f32_16x16x32_bf16 v[180:183], v[36:39], v[36:39], v[180:183]
  s_waitcnt lgkmcnt(12)
  v_mfma_f32_16x16x32_bf16 v[88:91], v[48:51], v[32:35], v[88:91]
  ds_read_b64_tr_b16 v[84:85], v10 offset:10368
  v_mfma_f32_16x16x32_bf16 v[92:95], v[48:51], v[36:39], v[92:95]
  ds_read_b64_tr_b16 v[86:87], v10 offset:11648
  v_mfma_f32_16x16x32_bf16 v[96:99], v[52:55], v[32:35], v[96:99]
  ds_read_b64_tr_b16 v[48:49], v10 offset:5120
  v_mfma_f32_16x16x32_bf16 v[100:103], v[52:55], v[36:39], v[100:103]
  ds_read_b64_tr_b16 v[50:51], v10 offset:6400
  v_mfma_f32_16x16x32_bf16 v[104:107], v[56:59], v[32:35], v[104:107]
  ds_read_b64_tr_b16 v[52:53], v10 offset:5152
  v_mfma_f32_16x16x32_bf16 v[108:111], v[56:59], v[36:39], v[108:111]
  ds_read_b64_tr_b16 v[54:55], v10 offset:6432
  s_waitcnt lgkmcnt(12)
  v_mfma_f32_16x16x32_bf16 v[112:115], v[60:63], v[32:35], v[112:115]
  ds_read_b64_tr_b16 v[56:57], v10 offset:5184
  v_mfma_f32_16x16x32_bf16 v[116:119], v[60:63], v[36:39], v[116:119]
  ds_read_b64_tr_b16 v[58:59], v10 offset:6464
  v_mfma_f32_16x16x32_bf16 v[120:123], v[64:67], v[32:35], v[120:123]
  ds_read_b64_tr_b16 v[60:61], v10 offset:5216
  v_mfma_f32_16x16x32_bf16 v[124:127], v[64:67], v[36:39], v[124:127]
  ds_read_b64_tr_b16 v[62:63], v10 offset:6496
  v_mfma_f32_16x16x32_bf16 v[128:131], v[68:71], v[32:35], v[128:131]
  ds_read_b64_tr_b16 v[64:65], v10 offset:5248
  v_mfma_f32_16x16x32_bf16 v[132:135], v[68:71], v[36:39], v[132:135]
  ds_read_b64_tr_b16 v[66:67], v10 offset:6528
  s_waitcnt lgkmcnt(12)
  v_mfma_f32_16x16x32_bf16 v[136:139], v[72:75], v[32:35], v[136:139]
  ds_read_b64_tr_b16 v[68:69], v10 offset:15360
  v_mfma_f32_16x16x32_bf16 v[140:143], v[72:75], v[36:39], v[140:143]
  ds_read_b64_tr_b16 v[70:71], v10 offset:16640
  v_mfma_f32_16x16x32_bf16 v[144:147], v[76:79], v[32:35], v[144:147]
  ds_read_b64_tr_b16 v[72:73], v10 offset:15392
  v_mfma_f32_16x16x32_bf16 v[148:151], v[76:79], v[36:39], v[148:151]
  ds_read_b64_tr_b16 v[74:75], v10 offset:16672
  v_mfma_f32_16x16x32_bf16 v[152:155], v[80:83], v[32:35], v[152:155]
  ds_read_b64_tr_b16 v[76:77], v10 offset:15424
  v_mfma_f32_16x16x32_bf16 v[156:159], v[80:83], v[36:39], v[156:159]
  ds_read_b64_tr_b16 v[78:79], v10 offset:16704
  s_waitcnt lgkmcnt(15)
  v_mfma_f32_16x16x32_bf16 v[160:163], v[84:87], v[32:35], v[160:163]
  ds_read_b64_tr_b16 v[80:81], v10 offset:15456
  v_mfma_f32_16x16x32_bf16 v[164:167], v[84:87], v[36:39], v[164:167]
  ds_read_b64_tr_b16 v[82:83], v10 offset:16736
  s_barrier
  v_mfma_f32_16x16x32_bf16 v[168:171], v[6:9], v[40:43], v[168:171]
  ds_read_b128 v[16:19], v14 offset:0
  v_mfma_f32_16x16x32_bf16 v[176:179], v[40:43], v[40:43], v[176:179]
  ds_read_b128 v[24:27], v15 offset:0
  v_mfma_f32_16x16x32_bf16 v[172:175], v[6:9], v[44:47], v[172:175]
  ds_read_b128 v[20:23], v14 offset:2048
  v_mfma_f32_16x16x32_bf16 v[180:183], v[44:47], v[44:47], v[180:183]
  ds_read_b128 v[28:31], v15 offset:2048
  s_waitcnt lgkmcnt(15)
  v_mfma_f32_16x16x32_bf16 v[88:91], v[48:51], v[40:43], v[88:91]
  ds_read_b64_tr_b16 v[84:85], v10 offset:15488
  v_mfma_f32_16x16x32_bf16 v[92:95], v[48:51], v[44:47], v[92:95]
  ds_read_b64_tr_b16 v[86:87], v10 offset:16768
  v_mfma_f32_16x16x32_bf16 v[96:99], v[52:55], v[40:43], v[96:99]
  ds_read_b64_tr_b16 v[48:49], v10 offset:20480
  v_mfma_f32_16x16x32_bf16 v[100:103], v[52:55], v[44:47], v[100:103]
  ds_read_b64_tr_b16 v[50:51], v10 offset:21760
  v_mfma_f32_16x16x32_bf16 v[104:107], v[56:59], v[40:43], v[104:107]
  ds_read_b64_tr_b16 v[52:53], v10 offset:20512
  v_mfma_f32_16x16x32_bf16 v[108:111], v[56:59], v[44:47], v[108:111]
  ds_read_b64_tr_b16 v[54:55], v10 offset:21792
  s_waitcnt lgkmcnt(15)
  v_mfma_f32_16x16x32_bf16 v[112:115], v[60:63], v[40:43], v[112:115]
  ds_read_b64_tr_b16 v[56:57], v10 offset:20544
  v_mfma_f32_16x16x32_bf16 v[116:119], v[60:63], v[44:47], v[116:119]
  ds_read_b64_tr_b16 v[58:59], v10 offset:21824
  v_mfma_f32_16x16x32_bf16 v[120:123], v[64:67], v[40:43], v[120:123]
  ds_read_b64_tr_b16 v[60:61], v10 offset:20576
  v_mfma_f32_16x16x32_bf16 v[124:127], v[64:67], v[44:47], v[124:127]
  ds_read_b64_tr_b16 v[62:63], v10 offset:21856
  v_mfma_f32_16x16x32_bf16 v[128:131], v[68:71], v[40:43], v[128:131]
  ds_read_b64_tr_b16 v[64:65], v10 offset:20608
  v_mfma_f32_16x16x32_bf16 v[132:135], v[68:71], v[44:47], v[132:135]
  ds_read_b64_tr_b16 v[66:67], v10 offset:21888
  s_waitcnt lgkmcnt(15)
  v_mfma_f32_16x16x32_bf16 v[136:139], v[72:75], v[40:43], v[136:139]
  ds_read_b64_tr_b16 v[68:69], v10 offset:30720
  v_mfma_f32_16x16x32_bf16 v[140:143], v[72:75], v[44:47], v[140:143]
  ds_read_b64_tr_b16 v[70:71], v10 offset:32000
  v_mfma_f32_16x16x32_bf16 v[144:147], v[76:79], v[40:43], v[144:147]
  ds_read_b64_tr_b16 v[72:73], v10 offset:30752
  v_mfma_f32_16x16x32_bf16 v[148:151], v[76:79], v[44:47], v[148:151]
  ds_read_b64_tr_b16 v[74:75], v10 offset:32032
  v_mfma_f32_16x16x32_bf16 v[152:155], v[80:83], v[40:43], v[152:155]
  ds_read_b64_tr_b16 v[76:77], v10 offset:30784
  v_mfma_f32_16x16x32_bf16 v[156:159], v[80:83], v[44:47], v[156:159]
  ds_read_b64_tr_b16 v[78:79], v10 offset:32064
  s_waitcnt lgkmcnt(15)
  v_mfma_f32_16x16x32_bf16 v[160:163], v[84:87], v[40:43], v[160:163]
  ds_read_b64_tr_b16 v[80:81], v10 offset:30816
  v_mfma_f32_16x16x32_bf16 v[164:167], v[84:87], v[44:47], v[164:167]
  ds_read_b64_tr_b16 v[82:83], v10 offset:32096
  v_mfma_f32_16x16x32_bf16 v[168:171], v[6:9], v[16:19], v[168:171]
  v_mfma_f32_16x16x32_bf16 v[176:179], v[16:19], v[16:19], v[176:179]
  v_mfma_f32_16x16x32_bf16 v[172:175], v[6:9], v[20:23], v[172:175]
  v_mfma_f32_16x16x32_bf16 v[180:183], v[20:23], v[20:23], v[180:183]
  s_waitcnt lgkmcnt(12)
  v_mfma_f32_16x16x32_bf16 v[88:91], v[48:51], v[16:19], v[88:91]
  ds_read_b64_tr_b16 v[84:85], v10 offset:30848
  v_mfma_f32_16x16x32_bf16 v[92:95], v[48:51], v[20:23], v[92:95]
  ds_read_b64_tr_b16 v[86:87], v10 offset:32128
  v_mfma_f32_16x16x32_bf16 v[96:99], v[52:55], v[16:19], v[96:99]
  ds_read_b64_tr_b16 v[48:49], v10 offset:25600
  v_mfma_f32_16x16x32_bf16 v[100:103], v[52:55], v[20:23], v[100:103]
  ds_read_b64_tr_b16 v[50:51], v10 offset:26880
  v_mfma_f32_16x16x32_bf16 v[104:107], v[56:59], v[16:19], v[104:107]
  ds_read_b64_tr_b16 v[52:53], v10 offset:25632
  v_mfma_f32_16x16x32_bf16 v[108:111], v[56:59], v[20:23], v[108:111]
  ds_read_b64_tr_b16 v[54:55], v10 offset:26912
  s_waitcnt lgkmcnt(12)
  v_mfma_f32_16x16x32_bf16 v[112:115], v[60:63], v[16:19], v[112:115]
  ds_read_b64_tr_b16 v[56:57], v10 offset:25664
  v_mfma_f32_16x16x32_bf16 v[116:119], v[60:63], v[20:23], v[116:119]
  ds_read_b64_tr_b16 v[58:59], v10 offset:26944
  v_mfma_f32_16x16x32_bf16 v[120:123], v[64:67], v[16:19], v[120:123]
  ds_read_b64_tr_b16 v[60:61], v10 offset:25696
  v_mfma_f32_16x16x32_bf16 v[124:127], v[64:67], v[20:23], v[124:127]
  ds_read_b64_tr_b16 v[62:63], v10 offset:26976
  v_mfma_f32_16x16x32_bf16 v[128:131], v[68:71], v[16:19], v[128:131]
  ds_read_b64_tr_b16 v[64:65], v10 offset:25728
  v_mfma_f32_16x16x32_bf16 v[132:135], v[68:71], v[20:23], v[132:135]
  ds_read_b64_tr_b16 v[66:67], v10 offset:27008
  s_waitcnt lgkmcnt(12)
  v_mfma_f32_16x16x32_bf16 v[136:139], v[72:75], v[16:19], v[136:139]
  ds_read_b64_tr_b16 v[68:69], v10 offset:35840
  v_mfma_f32_16x16x32_bf16 v[140:143], v[72:75], v[20:23], v[140:143]
  ds_read_b64_tr_b16 v[70:71], v10 offset:37120
  v_mfma_f32_16x16x32_bf16 v[144:147], v[76:79], v[16:19], v[144:147]
  ds_read_b64_tr_b16 v[72:73], v10 offset:35872
  v_mfma_f32_16x16x32_bf16 v[148:151], v[76:79], v[20:23], v[148:151]
  ds_read_b64_tr_b16 v[74:75], v10 offset:37152
  v_mfma_f32_16x16x32_bf16 v[152:155], v[80:83], v[16:19], v[152:155]
  ds_read_b64_tr_b16 v[76:77], v10 offset:35904
  v_mfma_f32_16x16x32_bf16 v[156:159], v[80:83], v[20:23], v[156:159]
  ds_read_b64_tr_b16 v[78:79], v10 offset:37184
  s_waitcnt lgkmcnt(15)
  v_mfma_f32_16x16x32_bf16 v[160:163], v[84:87], v[16:19], v[160:163]
  ds_read_b64_tr_b16 v[80:81], v10 offset:35936
  v_mfma_f32_16x16x32_bf16 v[164:167], v[84:87], v[20:23], v[164:167]
  ds_read_b64_tr_b16 v[82:83], v10 offset:37216
  s_barrier
  v_mfma_f32_16x16x32_bf16 v[168:171], v[6:9], v[24:27], v[168:171]
  ds_read_b128 v[32:35], v14 offset:16384
  v_mfma_f32_16x16x32_bf16 v[176:179], v[24:27], v[24:27], v[176:179]
  ds_read_b128 v[40:43], v15 offset:16384
  v_mfma_f32_16x16x32_bf16 v[172:175], v[6:9], v[28:31], v[172:175]
  ds_read_b128 v[36:39], v14 offset:18432
  v_mfma_f32_16x16x32_bf16 v[180:183], v[28:31], v[28:31], v[180:183]
  ds_read_b128 v[44:47], v15 offset:18432
  s_waitcnt lgkmcnt(15)
  v_mfma_f32_16x16x32_bf16 v[88:91], v[48:51], v[24:27], v[88:91]
  ds_read_b64_tr_b16 v[84:85], v10 offset:35968
  v_mfma_f32_16x16x32_bf16 v[92:95], v[48:51], v[28:31], v[92:95]
  ds_read_b64_tr_b16 v[86:87], v10 offset:37248
  v_mfma_f32_16x16x32_bf16 v[96:99], v[52:55], v[24:27], v[96:99]
  ds_read_b64_tr_b16 v[48:49], v10 offset:40960
  v_mfma_f32_16x16x32_bf16 v[100:103], v[52:55], v[28:31], v[100:103]
  ds_read_b64_tr_b16 v[50:51], v10 offset:42240
  v_mfma_f32_16x16x32_bf16 v[104:107], v[56:59], v[24:27], v[104:107]
  ds_read_b64_tr_b16 v[52:53], v10 offset:40992
  v_mfma_f32_16x16x32_bf16 v[108:111], v[56:59], v[28:31], v[108:111]
  ds_read_b64_tr_b16 v[54:55], v10 offset:42272
  s_waitcnt lgkmcnt(15)
  v_mfma_f32_16x16x32_bf16 v[112:115], v[60:63], v[24:27], v[112:115]
  ds_read_b64_tr_b16 v[56:57], v10 offset:41024
  v_mfma_f32_16x16x32_bf16 v[116:119], v[60:63], v[28:31], v[116:119]
  ds_read_b64_tr_b16 v[58:59], v10 offset:42304
  v_mfma_f32_16x16x32_bf16 v[120:123], v[64:67], v[24:27], v[120:123]
  ds_read_b64_tr_b16 v[60:61], v10 offset:41056
  v_mfma_f32_16x16x32_bf16 v[124:127], v[64:67], v[28:31], v[124:127]
  ds_read_b64_tr_b16 v[62:63], v10 offset:42336
  v_mfma_f32_16x16x32_bf16 v[128:131], v[68:71], v[24:27], v[128:131]
  ds_read_b64_tr_b16 v[64:65], v10 offset:41088
  v_mfma_f32_16x16x32_bf16 v[132:135], v[68:71], v[28:31], v[132:135]
  ds_read_b64_tr_b16 v[66:67], v10 offset:42368
  s_waitcnt lgkmcnt(15)
  v_mfma_f32_16x16x32_bf16 v[136:139], v[72:75], v[24:27], v[136:139]
  ds_read_b64_tr_b16 v[68:69], v10 offset:51200
  v_mfma_f32_16x16x32_bf16 v[140:143], v[72:75], v[28:31], v[140:143]
  ds_read_b64_tr_b16 v[70:71], v10 offset:52480
  v_mfma_f32_16x16x32_bf16 v[144:147], v[76:79], v[24:27], v[144:147]
  ds_read_b64_tr_b16 v[72:73], v10 offset:51232
  v_mfma_f32_16x16x32_bf16 v[148:151], v[76:79], v[28:31], v[148:151]
  ds_read_b64_tr_b16 v[74:75], v10 offset:52512
  v_mfma_f32_16x16x32_bf16 v[152:155], v[80:83], v[24:27], v[152:155]
  ds_read_b64_tr_b16 v[76:77], v10 offset:51264
  v_mfma_f32_16x16x32_bf16 v[156:159], v[80:83], v[28:31], v[156:159]
  ds_read_b64_tr_b16 v[78:79], v10 offset:52544
  s_waitcnt lgkmcnt(15)
  v_mfma_f32_16x16x32_bf16 v[160:163], v[84:87], v[24:27], v[160:163]
  ds_read_b64_tr_b16 v[80:81], v10 offset:51296
  v_mfma_f32_16x16x32_bf16 v[164:167], v[84:87], v[28:31], v[164:167]
  ds_read_b64_tr_b16 v[82:83], v10 offset:52576
  v_mfma_f32_16x16x32_bf16 v[168:171], v[6:9], v[32:35], v[168:171]
  v_mfma_f32_16x16x32_bf16 v[176:179], v[32:35], v[32:35], v[176:179]
  v_mfma_f32_16x16x32_bf16 v[172:175], v[6:9], v[36:39], v[172:175]
  v_mfma_f32_16x16x32_bf16 v[180:183], v[36:39], v[36:39], v[180:183]
  s_waitcnt lgkmcnt(12)
  v_mfma_f32_16x16x32_bf16 v[88:91], v[48:51], v[32:35], v[88:91]
  ds_read_b64_tr_b16 v[84:85], v10 offset:51328
  v_mfma_f32_16x16x32_bf16 v[92:95], v[48:51], v[36:39], v[92:95]
  ds_read_b64_tr_b16 v[86:87], v10 offset:52608
  v_mfma_f32_16x16x32_bf16 v[96:99], v[52:55], v[32:35], v[96:99]
  ds_read_b64_tr_b16 v[48:49], v10 offset:46080
  v_mfma_f32_16x16x32_bf16 v[100:103], v[52:55], v[36:39], v[100:103]
  ds_read_b64_tr_b16 v[50:51], v10 offset:47360
  v_mfma_f32_16x16x32_bf16 v[104:107], v[56:59], v[32:35], v[104:107]
  ds_read_b64_tr_b16 v[52:53], v10 offset:46112
  v_mfma_f32_16x16x32_bf16 v[108:111], v[56:59], v[36:39], v[108:111]
  ds_read_b64_tr_b16 v[54:55], v10 offset:47392
  s_waitcnt lgkmcnt(12)
  v_mfma_f32_16x16x32_bf16 v[112:115], v[60:63], v[32:35], v[112:115]
  ds_read_b64_tr_b16 v[56:57], v10 offset:46144
  v_mfma_f32_16x16x32_bf16 v[116:119], v[60:63], v[36:39], v[116:119]
  ds_read_b64_tr_b16 v[58:59], v10 offset:47424
  v_mfma_f32_16x16x32_bf16 v[120:123], v[64:67], v[32:35], v[120:123]
  ds_read_b64_tr_b16 v[60:61], v10 offset:46176
  v_mfma_f32_16x16x32_bf16 v[124:127], v[64:67], v[36:39], v[124:127]
  ds_read_b64_tr_b16 v[62:63], v10 offset:47456
  v_mfma_f32_16x16x32_bf16 v[128:131], v[68:71], v[32:35], v[128:131]
  ds_read_b64_tr_b16 v[64:65], v10 offset:46208
  v_mfma_f32_16x16x32_bf16 v[132:135], v[68:71], v[36:39], v[132:135]
  ds_read_b64_tr_b16 v[66:67], v10 offset:47488
  s_waitcnt lgkmcnt(12)
  v_mfma_f32_16x16x32_bf16 v[136:139], v[72:75], v[32:35], v[136:139]
  ds_read_b64_tr_b16 v[68:69], v10 offset:56320
  v_mfma_f32_16x16x32_bf16 v[140:143], v[72:75], v[36:39], v[140:143]
  ds_read_b64_tr_b16 v[70:71], v10 offset:57600
  v_mfma_f32_16x16x32_bf16 v[144:147], v[76:79], v[32:35], v[144:147]
  ds_read_b64_tr_b16 v[72:73], v10 offset:56352
  v_mfma_f32_16x16x32_bf16 v[148:151], v[76:79], v[36:39], v[148:151]
  ds_read_b64_tr_b16 v[74:75], v10 offset:57632
  v_mfma_f32_16x16x32_bf16 v[152:155], v[80:83], v[32:35], v[152:155]
  ds_read_b64_tr_b16 v[76:77], v10 offset:56384
  v_mfma_f32_16x16x32_bf16 v[156:159], v[80:83], v[36:39], v[156:159]
  ds_read_b64_tr_b16 v[78:79], v10 offset:57664
  s_waitcnt lgkmcnt(15)
  v_mfma_f32_16x16x32_bf16 v[160:163], v[84:87], v[32:35], v[160:163]
  ds_read_b64_tr_b16 v[80:81], v10 offset:56416
  v_mfma_f32_16x16x32_bf16 v[164:167], v[84:87], v[36:39], v[164:167]
  ds_read_b64_tr_b16 v[82:83], v10 offset:57696
  s_barrier
  v_mfma_f32_16x16x32_bf16 v[168:171], v[6:9], v[40:43], v[168:171]
  ds_read_b128 v[16:19], v14 offset:32768
  v_mfma_f32_16x16x32_bf16 v[176:179], v[40:43], v[40:43], v[176:179]
  ds_read_b128 v[24:27], v15 offset:32768
  v_mfma_f32_16x16x32_bf16 v[172:175], v[6:9], v[44:47], v[172:175]
  ds_read_b128 v[20:23], v14 offset:34816
  v_mfma_f32_16x16x32_bf16 v[180:183], v[44:47], v[44:47], v[180:183]
  ds_read_b128 v[28:31], v15 offset:34816
  s_waitcnt lgkmcnt(15)
  v_mfma_f32_16x16x32_bf16 v[88:91], v[48:51], v[40:43], v[88:91]
  ds_read_b64_tr_b16 v[84:85], v10 offset:56448
  v_mfma_f32_16x16x32_bf16 v[92:95], v[48:51], v[44:47], v[92:95]
  ds_read_b64_tr_b16 v[86:87], v10 offset:57728
  v_mfma_f32_16x16x32_bf16 v[96:99], v[52:55], v[40:43], v[96:99]
  ds_read_b64_tr_b16 v[48:49], v11 offset:0
  v_mfma_f32_16x16x32_bf16 v[100:103], v[52:55], v[44:47], v[100:103]
  ds_read_b64_tr_b16 v[50:51], v11 offset:1280
  v_mfma_f32_16x16x32_bf16 v[104:107], v[56:59], v[40:43], v[104:107]
  ds_read_b64_tr_b16 v[52:53], v11 offset:32
  v_mfma_f32_16x16x32_bf16 v[108:111], v[56:59], v[44:47], v[108:111]
  ds_read_b64_tr_b16 v[54:55], v11 offset:1312
  s_waitcnt lgkmcnt(15)
  v_mfma_f32_16x16x32_bf16 v[112:115], v[60:63], v[40:43], v[112:115]
  ds_read_b64_tr_b16 v[56:57], v11 offset:64
  v_mfma_f32_16x16x32_bf16 v[116:119], v[60:63], v[44:47], v[116:119]
  ds_read_b64_tr_b16 v[58:59], v11 offset:1344
  v_mfma_f32_16x16x32_bf16 v[120:123], v[64:67], v[40:43], v[120:123]
  ds_read_b64_tr_b16 v[60:61], v11 offset:96
  v_mfma_f32_16x16x32_bf16 v[124:127], v[64:67], v[44:47], v[124:127]
  ds_read_b64_tr_b16 v[62:63], v11 offset:1376
  v_mfma_f32_16x16x32_bf16 v[128:131], v[68:71], v[40:43], v[128:131]
  ds_read_b64_tr_b16 v[64:65], v11 offset:128
  v_mfma_f32_16x16x32_bf16 v[132:135], v[68:71], v[44:47], v[132:135]
  ds_read_b64_tr_b16 v[66:67], v11 offset:1408
  s_waitcnt lgkmcnt(15)
  v_mfma_f32_16x16x32_bf16 v[136:139], v[72:75], v[40:43], v[136:139]
  ds_read_b64_tr_b16 v[68:69], v11 offset:10240
  v_mfma_f32_16x16x32_bf16 v[140:143], v[72:75], v[44:47], v[140:143]
  ds_read_b64_tr_b16 v[70:71], v11 offset:11520
  v_mfma_f32_16x16x32_bf16 v[144:147], v[76:79], v[40:43], v[144:147]
  ds_read_b64_tr_b16 v[72:73], v11 offset:10272
  v_mfma_f32_16x16x32_bf16 v[148:151], v[76:79], v[44:47], v[148:151]
  ds_read_b64_tr_b16 v[74:75], v11 offset:11552
  v_mfma_f32_16x16x32_bf16 v[152:155], v[80:83], v[40:43], v[152:155]
  ds_read_b64_tr_b16 v[76:77], v11 offset:10304
  v_mfma_f32_16x16x32_bf16 v[156:159], v[80:83], v[44:47], v[156:159]
  ds_read_b64_tr_b16 v[78:79], v11 offset:11584
  s_waitcnt lgkmcnt(15)
  v_mfma_f32_16x16x32_bf16 v[160:163], v[84:87], v[40:43], v[160:163]
  ds_read_b64_tr_b16 v[80:81], v11 offset:10336
  v_mfma_f32_16x16x32_bf16 v[164:167], v[84:87], v[44:47], v[164:167]
  ds_read_b64_tr_b16 v[82:83], v11 offset:11616
  v_mfma_f32_16x16x32_bf16 v[168:171], v[6:9], v[16:19], v[168:171]
  v_mfma_f32_16x16x32_bf16 v[176:179], v[16:19], v[16:19], v[176:179]
  v_mfma_f32_16x16x32_bf16 v[172:175], v[6:9], v[20:23], v[172:175]
  v_mfma_f32_16x16x32_bf16 v[180:183], v[20:23], v[20:23], v[180:183]
  s_waitcnt lgkmcnt(12)
  v_mfma_f32_16x16x32_bf16 v[88:91], v[48:51], v[16:19], v[88:91]
  ds_read_b64_tr_b16 v[84:85], v11 offset:10368
  v_mfma_f32_16x16x32_bf16 v[92:95], v[48:51], v[20:23], v[92:95]
  ds_read_b64_tr_b16 v[86:87], v11 offset:11648
  v_mfma_f32_16x16x32_bf16 v[96:99], v[52:55], v[16:19], v[96:99]
  ds_read_b64_tr_b16 v[48:49], v11 offset:5120
  v_mfma_f32_16x16x32_bf16 v[100:103], v[52:55], v[20:23], v[100:103]
  ds_read_b64_tr_b16 v[50:51], v11 offset:6400
  v_mfma_f32_16x16x32_bf16 v[104:107], v[56:59], v[16:19], v[104:107]
  ds_read_b64_tr_b16 v[52:53], v11 offset:5152
  v_mfma_f32_16x16x32_bf16 v[108:111], v[56:59], v[20:23], v[108:111]
  ds_read_b64_tr_b16 v[54:55], v11 offset:6432
  s_waitcnt lgkmcnt(12)
  v_mfma_f32_16x16x32_bf16 v[112:115], v[60:63], v[16:19], v[112:115]
  ds_read_b64_tr_b16 v[56:57], v11 offset:5184
  v_mfma_f32_16x16x32_bf16 v[116:119], v[60:63], v[20:23], v[116:119]
  ds_read_b64_tr_b16 v[58:59], v11 offset:6464
  v_mfma_f32_16x16x32_bf16 v[120:123], v[64:67], v[16:19], v[120:123]
  ds_read_b64_tr_b16 v[60:61], v11 offset:5216
  v_mfma_f32_16x16x32_bf16 v[124:127], v[64:67], v[20:23], v[124:127]
  ds_read_b64_tr_b16 v[62:63], v11 offset:6496
  v_mfma_f32_16x16x32_bf16 v[128:131], v[68:71], v[16:19], v[128:131]
  ds_read_b64_tr_b16 v[64:65], v11 offset:5248
  v_mfma_f32_16x16x32_bf16 v[132:135], v[68:71], v[20:23], v[132:135]
  ds_read_b64_tr_b16 v[66:67], v11 offset:6528
  s_waitcnt lgkmcnt(12)
  v_mfma_f32_16x16x32_bf16 v[136:139], v[72:75], v[16:19], v[136:139]
  ds_read_b64_tr_b16 v[68:69], v11 offset:15360
  v_mfma_f32_16x16x32_bf16 v[140:143], v[72:75], v[20:23], v[140:143]
  ds_read_b64_tr_b16 v[70:71], v11 offset:16640
  v_mfma_f32_16x16x32_bf16 v[144:147], v[76:79], v[16:19], v[144:147]
  ds_read_b64_tr_b16 v[72:73], v11 offset:15392
  v_mfma_f32_16x16x32_bf16 v[148:151], v[76:79], v[20:23], v[148:151]
  ds_read_b64_tr_b16 v[74:75], v11 offset:16672
  v_mfma_f32_16x16x32_bf16 v[152:155], v[80:83], v[16:19], v[152:155]
  ds_read_b64_tr_b16 v[76:77], v11 offset:15424
  v_mfma_f32_16x16x32_bf16 v[156:159], v[80:83], v[20:23], v[156:159]
  ds_read_b64_tr_b16 v[78:79], v11 offset:16704
  s_waitcnt lgkmcnt(15)
  v_mfma_f32_16x16x32_bf16 v[160:163], v[84:87], v[16:19], v[160:163]
  ds_read_b64_tr_b16 v[80:81], v11 offset:15456
  v_mfma_f32_16x16x32_bf16 v[164:167], v[84:87], v[20:23], v[164:167]
  ds_read_b64_tr_b16 v[82:83], v11 offset:16736
  s_barrier
  v_mfma_f32_16x16x32_bf16 v[168:171], v[6:9], v[24:27], v[168:171]
  ds_read_b128 v[32:35], v14 offset:0
  v_mfma_f32_16x16x32_bf16 v[176:179], v[24:27], v[24:27], v[176:179]
  ds_read_b128 v[40:43], v15 offset:0
  v_mfma_f32_16x16x32_bf16 v[172:175], v[6:9], v[28:31], v[172:175]
  ds_read_b128 v[36:39], v14 offset:2048
  v_mfma_f32_16x16x32_bf16 v[180:183], v[28:31], v[28:31], v[180:183]
  ds_read_b128 v[44:47], v15 offset:2048
  s_waitcnt lgkmcnt(15)
  v_mfma_f32_16x16x32_bf16 v[88:91], v[48:51], v[24:27], v[88:91]
  ds_read_b64_tr_b16 v[84:85], v11 offset:15488
  v_mfma_f32_16x16x32_bf16 v[92:95], v[48:51], v[28:31], v[92:95]
  ds_read_b64_tr_b16 v[86:87], v11 offset:16768
  v_mfma_f32_16x16x32_bf16 v[96:99], v[52:55], v[24:27], v[96:99]
  ds_read_b64_tr_b16 v[48:49], v11 offset:20480
  v_mfma_f32_16x16x32_bf16 v[100:103], v[52:55], v[28:31], v[100:103]
  ds_read_b64_tr_b16 v[50:51], v11 offset:21760
  v_mfma_f32_16x16x32_bf16 v[104:107], v[56:59], v[24:27], v[104:107]
  ds_read_b64_tr_b16 v[52:53], v11 offset:20512
  v_mfma_f32_16x16x32_bf16 v[108:111], v[56:59], v[28:31], v[108:111]
  ds_read_b64_tr_b16 v[54:55], v11 offset:21792
  s_waitcnt lgkmcnt(15)
  v_mfma_f32_16x16x32_bf16 v[112:115], v[60:63], v[24:27], v[112:115]
  ds_read_b64_tr_b16 v[56:57], v11 offset:20544
  v_mfma_f32_16x16x32_bf16 v[116:119], v[60:63], v[28:31], v[116:119]
  ds_read_b64_tr_b16 v[58:59], v11 offset:21824
  v_mfma_f32_16x16x32_bf16 v[120:123], v[64:67], v[24:27], v[120:123]
  ds_read_b64_tr_b16 v[60:61], v11 offset:20576
  v_mfma_f32_16x16x32_bf16 v[124:127], v[64:67], v[28:31], v[124:127]
  ds_read_b64_tr_b16 v[62:63], v11 offset:21856
  v_mfma_f32_16x16x32_bf16 v[128:131], v[68:71], v[24:27], v[128:131]
  ds_read_b64_tr_b16 v[64:65], v11 offset:20608
  v_mfma_f32_16x16x32_bf16 v[132:135], v[68:71], v[28:31], v[132:135]
  ds_read_b64_tr_b16 v[66:67], v11 offset:21888
  s_waitcnt lgkmcnt(15)
  v_mfma_f32_16x16x32_bf16 v[136:139], v[72:75], v[24:27], v[136:139]
  ds_read_b64_tr_b16 v[68:69], v11 offset:30720
  v_mfma_f32_16x16x32_bf16 v[140:143], v[72:75], v[28:31], v[140:143]
  ds_read_b64_tr_b16 v[70:71], v11 offset:32000
  v_mfma_f32_16x16x32_bf16 v[144:147], v[76:79], v[24:27], v[144:147]
  ds_read_b64_tr_b16 v[72:73], v11 offset:30752
  v_mfma_f32_16x16x32_bf16 v[148:151], v[76:79], v[28:31], v[148:151]
  ds_read_b64_tr_b16 v[74:75], v11 offset:32032
  v_mfma_f32_16x16x32_bf16 v[152:155], v[80:83], v[24:27], v[152:155]
  ds_read_b64_tr_b16 v[76:77], v11 offset:30784
  v_mfma_f32_16x16x32_bf16 v[156:159], v[80:83], v[28:31], v[156:159]
  ds_read_b64_tr_b16 v[78:79], v11 offset:32064
  s_waitcnt lgkmcnt(15)
  v_mfma_f32_16x16x32_bf16 v[160:163], v[84:87], v[24:27], v[160:163]
  ds_read_b64_tr_b16 v[80:81], v11 offset:30816
  v_mfma_f32_16x16x32_bf16 v[164:167], v[84:87], v[28:31], v[164:167]
  ds_read_b64_tr_b16 v[82:83], v11 offset:32096
  v_mfma_f32_16x16x32_bf16 v[168:171], v[6:9], v[32:35], v[168:171]
  v_mfma_f32_16x16x32_bf16 v[176:179], v[32:35], v[32:35], v[176:179]
  v_mfma_f32_16x16x32_bf16 v[172:175], v[6:9], v[36:39], v[172:175]
  v_mfma_f32_16x16x32_bf16 v[180:183], v[36:39], v[36:39], v[180:183]
  s_waitcnt lgkmcnt(12)
  v_mfma_f32_16x16x32_bf16 v[88:91], v[48:51], v[32:35], v[88:91]
  ds_read_b64_tr_b16 v[84:85], v11 offset:30848
  v_mfma_f32_16x16x32_bf16 v[92:95], v[48:51], v[36:39], v[92:95]
  ds_read_b64_tr_b16 v[86:87], v11 offset:32128
  v_mfma_f32_16x16x32_bf16 v[96:99], v[52:55], v[32:35], v[96:99]
  ds_read_b64_tr_b16 v[48:49], v11 offset:25600
  v_mfma_f32_16x16x32_bf16 v[100:103], v[52:55], v[36:39], v[100:103]
  ds_read_b64_tr_b16 v[50:51], v11 offset:26880
  v_mfma_f32_16x16x32_bf16 v[104:107], v[56:59], v[32:35], v[104:107]
  ds_read_b64_tr_b16 v[52:53], v11 offset:25632
  v_mfma_f32_16x16x32_bf16 v[108:111], v[56:59], v[36:39], v[108:111]
  ds_read_b64_tr_b16 v[54:55], v11 offset:26912
  s_waitcnt lgkmcnt(12)
  v_mfma_f32_16x16x32_bf16 v[112:115], v[60:63], v[32:35], v[112:115]
  ds_read_b64_tr_b16 v[56:57], v11 offset:25664
  v_mfma_f32_16x16x32_bf16 v[116:119], v[60:63], v[36:39], v[116:119]
  ds_read_b64_tr_b16 v[58:59], v11 offset:26944
  v_mfma_f32_16x16x32_bf16 v[120:123], v[64:67], v[32:35], v[120:123]
  ds_read_b64_tr_b16 v[60:61], v11 offset:25696
  v_mfma_f32_16x16x32_bf16 v[124:127], v[64:67], v[36:39], v[124:127]
  ds_read_b64_tr_b16 v[62:63], v11 offset:26976
  v_mfma_f32_16x16x32_bf16 v[128:131], v[68:71], v[32:35], v[128:131]
  ds_read_b64_tr_b16 v[64:65], v11 offset:25728
  v_mfma_f32_16x16x32_bf16 v[132:135], v[68:71], v[36:39], v[132:135]
  ds_read_b64_tr_b16 v[66:67], v11 offset:27008
  s_waitcnt lgkmcnt(12)
  v_mfma_f32_16x16x32_bf16 v[136:139], v[72:75], v[32:35], v[136:139]
  ds_read_b64_tr_b16 v[68:69], v11 offset:35840
  v_mfma_f32_16x16x32_bf16 v[140:143], v[72:75], v[36:39], v[140:143]
  ds_read_b64_tr_b16 v[70:71], v11 offset:37120
  v_mfma_f32_16x16x32_bf16 v[144:147], v[76:79], v[32:35], v[144:147]
  ds_read_b64_tr_b16 v[72:73], v11 offset:35872
  v_mfma_f32_16x16x32_bf16 v[148:151], v[76:79], v[36:39], v[148:151]
  ds_read_b64_tr_b16 v[74:75], v11 offset:37152
  v_mfma_f32_16x16x32_bf16 v[152:155], v[80:83], v[32:35], v[152:155]
  ds_read_b64_tr_b16 v[76:77], v11 offset:35904
  v_mfma_f32_16x16x32_bf16 v[156:159], v[80:83], v[36:39], v[156:159]
  ds_read_b64_tr_b16 v[78:79], v11 offset:37184
  s_waitcnt lgkmcnt(15)
  v_mfma_f32_16x16x32_bf16 v[160:163], v[84:87], v[32:35], v[160:163]
  ds_read_b64_tr_b16 v[80:81], v11 offset:35936
  v_mfma_f32_16x16x32_bf16 v[164:167], v[84:87], v[36:39], v[164:167]
  ds_read_b64_tr_b16 v[82:83], v11 offset:37216
  v_mfma_f32_16x16x32_bf16 v[168:171], v[6:9], v[40:43], v[168:171]
  v_mfma_f32_16x16x32_bf16 v[176:179], v[40:43], v[40:43], v[176:179]
  v_mfma_f32_16x16x32_bf16 v[172:175], v[6:9], v[44:47], v[172:175]
  v_mfma_f32_16x16x32_bf16 v[180:183], v[44:47], v[44:47], v[180:183]
  s_waitcnt lgkmcnt(12)
  v_mfma_f32_16x16x32_bf16 v[88:91], v[48:51], v[40:43], v[88:91]
  ds_read_b64_tr_b16 v[84:85], v11 offset:35968
  v_mfma_f32_16x16x32_bf16 v[92:95], v[48:51], v[44:47], v[92:95]
  ds_read_b64_tr_b16 v[86:87], v11 offset:37248
  v_mfma_f32_16x16x32_bf16 v[96:99], v[52:55], v[40:43], v[96:99]
  v_mfma_f32_16x16x32_bf16 v[100:103], v[52:55], v[44:47], v[100:103]
  v_mfma_f32_16x16x32_bf16 v[104:107], v[56:59], v[40:43], v[104:107]
  v_mfma_f32_16x16x32_bf16 v[108:111], v[56:59], v[44:47], v[108:111]
  s_waitcnt lgkmcnt(8)
  v_mfma_f32_16x16x32_bf16 v[112:115], v[60:63], v[40:43], v[112:115]
  v_mfma_f32_16x16x32_bf16 v[116:119], v[60:63], v[44:47], v[116:119]
  v_mfma_f32_16x16x32_bf16 v[120:123], v[64:67], v[40:43], v[120:123]
  v_mfma_f32_16x16x32_bf16 v[124:127], v[64:67], v[44:47], v[124:127]
  v_mfma_f32_16x16x32_bf16 v[128:131], v[68:71], v[40:43], v[128:131]
  v_mfma_f32_16x16x32_bf16 v[132:135], v[68:71], v[44:47], v[132:135]
  s_waitcnt lgkmcnt(2)
  v_mfma_f32_16x16x32_bf16 v[136:139], v[72:75], v[40:43], v[136:139]
  v_mfma_f32_16x16x32_bf16 v[140:143], v[72:75], v[44:47], v[140:143]
  v_mfma_f32_16x16x32_bf16 v[144:147], v[76:79], v[40:43], v[144:147]
  v_mfma_f32_16x16x32_bf16 v[148:151], v[76:79], v[44:47], v[148:151]
  v_mfma_f32_16x16x32_bf16 v[152:155], v[80:83], v[40:43], v[152:155]
  v_mfma_f32_16x16x32_bf16 v[156:159], v[80:83], v[44:47], v[156:159]
  s_waitcnt lgkmcnt(0)
  v_mfma_f32_16x16x32_bf16 v[160:163], v[84:87], v[40:43], v[160:163]
  v_mfma_f32_16x16x32_bf16 v[164:167], v[84:87], v[44:47], v[164:167]
  s_barrier
  v_lshlrev_b32 v34, 4, v3
  v_add_u32 v34, 0x277c0, v34
  ds_read_b128 v[6:9], v34 offset:0
  ds_read_b128 v[14:17], v34 offset:64
  ds_read_b128 v[18:21], v34 offset:128
  ds_read_b128 v[22:25], v34 offset:192
  ds_read_b128 v[26:29], v34 offset:256
  ds_read_b128 v[30:33], v34 offset:320
  s_waitcnt lgkmcnt(0)
  v_pk_add_f32 v[26:27], v[26:27], v[30:31]
  v_pk_add_f32 v[28:29], v[28:29], v[32:33]
  v_and_b32 v38, 3, v2
  v_cmp_eq_u32 s[66:67], 1, v38
  v_cmp_eq_u32 s[68:69], 2, v38
  v_cmp_eq_u32 s[70:71], 3, v38
  v_lshrrev_b32 v39, 2, v2
  v_lshl_add_u32 v39, v39, 4, v2
  v_lshlrev_b32 v39, 2, v39
  v_mov_b32 v40, v176
  v_cndmask_b32 v40, v40, v177, s[66:67]
  v_cndmask_b32 v40, v40, v178, s[68:69]
  v_cndmask_b32 v40, v40, v179, s[70:71]
  ds_bpermute_b32 v40, v39, v40
  v_mul_f32 v30, 0xbacccccd, v168
  v_mov_b32 v41, v180
  v_cndmask_b32 v41, v41, v181, s[66:67]
  v_cndmask_b32 v41, v41, v182, s[68:69]
  v_cndmask_b32 v41, v41, v183, s[70:71]
  ds_bpermute_b32 v41, v39, v41
  v_mul_f32 v32, 0xbacccccd, v172
  s_lshl_b32 s72, s6, 8
  s_add_u32 s72, s72, 0x27c00
  v_lshl_add_u32 v42, v2, 3, s72
  s_waitcnt lgkmcnt(1)
  v_mul_f32 v40, 0x3acccccd, v40
  v_fma_f32 v40, -v30, v30, v40
  v_max_f32 v40, 0, v40
  v_add_f32 v38, 0x3727c5ac, v40
  v_rsq_f32 v34, v38
  s_nop 0
  v_mul_f32 v40, v40, v34
  v_fmaak_f32 v40, v40, v34, 0x3727c5ac
  v_rsq_f32 v40, v40
  s_nop 0
  v_mul_f32 v35, v40, v34
  v_mov_b32 v31, v34
  ds_write_b64 v42, v[30:31] offset:0
  s_waitcnt lgkmcnt(1)
  v_mul_f32 v41, 0x3acccccd, v41
  v_fma_f32 v41, -v32, v32, v41
  v_max_f32 v41, 0, v41
  v_add_f32 v38, 0x3727c5ac, v41
  v_rsq_f32 v36, v38
  s_nop 0
  v_mul_f32 v41, v41, v36
  v_fmaak_f32 v41, v41, v36, 0x3727c5ac
  v_rsq_f32 v41, v41
  s_nop 0
  v_mul_f32 v37, v41, v36
  v_mov_b32 v33, v36
  ds_write_b64 v42, v[32:33] offset:128
  v_pk_fma_f32 v[88:89], v[6:7], v[30:31], v[88:89] op_sel_hi:[1,0,1]
  v_pk_fma_f32 v[90:91], v[8:9], v[30:31], v[90:91] op_sel_hi:[1,0,1]
  v_pk_fma_f32 v[92:93], v[6:7], v[32:33], v[92:93] op_sel_hi:[1,0,1]
  v_pk_fma_f32 v[94:95], v[8:9], v[32:33], v[94:95] op_sel_hi:[1,0,1]
  v_pk_fma_f32 v[96:97], v[14:15], v[30:31], v[96:97] op_sel_hi:[1,0,1]
  v_pk_fma_f32 v[98:99], v[16:17], v[30:31], v[98:99] op_sel_hi:[1,0,1]
  v_pk_fma_f32 v[100:101], v[14:15], v[32:33], v[100:101] op_sel_hi:[1,0,1]
  v_pk_fma_f32 v[102:103], v[16:17], v[32:33], v[102:103] op_sel_hi:[1,0,1]
  v_pk_fma_f32 v[104:105], v[18:19], v[30:31], v[104:105] op_sel_hi:[1,0,1]
  v_pk_fma_f32 v[106:107], v[20:21], v[30:31], v[106:107] op_sel_hi:[1,0,1]
  v_pk_fma_f32 v[108:109], v[18:19], v[32:33], v[108:109] op_sel_hi:[1,0,1]
  v_pk_fma_f32 v[110:111], v[20:21], v[32:33], v[110:111] op_sel_hi:[1,0,1]
  v_pk_fma_f32 v[112:113], v[22:23], v[30:31], v[112:113] op_sel_hi:[1,0,1]
  v_pk_fma_f32 v[114:115], v[24:25], v[30:31], v[114:115] op_sel_hi:[1,0,1]
  v_pk_fma_f32 v[116:117], v[22:23], v[32:33], v[116:117] op_sel_hi:[1,0,1]
  v_pk_fma_f32 v[118:119], v[24:25], v[32:33], v[118:119] op_sel_hi:[1,0,1]
  v_pk_fma_f32 v[120:121], v[26:27], v[30:31], v[120:121] op_sel_hi:[1,0,1]
  v_pk_fma_f32 v[122:123], v[28:29], v[30:31], v[122:123] op_sel_hi:[1,0,1]
  v_pk_fma_f32 v[124:125], v[26:27], v[32:33], v[124:125] op_sel_hi:[1,0,1]
  v_pk_fma_f32 v[126:127], v[28:29], v[32:33], v[126:127] op_sel_hi:[1,0,1]
  v_lshlrev_b32 v42, 4, v3
  v_add_u32 v42, 0x27940, v42
  ds_read_b128 v[6:9], v42 offset:0
  ds_read_b128 v[14:17], v42 offset:64
  ds_read_b128 v[18:21], v42 offset:128
  ds_read_b128 v[22:25], v42 offset:192
  ds_read_b128 v[26:29], v42 offset:256
  ds_read_b128 v[38:41], v42 offset:320
  s_waitcnt lgkmcnt(0)
  v_pk_add_f32 v[26:27], v[26:27], v[38:39]
  v_pk_add_f32 v[28:29], v[28:29], v[40:41]
  s_nop 7
  s_cmp_lg_u32 s53, 0
  s_cbranch_scc1 L_eb_5
  v_mov_b32 v38, v35
  v_mov_b32 v40, v37
  v_and_b32 v51, 1, v3
  v_mul_u32_u24 v50, 0x5000, v51
  v_lshl_add_u32 v50, v2, 4, v50
  v_lshrrev_b32 v51, 1, v3
  v_lshl_add_u32 v50, v51, 8, v50
  v_add_u32 v50, 0x800, v50
  s_lshl_b32 s68, s4, 2
  s_add_u32 s68, s68, s6
  s_lshl_b32 s68, s68, 1
  s_add_u32 s68, s68, 1
  s_mul_i32 s68, s68, 0x5000
  s_mul_i32 s66, s52, 0xa00
  s_add_u32 s66, s66, s68
  s_add_u32 s66, s66, 0x1a4000
  s_add_u32 s67, s66, 0x5000
  v_pk_mul_f32 v[88:89], v[88:89], v[38:39] op_sel_hi:[1,0]
  v_pk_mul_f32 v[90:91], v[90:91], v[38:39] op_sel_hi:[1,0]
  v_pk_mul_f32 v[96:97], v[96:97], v[38:39] op_sel_hi:[1,0]
  v_pk_mul_f32 v[98:99], v[98:99], v[38:39] op_sel_hi:[1,0]
  v_pk_mul_f32 v[52:53], v[88:89], v[88:89]
  v_pk_mul_f32 v[54:55], v[90:91], v[90:91]
  v_pk_mul_f32 v[56:57], v[96:97], v[96:97]
  v_pk_mul_f32 v[58:59], v[98:99], v[98:99]
  v_pk_fma_f32 v[52:53], v[52:53], s[60:61], v[4:5] op_sel_hi:[1,0,0]
  v_pk_fma_f32 v[54:55], v[54:55], s[60:61], v[4:5] op_sel_hi:[1,0,0]
  v_pk_fma_f32 v[56:57], v[56:57], s[60:61], v[4:5] op_sel_hi:[1,0,0]
  v_pk_fma_f32 v[58:59], v[58:59], s[60:61], v[4:5] op_sel_hi:[1,0,0]
  v_pk_mul_f32 v[52:53], v[52:53], v[88:89]
  v_pk_mul_f32 v[54:55], v[54:55], v[90:91]
  v_pk_mul_f32 v[56:57], v[56:57], v[96:97]
  v_pk_mul_f32 v[58:59], v[58:59], v[98:99]
  v_exp_f32 v52, v52
  v_exp_f32 v53, v53
  v_exp_f32 v54, v54
  v_exp_f32 v55, v55
  v_exp_f32 v56, v56
  v_exp_f32 v57, v57
  v_exp_f32 v58, v58
  v_exp_f32 v59, v59
  v_pk_add_f32 v[52:53], v[52:53], v[4:5] op_sel:[0,1] op_sel_hi:[1,1]
  v_pk_add_f32 v[54:55], v[54:55], v[4:5] op_sel:[0,1] op_sel_hi:[1,1]
  v_pk_add_f32 v[56:57], v[56:57], v[4:5] op_sel:[0,1] op_sel_hi:[1,1]
  v_pk_add_f32 v[58:59], v[58:59], v[4:5] op_sel:[0,1] op_sel_hi:[1,1]
  v_rcp_f32 v52, v52
  v_rcp_f32 v53, v53
  v_rcp_f32 v54, v54
  v_rcp_f32 v55, v55
  v_rcp_f32 v56, v56
  v_rcp_f32 v57, v57
  v_rcp_f32 v58, v58
  v_rcp_f32 v59, v59
  v_pk_mul_f32 v[52:53], v[52:53], v[88:89]
  v_pk_mul_f32 v[54:55], v[54:55], v[90:91]
  v_pk_mul_f32 v[56:57], v[56:57], v[96:97]
  v_pk_mul_f32 v[58:59], v[58:59], v[98:99]
  v_cvt_pk_bf16_f32 v42, v52, v53
  v_cvt_pk_bf16_f32 v43, v54, v55
  v_cvt_pk_bf16_f32 v44, v56, v57
  v_cvt_pk_bf16_f32 v45, v58, v59
  s_nop 0
  v_permlane16_swap_b32 v42, v44
  v_permlane16_swap_b32 v43, v45
  buffer_store_dwordx4 v[42:45], v189, s[20:23], s66 offen offset:0 sc1
  v_pk_mul_f32 v[104:105], v[104:105], v[38:39] op_sel_hi:[1,0]
  v_pk_mul_f32 v[106:107], v[106:107], v[38:39] op_sel_hi:[1,0]
  v_pk_mul_f32 v[112:113], v[112:113], v[38:39] op_sel_hi:[1,0]
  v_pk_mul_f32 v[114:115], v[114:115], v[38:39] op_sel_hi:[1,0]
  v_pk_mul_f32 v[52:53], v[104:105], v[104:105]
  v_pk_mul_f32 v[54:55], v[106:107], v[106:107]
  v_pk_mul_f32 v[56:57], v[112:113], v[112:113]
  v_pk_mul_f32 v[58:59], v[114:115], v[114:115]
  v_pk_fma_f32 v[52:53], v[52:53], s[60:61], v[4:5] op_sel_hi:[1,0,0]
  v_pk_fma_f32 v[54:55], v[54:55], s[60:61], v[4:5] op_sel_hi:[1,0,0]
  v_pk_fma_f32 v[56:57], v[56:57], s[60:61], v[4:5] op_sel_hi:[1,0,0]
  v_pk_fma_f32 v[58:59], v[58:59], s[60:61], v[4:5] op_sel_hi:[1,0,0]
  v_pk_mul_f32 v[52:53], v[52:53], v[104:105]
  v_pk_mul_f32 v[54:55], v[54:55], v[106:107]
  v_pk_mul_f32 v[56:57], v[56:57], v[112:113]
  v_pk_mul_f32 v[58:59], v[58:59], v[114:115]
  v_exp_f32 v52, v52
  v_exp_f32 v53, v53
  v_exp_f32 v54, v54
  v_exp_f32 v55, v55
  v_exp_f32 v56, v56
  v_exp_f32 v57, v57
  v_exp_f32 v58, v58
  v_exp_f32 v59, v59
  v_pk_add_f32 v[52:53], v[52:53], v[4:5] op_sel:[0,1] op_sel_hi:[1,1]
  v_pk_add_f32 v[54:55], v[54:55], v[4:5] op_sel:[0,1] op_sel_hi:[1,1]
  v_pk_add_f32 v[56:57], v[56:57], v[4:5] op_sel:[0,1] op_sel_hi:[1,1]
  v_pk_add_f32 v[58:59], v[58:59], v[4:5] op_sel:[0,1] op_sel_hi:[1,1]
  v_rcp_f32 v52, v52
  v_rcp_f32 v53, v53
  v_rcp_f32 v54, v54
  v_rcp_f32 v55, v55
  v_rcp_f32 v56, v56
  v_rcp_f32 v57, v57
  v_rcp_f32 v58, v58
  v_rcp_f32 v59, v59
  v_pk_mul_f32 v[52:53], v[52:53], v[104:105]
  v_pk_mul_f32 v[54:55], v[54:55], v[106:107]
  v_pk_mul_f32 v[56:57], v[56:57], v[112:113]
  v_pk_mul_f32 v[58:59], v[58:59], v[114:115]
  v_cvt_pk_bf16_f32 v46, v52, v53
  v_cvt_pk_bf16_f32 v47, v54, v55
  v_cvt_pk_bf16_f32 v48, v56, v57
  v_cvt_pk_bf16_f32 v49, v58, v59
  s_nop 0
  v_permlane16_swap_b32 v46, v48
  v_permlane16_swap_b32 v47, v49
  buffer_store_dwordx4 v[46:49], v189, s[20:23], s66 offen offset:1024 sc1
  v_pk_mul_f32 v[92:93], v[92:93], v[40:41] op_sel_hi:[1,0]
  v_pk_mul_f32 v[94:95], v[94:95], v[40:41] op_sel_hi:[1,0]
  v_pk_mul_f32 v[100:101], v[100:101], v[40:41] op_sel_hi:[1,0]
  v_pk_mul_f32 v[102:103], v[102:103], v[40:41] op_sel_hi:[1,0]
  v_pk_mul_f32 v[52:53], v[92:93], v[92:93]
  v_pk_mul_f32 v[54:55], v[94:95], v[94:95]
  v_pk_mul_f32 v[56:57], v[100:101], v[100:101]
  v_pk_mul_f32 v[58:59], v[102:103], v[102:103]
  v_pk_fma_f32 v[52:53], v[52:53], s[60:61], v[4:5] op_sel_hi:[1,0,0]
  v_pk_fma_f32 v[54:55], v[54:55], s[60:61], v[4:5] op_sel_hi:[1,0,0]
  v_pk_fma_f32 v[56:57], v[56:57], s[60:61], v[4:5] op_sel_hi:[1,0,0]
  v_pk_fma_f32 v[58:59], v[58:59], s[60:61], v[4:5] op_sel_hi:[1,0,0]
  v_pk_mul_f32 v[52:53], v[52:53], v[92:93]
  v_pk_mul_f32 v[54:55], v[54:55], v[94:95]
  v_pk_mul_f32 v[56:57], v[56:57], v[100:101]
  v_pk_mul_f32 v[58:59], v[58:59], v[102:103]
  v_exp_f32 v52, v52
  v_exp_f32 v53, v53
  v_exp_f32 v54, v54
  v_exp_f32 v55, v55
  v_exp_f32 v56, v56
  v_exp_f32 v57, v57
  v_exp_f32 v58, v58
  v_exp_f32 v59, v59
  v_pk_add_f32 v[52:53], v[52:53], v[4:5] op_sel:[0,1] op_sel_hi:[1,1]
  v_pk_add_f32 v[54:55], v[54:55], v[4:5] op_sel:[0,1] op_sel_hi:[1,1]
  v_pk_add_f32 v[56:57], v[56:57], v[4:5] op_sel:[0,1] op_sel_hi:[1,1]
  v_pk_add_f32 v[58:59], v[58:59], v[4:5] op_sel:[0,1] op_sel_hi:[1,1]
  v_rcp_f32 v52, v52
  v_rcp_f32 v53, v53
  v_rcp_f32 v54, v54
  v_rcp_f32 v55, v55
  v_rcp_f32 v56, v56
  v_rcp_f32 v57, v57
  v_rcp_f32 v58, v58
  v_rcp_f32 v59, v59
  v_pk_mul_f32 v[52:53], v[52:53], v[92:93]
  v_pk_mul_f32 v[54:55], v[54:55], v[94:95]
  v_pk_mul_f32 v[56:57], v[56:57], v[100:101]
  v_pk_mul_f32 v[58:59], v[58:59], v[102:103]
  v_cvt_pk_bf16_f32 v42, v52, v53
  v_cvt_pk_bf16_f32 v43, v54, v55
  v_cvt_pk_bf16_f32 v44, v56, v57
  v_cvt_pk_bf16_f32 v45, v58, v59
  s_nop 0
  v_permlane16_swap_b32 v42, v44
  v_permlane16_swap_b32 v43, v45
  buffer_store_dwordx4 v[42:45], v189, s[20:23], s67 offen offset:0 sc1
  v_pk_mul_f32 v[108:109], v[108:109], v[40:41] op_sel_hi:[1,0]
  v_pk_mul_f32 v[110:111], v[110:111], v[40:41] op_sel_hi:[1,0]
  v_pk_mul_f32 v[116:117], v[116:117], v[40:41] op_sel_hi:[1,0]
  v_pk_mul_f32 v[118:119], v[118:119], v[40:41] op_sel_hi:[1,0]
  v_pk_mul_f32 v[52:53], v[108:109], v[108:109]
  v_pk_mul_f32 v[54:55], v[110:111], v[110:111]
  v_pk_mul_f32 v[56:57], v[116:117], v[116:117]
  v_pk_mul_f32 v[58:59], v[118:119], v[118:119]
  v_pk_fma_f32 v[52:53], v[52:53], s[60:61], v[4:5] op_sel_hi:[1,0,0]
  v_pk_fma_f32 v[54:55], v[54:55], s[60:61], v[4:5] op_sel_hi:[1,0,0]
  v_pk_fma_f32 v[56:57], v[56:57], s[60:61], v[4:5] op_sel_hi:[1,0,0]
  v_pk_fma_f32 v[58:59], v[58:59], s[60:61], v[4:5] op_sel_hi:[1,0,0]
  v_pk_mul_f32 v[52:53], v[52:53], v[108:109]
  v_pk_mul_f32 v[54:55], v[54:55], v[110:111]
  v_pk_mul_f32 v[56:57], v[56:57], v[116:117]
  v_pk_mul_f32 v[58:59], v[58:59], v[118:119]
  v_exp_f32 v52, v52
  v_exp_f32 v53, v53
  v_exp_f32 v54, v54
  v_exp_f32 v55, v55
  v_exp_f32 v56, v56
  v_exp_f32 v57, v57
  v_exp_f32 v58, v58
  v_exp_f32 v59, v59
  v_pk_add_f32 v[52:53], v[52:53], v[4:5] op_sel:[0,1] op_sel_hi:[1,1]
  v_pk_add_f32 v[54:55], v[54:55], v[4:5] op_sel:[0,1] op_sel_hi:[1,1]
  v_pk_add_f32 v[56:57], v[56:57], v[4:5] op_sel:[0,1] op_sel_hi:[1,1]
  v_pk_add_f32 v[58:59], v[58:59], v[4:5] op_sel:[0,1] op_sel_hi:[1,1]
  v_rcp_f32 v52, v52
  v_rcp_f32 v53, v53
  v_rcp_f32 v54, v54
  v_rcp_f32 v55, v55
  v_rcp_f32 v56, v56
  v_rcp_f32 v57, v57
  v_rcp_f32 v58, v58
  v_rcp_f32 v59, v59
  v_pk_mul_f32 v[52:53], v[52:53], v[108:109]
  v_pk_mul_f32 v[54:55], v[54:55], v[110:111]
  v_pk_mul_f32 v[56:57], v[56:57], v[116:117]
  v_pk_mul_f32 v[58:59], v[58:59], v[118:119]
  v_cvt_pk_bf16_f32 v46, v52, v53
  v_cvt_pk_bf16_f32 v47, v54, v55
  v_cvt_pk_bf16_f32 v48, v56, v57
  v_cvt_pk_bf16_f32 v49, v58, v59
  s_nop 0
  v_permlane16_swap_b32 v46, v48
  v_permlane16_swap_b32 v47, v49
  buffer_store_dwordx4 v[46:49], v189, s[20:23], s67 offen offset:1024 sc1
  v_pk_mul_f32 v[120:121], v[120:121], v[38:39] op_sel_hi:[1,0]
  v_pk_mul_f32 v[122:123], v[122:123], v[38:39] op_sel_hi:[1,0]
  v_pk_mul_f32 v[124:125], v[124:125], v[40:41] op_sel_hi:[1,0]
  v_pk_mul_f32 v[126:127], v[126:127], v[40:41] op_sel_hi:[1,0]
  v_pk_mul_f32 v[52:53], v[120:121], v[120:121]
  v_pk_mul_f32 v[54:55], v[122:123], v[122:123]
  v_pk_mul_f32 v[56:57], v[124:125], v[124:125]
  v_pk_mul_f32 v[58:59], v[126:127], v[126:127]
  v_pk_fma_f32 v[52:53], v[52:53], s[60:61], v[4:5] op_sel_hi:[1,0,0]
  v_pk_fma_f32 v[54:55], v[54:55], s[60:61], v[4:5] op_sel_hi:[1,0,0]
  v_pk_fma_f32 v[56:57], v[56:57], s[60:61], v[4:5] op_sel_hi:[1,0,0]
  v_pk_fma_f32 v[58:59], v[58:59], s[60:61], v[4:5] op_sel_hi:[1,0,0]
  v_pk_mul_f32 v[52:53], v[52:53], v[120:121]
  v_pk_mul_f32 v[54:55], v[54:55], v[122:123]
  v_pk_mul_f32 v[56:57], v[56:57], v[124:125]
  v_pk_mul_f32 v[58:59], v[58:59], v[126:127]
  v_exp_f32 v52, v52
  v_exp_f32 v53, v53
  v_exp_f32 v54, v54
  v_exp_f32 v55, v55
  v_exp_f32 v56, v56
  v_exp_f32 v57, v57
  v_exp_f32 v58, v58
  v_exp_f32 v59, v59
  v_pk_add_f32 v[52:53], v[52:53], v[4:5] op_sel:[0,1] op_sel_hi:[1,1]
  v_pk_add_f32 v[54:55], v[54:55], v[4:5] op_sel:[0,1] op_sel_hi:[1,1]
  v_pk_add_f32 v[56:57], v[56:57], v[4:5] op_sel:[0,1] op_sel_hi:[1,1]
  v_pk_add_f32 v[58:59], v[58:59], v[4:5] op_sel:[0,1] op_sel_hi:[1,1]
  v_rcp_f32 v52, v52
  v_rcp_f32 v53, v53
  v_rcp_f32 v54, v54
  v_rcp_f32 v55, v55
  v_rcp_f32 v56, v56
  v_rcp_f32 v57, v57
  v_rcp_f32 v58, v58
  v_rcp_f32 v59, v59
  v_pk_mul_f32 v[52:53], v[52:53], v[120:121]
  v_pk_mul_f32 v[54:55], v[54:55], v[122:123]
  v_pk_mul_f32 v[56:57], v[56:57], v[124:125]
  v_pk_mul_f32 v[58:59], v[58:59], v[126:127]
  v_cvt_pk_bf16_f32 v42, v52, v53
  v_cvt_pk_bf16_f32 v43, v54, v55
  v_cvt_pk_bf16_f32 v44, v56, v57
  v_cvt_pk_bf16_f32 v45, v58, v59
  s_nop 0
  v_permlane16_swap_b32 v42, v44
  v_permlane16_swap_b32 v43, v45
  buffer_store_dwordx4 v[42:45], v50, s[20:23], s66 offen sc1
  s_nop 1
  v_mov_b32 v46, 0
  v_mov_b32 v47, 0
  v_mov_b32 v48, 0
  v_mov_b32 v49, 0
  v_lshlrev_b32 v50, 4, v0
  v_mov_b32 v51, 0x40000000
  v_cmp_gt_u32 vcc, 0xa0, v0
  s_nop 1
  v_cndmask_b32 v50, v51, v50, vcc
  s_mul_i32 s68, s52, 0xa00
  s_add_u32 s68, s68, 0x1a4000
  s_add_u32 s69, s68, 0x285000
  s_cmp_eq_u32 s4, 15
  s_cselect_b32 s69, s69, 0x40000000
  s_cmp_eq_u32 s4, 0
  s_cselect_b32 s68, s68, s69
  buffer_store_dwordx4 v[46:49], v50, s[20:23], s68 offen sc1
  s_nop 1
  v_pk_fma_f32 v[128:129], v[6:7], v[30:31], v[128:129] op_sel_hi:[1,0,1]
  v_pk_fma_f32 v[130:131], v[8:9], v[30:31], v[130:131] op_sel_hi:[1,0,1]
  v_pk_fma_f32 v[132:133], v[6:7], v[32:33], v[132:133] op_sel_hi:[1,0,1]
  v_pk_fma_f32 v[134:135], v[8:9], v[32:33], v[134:135] op_sel_hi:[1,0,1]
  v_pk_fma_f32 v[136:137], v[14:15], v[30:31], v[136:137] op_sel_hi:[1,0,1]
  v_pk_fma_f32 v[138:139], v[16:17], v[30:31], v[138:139] op_sel_hi:[1,0,1]
  v_pk_fma_f32 v[140:141], v[14:15], v[32:33], v[140:141] op_sel_hi:[1,0,1]
  v_pk_fma_f32 v[142:143], v[16:17], v[32:33], v[142:143] op_sel_hi:[1,0,1]
  v_pk_fma_f32 v[144:145], v[18:19], v[30:31], v[144:145] op_sel_hi:[1,0,1]
  v_pk_fma_f32 v[146:147], v[20:21], v[30:31], v[146:147] op_sel_hi:[1,0,1]
  v_pk_fma_f32 v[148:149], v[18:19], v[32:33], v[148:149] op_sel_hi:[1,0,1]
  v_pk_fma_f32 v[150:151], v[20:21], v[32:33], v[150:151] op_sel_hi:[1,0,1]
  v_pk_fma_f32 v[152:153], v[22:23], v[30:31], v[152:153] op_sel_hi:[1,0,1]
  v_pk_fma_f32 v[154:155], v[24:25], v[30:31], v[154:155] op_sel_hi:[1,0,1]
  v_pk_fma_f32 v[156:157], v[22:23], v[32:33], v[156:157] op_sel_hi:[1,0,1]
  v_pk_fma_f32 v[158:159], v[24:25], v[32:33], v[158:159] op_sel_hi:[1,0,1]
  v_pk_fma_f32 v[160:161], v[26:27], v[30:31], v[160:161] op_sel_hi:[1,0,1]
  v_pk_fma_f32 v[162:163], v[28:29], v[30:31], v[162:163] op_sel_hi:[1,0,1]
  v_pk_fma_f32 v[164:165], v[26:27], v[32:33], v[164:165] op_sel_hi:[1,0,1]
  v_pk_fma_f32 v[166:167], v[28:29], v[32:33], v[166:167] op_sel_hi:[1,0,1]
  v_cvt_pk_bf16_f32 v38, v128, v129
  v_cvt_pk_bf16_f32 v39, v130, v131
  v_cvt_pk_bf16_f32 v40, v136, v137
  v_cvt_pk_bf16_f32 v41, v138, v139
  v_cvt_pk_bf16_f32 v42, v144, v145
  v_cvt_pk_bf16_f32 v43, v146, v147
  v_cvt_pk_bf16_f32 v44, v152, v153
  v_cvt_pk_bf16_f32 v45, v154, v155
  v_cvt_pk_bf16_f32 v46, v160, v161
  v_cvt_pk_bf16_f32 v47, v162, v163
  v_cvt_pk_bf16_f32 v244, v132, v133
  v_cvt_pk_bf16_f32 v245, v134, v135
  v_cvt_pk_bf16_f32 v246, v140, v141
  v_cvt_pk_bf16_f32 v247, v142, v143
  v_cvt_pk_bf16_f32 v248, v148, v149
  v_cvt_pk_bf16_f32 v249, v150, v151
  v_cvt_pk_bf16_f32 v250, v156, v157
  v_cvt_pk_bf16_f32 v251, v158, v159
  v_cvt_pk_bf16_f32 v252, v164, v165
  v_cvt_pk_bf16_f32 v253, v166, v167
  v_bfe_u32 v52, v1, 2, 2
  v_lshl_add_u32 v52, v3, 2, v52
  v_mul_u32_u24 v48, 40, v52
  v_add_u32 v48, 0x25000, v48
  v_and_b32 v51, 3, v1
  v_lshl_add_u32 v49, v51, 3, v48
  v_add_u32 v50, 32, v48
  v_cmp_eq_u32 s[68:69], 0, v51
  v_cmp_le_u32 s[66:67], 0, v3
  v_mov_b32 v52, 0x26000
  s_nop 0
  v_cndmask_b32 v53, v52, v49, s[66:67]
  ds_read_b64_tr_b16 v[212:213], v53 offset:0
  s_and_b64 s[66:67], s[66:67], s[68:69]
  v_cndmask_b32 v54, v52, v50, s[66:67]
  ds_read_b64_tr_b16 v[228:229], v54 offset:0
  v_cmp_ge_u32 s[66:67], 0, v3
  v_mov_b32 v52, 0x25d80
  s_nop 0
  v_cndmask_b32 v53, v52, v49, s[66:67]
  ds_read_b64_tr_b16 v[214:215], v53 offset:640
  s_and_b64 s[66:67], s[66:67], s[68:69]
  v_cndmask_b32 v54, v52, v50, s[66:67]
  ds_read_b64_tr_b16 v[230:231], v54 offset:640
  v_cmp_eq_u32 s[68:69], 1, v51
  v_cmp_le_u32 s[66:67], 1, v3
  v_mov_b32 v52, 0x25d80
  s_nop 0
  v_cndmask_b32 v53, v52, v49, s[66:67]
  ds_read_b64_tr_b16 v[216:217], v53 offset:640
  s_and_b64 s[66:67], s[66:67], s[68:69]
  v_cndmask_b32 v54, v52, v50, s[66:67]
  ds_read_b64_tr_b16 v[232:233], v54 offset:640
  v_cmp_ge_u32 s[66:67], 1, v3
  v_mov_b32 v52, 0x25b00
  s_nop 0
  v_cndmask_b32 v53, v52, v49, s[66:67]
  ds_read_b64_tr_b16 v[218:219], v53 offset:1280
  s_and_b64 s[66:67], s[66:67], s[68:69]
  v_cndmask_b32 v54, v52, v50, s[66:67]
  ds_read_b64_tr_b16 v[234:235], v54 offset:1280
  v_cmp_eq_u32 s[68:69], 2, v51
  v_cmp_le_u32 s[66:67], 2, v3
  v_mov_b32 v52, 0x25b00
  s_nop 0
  v_cndmask_b32 v53, v52, v49, s[66:67]
  ds_read_b64_tr_b16 v[220:221], v53 offset:1280
  s_and_b64 s[66:67], s[66:67], s[68:69]
  v_cndmask_b32 v54, v52, v50, s[66:67]
  ds_read_b64_tr_b16 v[236:237], v54 offset:1280
  v_cmp_ge_u32 s[66:67], 2, v3
  v_mov_b32 v52, 0x25880
  s_nop 0
  v_cndmask_b32 v53, v52, v49, s[66:67]
  ds_read_b64_tr_b16 v[222:223], v53 offset:1920
  s_and_b64 s[66:67], s[66:67], s[68:69]
  v_cndmask_b32 v54, v52, v50, s[66:67]
  ds_read_b64_tr_b16 v[238:239], v54 offset:1920
  v_cmp_eq_u32 s[68:69], 3, v51
  v_cmp_le_u32 s[66:67], 3, v3
  v_mov_b32 v52, 0x25880
  s_nop 0
  v_cndmask_b32 v53, v52, v49, s[66:67]
  ds_read_b64_tr_b16 v[224:225], v53 offset:1920
  s_and_b64 s[66:67], s[66:67], s[68:69]
  v_cndmask_b32 v54, v52, v50, s[66:67]
  ds_read_b64_tr_b16 v[240:241], v54 offset:1920
  v_cmp_ge_u32 s[66:67], 3, v3
  v_mov_b32 v52, 0x25600
  s_nop 0
  v_cndmask_b32 v53, v52, v49, s[66:67]
  ds_read_b64_tr_b16 v[226:227], v53 offset:2560
  s_and_b64 s[66:67], s[66:67], s[68:69]
  v_cndmask_b32 v54, v52, v50, s[66:67]
  ds_read_b64_tr_b16 v[242:243], v54 offset:2560
  s_waitcnt vmcnt(0)
  s_barrier
  s_waitcnt lgkmcnt(13)
  v_mfma_f32_16x16x32_bf16 v[48:51], v[212:215], v[38:41], 0
  s_waitcnt lgkmcnt(12)
  v_mfma_f32_16x16x32_bf16 v[64:67], v[228:231], v[38:41], 0
  s_waitcnt lgkmcnt(9)
  v_mfma_f32_16x16x32_bf16 v[52:55], v[216:219], v[40:43], 0
  s_waitcnt lgkmcnt(8)
  v_mfma_f32_16x16x32_bf16 v[64:67], v[232:235], v[40:43], v[64:67]
  s_waitcnt lgkmcnt(5)
  v_mfma_f32_16x16x32_bf16 v[56:59], v[220:223], v[42:45], 0
  s_waitcnt lgkmcnt(4)
  v_mfma_f32_16x16x32_bf16 v[64:67], v[236:239], v[42:45], v[64:67]
  s_waitcnt lgkmcnt(1)
  v_mfma_f32_16x16x32_bf16 v[60:63], v[224:227], v[44:47], 0
  s_waitcnt lgkmcnt(0)
  v_mfma_f32_16x16x32_bf16 v[64:67], v[240:243], v[44:47], v[64:67]
  v_mul_f32 v68, 0x3fb8aa3b, v34
  v_mul_f32 v69, 0xbfb8aa3b, v34
  v_max3_f32 v70, v48, v49, v50
  v_min3_f32 v74, v48, v49, v50
  v_max3_f32 v71, v52, v53, v54
  v_min3_f32 v75, v52, v53, v54
  v_max3_f32 v72, v56, v57, v58
  v_min3_f32 v76, v56, v57, v58
  v_max3_f32 v73, v60, v61, v62
  v_min3_f32 v77, v60, v61, v62
  v_max3_f32 v78, v64, v65, v66
  v_min3_f32 v79, v64, v65, v66
  v_max_f32 v70, v70, v51
  v_min_f32 v74, v74, v51
  v_max_f32 v71, v71, v55
  v_min_f32 v75, v75, v55
  v_max_f32 v72, v72, v59
  v_min_f32 v76, v76, v59
  v_max_f32 v73, v73, v63
  v_min_f32 v77, v77, v63
  v_max_f32 v78, v78, v67
  v_min_f32 v79, v79, v67
  s_mov_b64 exec, s[56:57]
  v_max_f32 v70, v70, v78
  v_min_f32 v74, v74, v79
  s_mov_b64 exec, s[58:59]
  v_max_f32 v71, v71, v78
  v_min_f32 v75, v75, v79
  s_mov_b64 exec, s[84:85]
  v_max_f32 v72, v72, v78
  v_min_f32 v76, v76, v79
  s_mov_b64 exec, s[86:87]
  v_max_f32 v73, v73, v78
  v_min_f32 v77, v77, v79
  s_mov_b64 exec, -1
  v_permlane16_swap_b32 v70, v71
  v_permlane16_swap_b32 v74, v75
  v_permlane16_swap_b32 v72, v73
  v_permlane16_swap_b32 v76, v77
  v_max_f32 v70, v70, v71
  v_min_f32 v74, v74, v75
  v_max_f32 v72, v72, v73
  v_min_f32 v76, v76, v77
  s_nop 0
  v_permlane32_swap_b32 v70, v72
  v_permlane32_swap_b32 v74, v76
  v_max_f32 v70, v70, v72
  v_min_f32 v74, v74, v76
  v_mov_b32 v78, v70
  v_mov_b32 v79, v74
  v_mov_b32 v71, v70
  v_mov_b32 v75, v74
  s_nop 0
  v_permlane32_swap_b32 v70, v71
  v_permlane32_swap_b32 v74, v75
  v_mov_b32 v72, v70
  v_mov_b32 v76, v74
  v_mov_b32 v73, v71
  v_mov_b32 v77, v75
  v_permlane16_swap_b32 v70, v72
  v_permlane16_swap_b32 v74, v76
  v_permlane16_swap_b32 v71, v73
  v_permlane16_swap_b32 v75, v77
  v_mul_f32 v80, v70, v69
  v_mul_f32 v81, v74, v68
  v_mul_f32 v82, v72, v69
  v_mul_f32 v83, v76, v68
  v_mul_f32 v84, v71, v69
  v_mul_f32 v85, v75, v68
  v_mul_f32 v86, v73, v69
  v_mul_f32 v87, v77, v68
  v_mul_f32 v88, v78, v69
  v_mul_f32 v89, v79, v68
  v_pk_fma_f32 v[70:71], v[48:49], v[68:69], v[80:81] op_sel:[0,1,1] op_sel_hi:[1,1,1]
  v_pk_fma_f32 v[72:73], v[50:51], v[68:69], v[80:81] op_sel:[0,1,1] op_sel_hi:[1,1,1]
  v_pk_fma_f32 v[48:49], v[48:49], v[68:69], v[80:81] op_sel_hi:[1,0,0]
  v_pk_fma_f32 v[50:51], v[50:51], v[68:69], v[80:81] op_sel_hi:[1,0,0]
  v_pk_fma_f32 v[74:75], v[52:53], v[68:69], v[82:83] op_sel:[0,1,1] op_sel_hi:[1,1,1]
  v_pk_fma_f32 v[76:77], v[54:55], v[68:69], v[82:83] op_sel:[0,1,1] op_sel_hi:[1,1,1]
  v_pk_fma_f32 v[52:53], v[52:53], v[68:69], v[82:83] op_sel_hi:[1,0,0]
  v_pk_fma_f32 v[54:55], v[54:55], v[68:69], v[82:83] op_sel_hi:[1,0,0]
  v_pk_fma_f32 v[90:91], v[56:57], v[68:69], v[84:85] op_sel:[0,1,1] op_sel_hi:[1,1,1]
  v_pk_fma_f32 v[92:93], v[58:59], v[68:69], v[84:85] op_sel:[0,1,1] op_sel_hi:[1,1,1]
  v_pk_fma_f32 v[56:57], v[56:57], v[68:69], v[84:85] op_sel_hi:[1,0,0]
  v_pk_fma_f32 v[58:59], v[58:59], v[68:69], v[84:85] op_sel_hi:[1,0,0]
  v_pk_fma_f32 v[94:95], v[60:61], v[68:69], v[86:87] op_sel:[0,1,1] op_sel_hi:[1,1,1]
  v_pk_fma_f32 v[96:97], v[62:63], v[68:69], v[86:87] op_sel:[0,1,1] op_sel_hi:[1,1,1]
  v_pk_fma_f32 v[60:61], v[60:61], v[68:69], v[86:87] op_sel_hi:[1,0,0]
  v_pk_fma_f32 v[62:63], v[62:63], v[68:69], v[86:87] op_sel_hi:[1,0,0]
  v_pk_fma_f32 v[98:99], v[64:65], v[68:69], v[88:89] op_sel:[0,1,1] op_sel_hi:[1,1,1]
  v_pk_fma_f32 v[100:101], v[66:67], v[68:69], v[88:89] op_sel:[0,1,1] op_sel_hi:[1,1,1]
  v_pk_fma_f32 v[64:65], v[64:65], v[68:69], v[88:89] op_sel_hi:[1,0,0]
  v_pk_fma_f32 v[66:67], v[66:67], v[68:69], v[88:89] op_sel_hi:[1,0,0]
  v_exp_f32 v48, v48
  v_exp_f32 v49, v49
  v_exp_f32 v50, v50
  v_exp_f32 v51, v51
  v_exp_f32 v70, v70
  v_exp_f32 v71, v71
  v_exp_f32 v72, v72
  v_exp_f32 v73, v73
  v_exp_f32 v52, v52
  v_exp_f32 v53, v53
  v_exp_f32 v54, v54
  v_exp_f32 v55, v55
  v_exp_f32 v74, v74
  v_exp_f32 v75, v75
  v_exp_f32 v76, v76
  v_exp_f32 v77, v77
  v_exp_f32 v56, v56
  v_exp_f32 v57, v57
  v_exp_f32 v58, v58
  v_exp_f32 v59, v59
  v_exp_f32 v90, v90
  v_exp_f32 v91, v91
  v_exp_f32 v92, v92
  v_exp_f32 v93, v93
  v_exp_f32 v60, v60
  v_exp_f32 v61, v61
  v_exp_f32 v62, v62
  v_exp_f32 v63, v63
  v_exp_f32 v94, v94
  v_exp_f32 v95, v95
  v_exp_f32 v96, v96
  v_exp_f32 v97, v97
  v_exp_f32 v64, v64
  v_exp_f32 v65, v65
  v_exp_f32 v66, v66
  v_exp_f32 v67, v67
  v_exp_f32 v98, v98
  v_exp_f32 v99, v99
  v_exp_f32 v100, v100
  v_exp_f32 v101, v101
  v_pk_add_f32 v[78:79], v[48:49], v[50:51]
  v_pk_add_f32 v[102:103], v[70:71], v[72:73]
  v_add_f32 v104, v78, v79
  v_add_f32 v108, v102, v103
  v_pk_add_f32 v[78:79], v[52:53], v[54:55]
  v_pk_add_f32 v[102:103], v[74:75], v[76:77]
  v_add_f32 v105, v78, v79
  v_add_f32 v109, v102, v103
  v_pk_add_f32 v[78:79], v[56:57], v[58:59]
  v_pk_add_f32 v[102:103], v[90:91], v[92:93]
  v_add_f32 v106, v78, v79
  v_add_f32 v110, v102, v103
  v_pk_add_f32 v[78:79], v[60:61], v[62:63]
  v_pk_add_f32 v[102:103], v[94:95], v[96:97]
  v_add_f32 v107, v78, v79
  v_add_f32 v111, v102, v103
  v_pk_add_f32 v[78:79], v[64:65], v[66:67]
  v_pk_add_f32 v[102:103], v[98:99], v[100:101]
  v_add_f32 v112, v78, v79
  v_add_f32 v113, v102, v103
  s_mov_b64 exec, s[56:57]
  v_add_f32 v104, v104, v112
  v_add_f32 v108, v108, v113
  s_mov_b64 exec, s[58:59]
  v_add_f32 v105, v105, v112
  v_add_f32 v109, v109, v113
  s_mov_b64 exec, s[84:85]
  v_add_f32 v106, v106, v112
  v_add_f32 v110, v110, v113
  s_mov_b64 exec, s[86:87]
  v_add_f32 v107, v107, v112
  v_add_f32 v111, v111, v113
  s_mov_b64 exec, -1
  v_permlane16_swap_b32 v104, v105
  v_permlane16_swap_b32 v108, v109
  v_permlane16_swap_b32 v106, v107
  v_permlane16_swap_b32 v110, v111
  v_add_f32 v104, v104, v105
  v_add_f32 v108, v108, v109
  v_add_f32 v106, v106, v107
  v_add_f32 v110, v110, v111
  s_nop 0
  v_permlane32_swap_b32 v104, v106
  v_permlane32_swap_b32 v108, v110
  v_add_f32 v104, v104, v106
  v_add_f32 v108, v108, v110
  v_mov_b32 v78, v104
  v_mov_b32 v79, v108
  v_mov_b32 v105, v104
  v_mov_b32 v109, v108
  s_nop 0
  v_permlane32_swap_b32 v104, v105
  v_permlane32_swap_b32 v108, v109
  v_mov_b32 v106, v104
  v_mov_b32 v110, v108
  v_mov_b32 v107, v105
  v_mov_b32 v111, v109
  v_permlane16_swap_b32 v104, v106
  v_permlane16_swap_b32 v108, v110
  v_permlane16_swap_b32 v105, v107
  v_permlane16_swap_b32 v109, v111
  v_rcp_f32 v80, v104
  v_rcp_f32 v81, v108
  v_rcp_f32 v82, v106
  v_rcp_f32 v83, v110
  v_rcp_f32 v84, v105
  v_rcp_f32 v85, v109
  v_rcp_f32 v86, v107
  v_rcp_f32 v87, v111
  v_rcp_f32 v88, v78
  v_rcp_f32 v89, v79
  v_pk_mul_f32 v[48:49], v[48:49], v[80:81] op_sel_hi:[1,0]
  v_pk_mul_f32 v[50:51], v[50:51], v[80:81] op_sel_hi:[1,0]
  v_pk_mul_f32 v[70:71], v[70:71], v[80:81] op_sel:[0,1] op_sel_hi:[1,1]
  v_pk_mul_f32 v[72:73], v[72:73], v[80:81] op_sel:[0,1] op_sel_hi:[1,1]
  v_pk_mul_f32 v[52:53], v[52:53], v[82:83] op_sel_hi:[1,0]
  v_pk_mul_f32 v[54:55], v[54:55], v[82:83] op_sel_hi:[1,0]
  v_pk_mul_f32 v[74:75], v[74:75], v[82:83] op_sel:[0,1] op_sel_hi:[1,1]
  v_pk_mul_f32 v[76:77], v[76:77], v[82:83] op_sel:[0,1] op_sel_hi:[1,1]
  v_pk_mul_f32 v[56:57], v[56:57], v[84:85] op_sel_hi:[1,0]
  v_pk_mul_f32 v[58:59], v[58:59], v[84:85] op_sel_hi:[1,0]
  v_pk_mul_f32 v[90:91], v[90:91], v[84:85] op_sel:[0,1] op_sel_hi:[1,1]
  v_pk_mul_f32 v[92:93], v[92:93], v[84:85] op_sel:[0,1] op_sel_hi:[1,1]
  v_pk_mul_f32 v[60:61], v[60:61], v[86:87] op_sel_hi:[1,0]
  v_pk_mul_f32 v[62:63], v[62:63], v[86:87] op_sel_hi:[1,0]
  v_pk_mul_f32 v[94:95], v[94:95], v[86:87] op_sel:[0,1] op_sel_hi:[1,1]
  v_pk_mul_f32 v[96:97], v[96:97], v[86:87] op_sel:[0,1] op_sel_hi:[1,1]
  v_pk_mul_f32 v[64:65], v[64:65], v[88:89] op_sel_hi:[1,0]
  v_pk_mul_f32 v[66:67], v[66:67], v[88:89] op_sel_hi:[1,0]
  v_pk_mul_f32 v[98:99], v[98:99], v[88:89] op_sel:[0,1] op_sel_hi:[1,1]
  v_pk_mul_f32 v[100:101], v[100:101], v[88:89] op_sel:[0,1] op_sel_hi:[1,1]
  v_cvt_pk_bf16_f32 v192, v48, v49
  v_cvt_pk_bf16_f32 v193, v50, v51
  v_cvt_pk_bf16_f32 v194, v70, v71
  v_cvt_pk_bf16_f32 v195, v72, v73
  v_cvt_pk_bf16_f32 v196, v52, v53
  v_cvt_pk_bf16_f32 v197, v54, v55
  v_cvt_pk_bf16_f32 v198, v74, v75
  v_cvt_pk_bf16_f32 v199, v76, v77
  v_cvt_pk_bf16_f32 v200, v56, v57
  v_cvt_pk_bf16_f32 v201, v58, v59
  v_cvt_pk_bf16_f32 v202, v90, v91
  v_cvt_pk_bf16_f32 v203, v92, v93
  v_cvt_pk_bf16_f32 v204, v60, v61
  v_cvt_pk_bf16_f32 v205, v62, v63
  v_cvt_pk_bf16_f32 v206, v94, v95
  v_cvt_pk_bf16_f32 v207, v96, v97
  v_cvt_pk_bf16_f32 v208, v64, v65
  v_cvt_pk_bf16_f32 v209, v66, v67
  v_cvt_pk_bf16_f32 v210, v98, v99
  v_cvt_pk_bf16_f32 v211, v100, v101
  s_waitcnt lgkmcnt(0)
  s_nop 7
  s_branch L_ee_6
L_eb_5:
  v_cvt_pk_bf16_f32 v38, v88, v89
  v_cvt_pk_bf16_f32 v39, v90, v91
  v_cvt_pk_bf16_f32 v40, v96, v97
  v_cvt_pk_bf16_f32 v41, v98, v99
  v_cvt_pk_bf16_f32 v42, v104, v105
  v_cvt_pk_bf16_f32 v43, v106, v107
  v_cvt_pk_bf16_f32 v44, v112, v113
  v_cvt_pk_bf16_f32 v45, v114, v115
  v_cvt_pk_bf16_f32 v46, v120, v121
  v_cvt_pk_bf16_f32 v47, v122, v123
  v_cvt_pk_bf16_f32 v48, v92, v93
  v_cvt_pk_bf16_f32 v49, v94, v95
  v_cvt_pk_bf16_f32 v50, v100, v101
  v_cvt_pk_bf16_f32 v51, v102, v103
  v_cvt_pk_bf16_f32 v52, v108, v109
  v_cvt_pk_bf16_f32 v53, v110, v111
  v_cvt_pk_bf16_f32 v54, v116, v117
  v_cvt_pk_bf16_f32 v55, v118, v119
  v_cvt_pk_bf16_f32 v56, v124, v125
  v_cvt_pk_bf16_f32 v57, v126, v127
  v_pk_fma_f32 v[128:129], v[6:7], v[30:31], v[128:129] op_sel_hi:[1,0,1]
  v_pk_fma_f32 v[130:131], v[8:9], v[30:31], v[130:131] op_sel_hi:[1,0,1]
  v_pk_fma_f32 v[132:133], v[6:7], v[32:33], v[132:133] op_sel_hi:[1,0,1]
  v_pk_fma_f32 v[134:135], v[8:9], v[32:33], v[134:135] op_sel_hi:[1,0,1]
  v_pk_fma_f32 v[136:137], v[14:15], v[30:31], v[136:137] op_sel_hi:[1,0,1]
  v_pk_fma_f32 v[138:139], v[16:17], v[30:31], v[138:139] op_sel_hi:[1,0,1]
  v_pk_fma_f32 v[140:141], v[14:15], v[32:33], v[140:141] op_sel_hi:[1,0,1]
  v_pk_fma_f32 v[142:143], v[16:17], v[32:33], v[142:143] op_sel_hi:[1,0,1]
  v_pk_fma_f32 v[144:145], v[18:19], v[30:31], v[144:145] op_sel_hi:[1,0,1]
  v_pk_fma_f32 v[146:147], v[20:21], v[30:31], v[146:147] op_sel_hi:[1,0,1]
  v_pk_fma_f32 v[148:149], v[18:19], v[32:33], v[148:149] op_sel_hi:[1,0,1]
  v_pk_fma_f32 v[150:151], v[20:21], v[32:33], v[150:151] op_sel_hi:[1,0,1]
  v_pk_fma_f32 v[152:153], v[22:23], v[30:31], v[152:153] op_sel_hi:[1,0,1]
  v_pk_fma_f32 v[154:155], v[24:25], v[30:31], v[154:155] op_sel_hi:[1,0,1]
  v_pk_fma_f32 v[156:157], v[22:23], v[32:33], v[156:157] op_sel_hi:[1,0,1]
  v_pk_fma_f32 v[158:159], v[24:25], v[32:33], v[158:159] op_sel_hi:[1,0,1]
  v_pk_fma_f32 v[160:161], v[26:27], v[30:31], v[160:161] op_sel_hi:[1,0,1]
  v_pk_fma_f32 v[162:163], v[28:29], v[30:31], v[162:163] op_sel_hi:[1,0,1]
  v_pk_fma_f32 v[164:165], v[26:27], v[32:33], v[164:165] op_sel_hi:[1,0,1]
  v_pk_fma_f32 v[166:167], v[28:29], v[32:33], v[166:167] op_sel_hi:[1,0,1]
  v_mov_b32 v58, v34
  v_pk_mul_f32 v[128:129], v[128:129], v[58:59] op_sel_hi:[1,0]
  v_cvt_pk_bf16_f32 v232, v128, v129
  v_pk_mul_f32 v[130:131], v[130:131], v[58:59] op_sel_hi:[1,0]
  v_cvt_pk_bf16_f32 v233, v130, v131
  v_pk_mul_f32 v[136:137], v[136:137], v[58:59] op_sel_hi:[1,0]
  v_cvt_pk_bf16_f32 v234, v136, v137
  v_pk_mul_f32 v[138:139], v[138:139], v[58:59] op_sel_hi:[1,0]
  v_cvt_pk_bf16_f32 v235, v138, v139
  v_pk_mul_f32 v[144:145], v[144:145], v[58:59] op_sel_hi:[1,0]
  v_cvt_pk_bf16_f32 v236, v144, v145
  v_pk_mul_f32 v[146:147], v[146:147], v[58:59] op_sel_hi:[1,0]
  v_cvt_pk_bf16_f32 v237, v146, v147
  v_pk_mul_f32 v[152:153], v[152:153], v[58:59] op_sel_hi:[1,0]
  v_cvt_pk_bf16_f32 v238, v152, v153
  v_pk_mul_f32 v[154:155], v[154:155], v[58:59] op_sel_hi:[1,0]
  v_cvt_pk_bf16_f32 v239, v154, v155
  v_pk_mul_f32 v[160:161], v[160:161], v[58:59] op_sel_hi:[1,0]
  v_cvt_pk_bf16_f32 v240, v160, v161
  v_pk_mul_f32 v[162:163], v[162:163], v[58:59] op_sel_hi:[1,0]
  v_cvt_pk_bf16_f32 v241, v162, v163
  v_mov_b32 v58, v36
  v_pk_mul_f32 v[132:133], v[132:133], v[58:59] op_sel_hi:[1,0]
  v_cvt_pk_bf16_f32 v242, v132, v133
  v_pk_mul_f32 v[134:135], v[134:135], v[58:59] op_sel_hi:[1,0]
  v_cvt_pk_bf16_f32 v243, v134, v135
  v_pk_mul_f32 v[140:141], v[140:141], v[58:59] op_sel_hi:[1,0]
  v_cvt_pk_bf16_f32 v244, v140, v141
  v_pk_mul_f32 v[142:143], v[142:143], v[58:59] op_sel_hi:[1,0]
  v_cvt_pk_bf16_f32 v245, v142, v143
  v_pk_mul_f32 v[148:149], v[148:149], v[58:59] op_sel_hi:[1,0]
  v_cvt_pk_bf16_f32 v246, v148, v149
  v_pk_mul_f32 v[150:151], v[150:151], v[58:59] op_sel_hi:[1,0]
  v_cvt_pk_bf16_f32 v247, v150, v151
  v_pk_mul_f32 v[156:157], v[156:157], v[58:59] op_sel_hi:[1,0]
  v_cvt_pk_bf16_f32 v248, v156, v157
  v_pk_mul_f32 v[158:159], v[158:159], v[58:59] op_sel_hi:[1,0]
  v_cvt_pk_bf16_f32 v249, v158, v159
  v_pk_mul_f32 v[164:165], v[164:165], v[58:59] op_sel_hi:[1,0]
  v_cvt_pk_bf16_f32 v250, v164, v165
  v_pk_mul_f32 v[166:167], v[166:167], v[58:59] op_sel_hi:[1,0]
  v_cvt_pk_bf16_f32 v251, v166, v167
  v_bfe_u32 v94, v1, 2, 2
  v_lshl_add_u32 v94, v3, 2, v94
  v_mul_u32_u24 v90, 40, v94
  v_add_u32 v90, 0x25000, v90
  v_and_b32 v93, 3, v1
  v_lshl_add_u32 v91, v93, 3, v90
  v_add_u32 v92, 32, v90
  v_cmp_eq_u32 s[68:69], 0, v93
  v_cmp_le_u32 s[66:67], 0, v3
  v_mov_b32 v94, 0x26000
  s_nop 0
  v_cndmask_b32 v95, v94, v91, s[66:67]
  ds_read_b64_tr_b16 v[58:59], v95 offset:0
  s_and_b64 s[66:67], s[66:67], s[68:69]
  v_cndmask_b32 v96, v94, v92, s[66:67]
  ds_read_b64_tr_b16 v[74:75], v96 offset:0
  v_cmp_ge_u32 s[66:67], 0, v3
  v_mov_b32 v94, 0x25d80
  s_nop 0
  v_cndmask_b32 v95, v94, v91, s[66:67]
  ds_read_b64_tr_b16 v[60:61], v95 offset:640
  s_and_b64 s[66:67], s[66:67], s[68:69]
  v_cndmask_b32 v96, v94, v92, s[66:67]
  ds_read_b64_tr_b16 v[76:77], v96 offset:640
  v_cmp_eq_u32 s[68:69], 1, v93
  v_cmp_le_u32 s[66:67], 1, v3
  v_mov_b32 v94, 0x25d80
  s_nop 0
  v_cndmask_b32 v95, v94, v91, s[66:67]
  ds_read_b64_tr_b16 v[62:63], v95 offset:640
  s_and_b64 s[66:67], s[66:67], s[68:69]
  v_cndmask_b32 v96, v94, v92, s[66:67]
  ds_read_b64_tr_b16 v[78:79], v96 offset:640
  v_cmp_ge_u32 s[66:67], 1, v3
  v_mov_b32 v94, 0x25b00
  s_nop 0
  v_cndmask_b32 v95, v94, v91, s[66:67]
  ds_read_b64_tr_b16 v[64:65], v95 offset:1280
  s_and_b64 s[66:67], s[66:67], s[68:69]
  v_cndmask_b32 v96, v94, v92, s[66:67]
  ds_read_b64_tr_b16 v[80:81], v96 offset:1280
  v_cmp_eq_u32 s[68:69], 2, v93
  v_cmp_le_u32 s[66:67], 2, v3
  v_mov_b32 v94, 0x25b00
  s_nop 0
  v_cndmask_b32 v95, v94, v91, s[66:67]
  ds_read_b64_tr_b16 v[66:67], v95 offset:1280
  s_and_b64 s[66:67], s[66:67], s[68:69]
  v_cndmask_b32 v96, v94, v92, s[66:67]
  ds_read_b64_tr_b16 v[82:83], v96 offset:1280
  v_cmp_ge_u32 s[66:67], 2, v3
  v_mov_b32 v94, 0x25880
  s_nop 0
  v_cndmask_b32 v95, v94, v91, s[66:67]
  ds_read_b64_tr_b16 v[68:69], v95 offset:1920
  s_and_b64 s[66:67], s[66:67], s[68:69]
  v_cndmask_b32 v96, v94, v92, s[66:67]
  ds_read_b64_tr_b16 v[84:85], v96 offset:1920
  v_cmp_eq_u32 s[68:69], 3, v93
  v_cmp_le_u32 s[66:67], 3, v3
  v_mov_b32 v94, 0x25880
  s_nop 0
  v_cndmask_b32 v95, v94, v91, s[66:67]
  ds_read_b64_tr_b16 v[70:71], v95 offset:1920
  s_and_b64 s[66:67], s[66:67], s[68:69]
  v_cndmask_b32 v96, v94, v92, s[66:67]
  ds_read_b64_tr_b16 v[86:87], v96 offset:1920
  v_cmp_ge_u32 s[66:67], 3, v3
  v_mov_b32 v94, 0x25600
  s_nop 0
  v_cndmask_b32 v95, v94, v91, s[66:67]
  ds_read_b64_tr_b16 v[72:73], v95 offset:2560
  s_and_b64 s[66:67], s[66:67], s[68:69]
  v_cndmask_b32 v96, v94, v92, s[66:67]
  ds_read_b64_tr_b16 v[88:89], v96 offset:2560
  s_waitcnt lgkmcnt(13)
  v_mfma_f32_16x16x32_bf16 v[90:93], v[58:61], v[38:41], 0
  s_waitcnt lgkmcnt(12)
  v_mfma_f32_16x16x32_bf16 v[106:109], v[74:77], v[38:41], 0
  s_waitcnt lgkmcnt(9)
  v_mfma_f32_16x16x32_bf16 v[94:97], v[62:65], v[40:43], 0
  s_waitcnt lgkmcnt(8)
  v_mfma_f32_16x16x32_bf16 v[106:109], v[78:81], v[40:43], v[106:109]
  s_waitcnt lgkmcnt(5)
  v_mfma_f32_16x16x32_bf16 v[98:101], v[66:69], v[42:45], 0
  s_waitcnt lgkmcnt(4)
  v_mfma_f32_16x16x32_bf16 v[106:109], v[82:85], v[42:45], v[106:109]
  s_waitcnt lgkmcnt(1)
  v_mfma_f32_16x16x32_bf16 v[102:105], v[70:73], v[44:47], 0
  s_waitcnt lgkmcnt(0)
  v_mfma_f32_16x16x32_bf16 v[106:109], v[86:89], v[44:47], v[106:109]
  v_mul_f32 v110, 0x3fb8aa3b, v34
  v_mul_f32 v111, 0xbfb8aa3b, v34
  v_max3_f32 v112, v90, v91, v92
  v_min3_f32 v116, v90, v91, v92
  v_max3_f32 v113, v94, v95, v96
  v_min3_f32 v117, v94, v95, v96
  v_max3_f32 v114, v98, v99, v100
  v_min3_f32 v118, v98, v99, v100
  v_max3_f32 v115, v102, v103, v104
  v_min3_f32 v119, v102, v103, v104
  v_max3_f32 v120, v106, v107, v108
  v_min3_f32 v121, v106, v107, v108
  v_max_f32 v112, v112, v93
  v_min_f32 v116, v116, v93
  v_max_f32 v113, v113, v97
  v_min_f32 v117, v117, v97
  v_max_f32 v114, v114, v101
  v_min_f32 v118, v118, v101
  v_max_f32 v115, v115, v105
  v_min_f32 v119, v119, v105
  v_max_f32 v120, v120, v109
  v_min_f32 v121, v121, v109
  s_mov_b64 exec, s[56:57]
  v_max_f32 v112, v112, v120
  v_min_f32 v116, v116, v121
  s_mov_b64 exec, s[58:59]
  v_max_f32 v113, v113, v120
  v_min_f32 v117, v117, v121
  s_mov_b64 exec, s[84:85]
  v_max_f32 v114, v114, v120
  v_min_f32 v118, v118, v121
  s_mov_b64 exec, s[86:87]
  v_max_f32 v115, v115, v120
  v_min_f32 v119, v119, v121
  s_mov_b64 exec, -1
  v_permlane16_swap_b32 v112, v113
  v_permlane16_swap_b32 v116, v117
  v_permlane16_swap_b32 v114, v115
  v_permlane16_swap_b32 v118, v119
  v_max_f32 v112, v112, v113
  v_min_f32 v116, v116, v117
  v_max_f32 v114, v114, v115
  v_min_f32 v118, v118, v119
  s_nop 0
  v_permlane32_swap_b32 v112, v114
  v_permlane32_swap_b32 v116, v118
  v_max_f32 v112, v112, v114
  v_min_f32 v116, v116, v118
  v_mov_b32 v120, v112
  v_mov_b32 v121, v116
  v_mov_b32 v113, v112
  v_mov_b32 v117, v116
  s_nop 0
  v_permlane32_swap_b32 v112, v113
  v_permlane32_swap_b32 v116, v117
  v_mov_b32 v114, v112
  v_mov_b32 v118, v116
  v_mov_b32 v115, v113
  v_mov_b32 v119, v117
  v_permlane16_swap_b32 v112, v114
  v_permlane16_swap_b32 v116, v118
  v_permlane16_swap_b32 v113, v115
  v_permlane16_swap_b32 v117, v119
  v_mul_f32 v122, v112, v111
  v_mul_f32 v123, v116, v110
  v_mul_f32 v124, v114, v111
  v_mul_f32 v125, v118, v110
  v_mul_f32 v126, v113, v111
  v_mul_f32 v127, v117, v110
  v_mul_f32 v128, v115, v111
  v_mul_f32 v129, v119, v110
  v_mul_f32 v130, v120, v111
  v_mul_f32 v131, v121, v110
  v_pk_fma_f32 v[112:113], v[90:91], v[110:111], v[122:123] op_sel:[0,1,1] op_sel_hi:[1,1,1]
  v_pk_fma_f32 v[114:115], v[92:93], v[110:111], v[122:123] op_sel:[0,1,1] op_sel_hi:[1,1,1]
  v_pk_fma_f32 v[90:91], v[90:91], v[110:111], v[122:123] op_sel_hi:[1,0,0]
  v_pk_fma_f32 v[92:93], v[92:93], v[110:111], v[122:123] op_sel_hi:[1,0,0]
  v_pk_fma_f32 v[116:117], v[94:95], v[110:111], v[124:125] op_sel:[0,1,1] op_sel_hi:[1,1,1]
  v_pk_fma_f32 v[118:119], v[96:97], v[110:111], v[124:125] op_sel:[0,1,1] op_sel_hi:[1,1,1]
  v_pk_fma_f32 v[94:95], v[94:95], v[110:111], v[124:125] op_sel_hi:[1,0,0]
  v_pk_fma_f32 v[96:97], v[96:97], v[110:111], v[124:125] op_sel_hi:[1,0,0]
  v_pk_fma_f32 v[132:133], v[98:99], v[110:111], v[126:127] op_sel:[0,1,1] op_sel_hi:[1,1,1]
  v_pk_fma_f32 v[134:135], v[100:101], v[110:111], v[126:127] op_sel:[0,1,1] op_sel_hi:[1,1,1]
  v_pk_fma_f32 v[98:99], v[98:99], v[110:111], v[126:127] op_sel_hi:[1,0,0]
  v_pk_fma_f32 v[100:101], v[100:101], v[110:111], v[126:127] op_sel_hi:[1,0,0]
  v_pk_fma_f32 v[136:137], v[102:103], v[110:111], v[128:129] op_sel:[0,1,1] op_sel_hi:[1,1,1]
  v_pk_fma_f32 v[138:139], v[104:105], v[110:111], v[128:129] op_sel:[0,1,1] op_sel_hi:[1,1,1]
  v_pk_fma_f32 v[102:103], v[102:103], v[110:111], v[128:129] op_sel_hi:[1,0,0]
  v_pk_fma_f32 v[104:105], v[104:105], v[110:111], v[128:129] op_sel_hi:[1,0,0]
  v_pk_fma_f32 v[140:141], v[106:107], v[110:111], v[130:131] op_sel:[0,1,1] op_sel_hi:[1,1,1]
  v_pk_fma_f32 v[142:143], v[108:109], v[110:111], v[130:131] op_sel:[0,1,1] op_sel_hi:[1,1,1]
  v_pk_fma_f32 v[106:107], v[106:107], v[110:111], v[130:131] op_sel_hi:[1,0,0]
  v_pk_fma_f32 v[108:109], v[108:109], v[110:111], v[130:131] op_sel_hi:[1,0,0]
  v_exp_f32 v90, v90
  v_exp_f32 v91, v91
  v_exp_f32 v92, v92
  v_exp_f32 v93, v93
  v_exp_f32 v112, v112
  v_exp_f32 v113, v113
  v_exp_f32 v114, v114
  v_exp_f32 v115, v115
  v_exp_f32 v94, v94
  v_exp_f32 v95, v95
  v_exp_f32 v96, v96
  v_exp_f32 v97, v97
  v_exp_f32 v116, v116
  v_exp_f32 v117, v117
  v_exp_f32 v118, v118
  v_exp_f32 v119, v119
  v_exp_f32 v98, v98
  v_exp_f32 v99, v99
  v_exp_f32 v100, v100
  v_exp_f32 v101, v101
  v_exp_f32 v132, v132
  v_exp_f32 v133, v133
  v_exp_f32 v134, v134
  v_exp_f32 v135, v135
  v_exp_f32 v102, v102
  v_exp_f32 v103, v103
  v_exp_f32 v104, v104
  v_exp_f32 v105, v105
  v_exp_f32 v136, v136
  v_exp_f32 v137, v137
  v_exp_f32 v138, v138
  v_exp_f32 v139, v139
  v_exp_f32 v106, v106
  v_exp_f32 v107, v107
  v_exp_f32 v108, v108
  v_exp_f32 v109, v109
  v_exp_f32 v140, v140
  v_exp_f32 v141, v141
  v_exp_f32 v142, v142
  v_exp_f32 v143, v143
  v_pk_add_f32 v[120:121], v[90:91], v[92:93]
  v_pk_add_f32 v[144:145], v[112:113], v[114:115]
  v_add_f32 v146, v120, v121
  v_add_f32 v150, v144, v145
  v_pk_add_f32 v[120:121], v[94:95], v[96:97]
  v_pk_add_f32 v[144:145], v[116:117], v[118:119]
  v_add_f32 v147, v120, v121
  v_add_f32 v151, v144, v145
  v_pk_add_f32 v[120:121], v[98:99], v[100:101]
  v_pk_add_f32 v[144:145], v[132:133], v[134:135]
  v_add_f32 v148, v120, v121
  v_add_f32 v152, v144, v145
  v_pk_add_f32 v[120:121], v[102:103], v[104:105]
  v_pk_add_f32 v[144:145], v[136:137], v[138:139]
  v_add_f32 v149, v120, v121
  v_add_f32 v153, v144, v145
  v_pk_add_f32 v[120:121], v[106:107], v[108:109]
  v_pk_add_f32 v[144:145], v[140:141], v[142:143]
  v_add_f32 v154, v120, v121
  v_add_f32 v155, v144, v145
  s_mov_b64 exec, s[56:57]
  v_add_f32 v146, v146, v154
  v_add_f32 v150, v150, v155
  s_mov_b64 exec, s[58:59]
  v_add_f32 v147, v147, v154
  v_add_f32 v151, v151, v155
  s_mov_b64 exec, s[84:85]
  v_add_f32 v148, v148, v154
  v_add_f32 v152, v152, v155
  s_mov_b64 exec, s[86:87]
  v_add_f32 v149, v149, v154
  v_add_f32 v153, v153, v155
  s_mov_b64 exec, -1
  v_permlane16_swap_b32 v146, v147
  v_permlane16_swap_b32 v150, v151
  v_permlane16_swap_b32 v148, v149
  v_permlane16_swap_b32 v152, v153
  v_add_f32 v146, v146, v147
  v_add_f32 v150, v150, v151
  v_add_f32 v148, v148, v149
  v_add_f32 v152, v152, v153
  s_nop 0
  v_permlane32_swap_b32 v146, v148
  v_permlane32_swap_b32 v150, v152
  v_add_f32 v146, v146, v148
  v_add_f32 v150, v150, v152
  v_mov_b32 v120, v146
  v_mov_b32 v121, v150
  v_mov_b32 v147, v146
  v_mov_b32 v151, v150
  s_nop 0
  v_permlane32_swap_b32 v146, v147
  v_permlane32_swap_b32 v150, v151
  v_mov_b32 v148, v146
  v_mov_b32 v152, v150
  v_mov_b32 v149, v147
  v_mov_b32 v153, v151
  v_permlane16_swap_b32 v146, v148
  v_permlane16_swap_b32 v150, v152
  v_permlane16_swap_b32 v147, v149
  v_permlane16_swap_b32 v151, v153
  v_rcp_f32 v122, v146
  v_rcp_f32 v123, v150
  v_rcp_f32 v124, v148
  v_rcp_f32 v125, v152
  v_rcp_f32 v126, v147
  v_rcp_f32 v127, v151
  v_rcp_f32 v128, v149
  v_rcp_f32 v129, v153
  v_rcp_f32 v130, v120
  v_rcp_f32 v131, v121
  v_pk_mul_f32 v[90:91], v[90:91], v[122:123] op_sel_hi:[1,0]
  v_pk_mul_f32 v[92:93], v[92:93], v[122:123] op_sel_hi:[1,0]
  v_pk_mul_f32 v[112:113], v[112:113], v[122:123] op_sel:[0,1] op_sel_hi:[1,1]
  v_pk_mul_f32 v[114:115], v[114:115], v[122:123] op_sel:[0,1] op_sel_hi:[1,1]
  v_pk_mul_f32 v[94:95], v[94:95], v[124:125] op_sel_hi:[1,0]
  v_pk_mul_f32 v[96:97], v[96:97], v[124:125] op_sel_hi:[1,0]
  v_pk_mul_f32 v[116:117], v[116:117], v[124:125] op_sel:[0,1] op_sel_hi:[1,1]
  v_pk_mul_f32 v[118:119], v[118:119], v[124:125] op_sel:[0,1] op_sel_hi:[1,1]
  v_pk_mul_f32 v[98:99], v[98:99], v[126:127] op_sel_hi:[1,0]
  v_pk_mul_f32 v[100:101], v[100:101], v[126:127] op_sel_hi:[1,0]
  v_pk_mul_f32 v[132:133], v[132:133], v[126:127] op_sel:[0,1] op_sel_hi:[1,1]
  v_pk_mul_f32 v[134:135], v[134:135], v[126:127] op_sel:[0,1] op_sel_hi:[1,1]
  v_pk_mul_f32 v[102:103], v[102:103], v[128:129] op_sel_hi:[1,0]
  v_pk_mul_f32 v[104:105], v[104:105], v[128:129] op_sel_hi:[1,0]
  v_pk_mul_f32 v[136:137], v[136:137], v[128:129] op_sel:[0,1] op_sel_hi:[1,1]
  v_pk_mul_f32 v[138:139], v[138:139], v[128:129] op_sel:[0,1] op_sel_hi:[1,1]
  v_pk_mul_f32 v[106:107], v[106:107], v[130:131] op_sel_hi:[1,0]
  v_pk_mul_f32 v[108:109], v[108:109], v[130:131] op_sel_hi:[1,0]
  v_pk_mul_f32 v[140:141], v[140:141], v[130:131] op_sel:[0,1] op_sel_hi:[1,1]
  v_pk_mul_f32 v[142:143], v[142:143], v[130:131] op_sel:[0,1] op_sel_hi:[1,1]
  v_cvt_pk_bf16_f32 v192, v90, v91
  v_cvt_pk_bf16_f32 v193, v92, v93
  v_cvt_pk_bf16_f32 v194, v112, v113
  v_cvt_pk_bf16_f32 v195, v114, v115
  v_cvt_pk_bf16_f32 v196, v94, v95
  v_cvt_pk_bf16_f32 v197, v96, v97
  v_cvt_pk_bf16_f32 v198, v116, v117
  v_cvt_pk_bf16_f32 v199, v118, v119
  v_cvt_pk_bf16_f32 v200, v98, v99
  v_cvt_pk_bf16_f32 v201, v100, v101
  v_cvt_pk_bf16_f32 v202, v132, v133
  v_cvt_pk_bf16_f32 v203, v134, v135
  v_cvt_pk_bf16_f32 v204, v102, v103
  v_cvt_pk_bf16_f32 v205, v104, v105
  v_cvt_pk_bf16_f32 v206, v136, v137
  v_cvt_pk_bf16_f32 v207, v138, v139
  v_cvt_pk_bf16_f32 v208, v106, v107
  v_cvt_pk_bf16_f32 v209, v108, v109
  v_cvt_pk_bf16_f32 v210, v140, v141
  v_cvt_pk_bf16_f32 v211, v142, v143
  v_mfma_f32_16x16x32_bf16 v[90:93], v[58:61], v[48:51], 0
  v_mfma_f32_16x16x32_bf16 v[106:109], v[74:77], v[48:51], 0
  v_mfma_f32_16x16x32_bf16 v[94:97], v[62:65], v[50:53], 0
  v_mfma_f32_16x16x32_bf16 v[106:109], v[78:81], v[50:53], v[106:109]
  v_mfma_f32_16x16x32_bf16 v[98:101], v[66:69], v[52:55], 0
  v_mfma_f32_16x16x32_bf16 v[106:109], v[82:85], v[52:55], v[106:109]
  v_mfma_f32_16x16x32_bf16 v[102:105], v[70:73], v[54:57], 0
  v_mfma_f32_16x16x32_bf16 v[106:109], v[86:89], v[54:57], v[106:109]
  v_mul_f32 v110, 0x3fb8aa3b, v36
  v_mul_f32 v111, 0xbfb8aa3b, v36
  v_max3_f32 v112, v90, v91, v92
  v_min3_f32 v116, v90, v91, v92
  v_max3_f32 v113, v94, v95, v96
  v_min3_f32 v117, v94, v95, v96
  v_max3_f32 v114, v98, v99, v100
  v_min3_f32 v118, v98, v99, v100
  v_max3_f32 v115, v102, v103, v104
  v_min3_f32 v119, v102, v103, v104
  v_max3_f32 v120, v106, v107, v108
  v_min3_f32 v121, v106, v107, v108
  v_max_f32 v112, v112, v93
  v_min_f32 v116, v116, v93
  v_max_f32 v113, v113, v97
  v_min_f32 v117, v117, v97
  v_max_f32 v114, v114, v101
  v_min_f32 v118, v118, v101
  v_max_f32 v115, v115, v105
  v_min_f32 v119, v119, v105
  v_max_f32 v120, v120, v109
  v_min_f32 v121, v121, v109
  s_mov_b64 exec, s[56:57]
  v_max_f32 v112, v112, v120
  v_min_f32 v116, v116, v121
  s_mov_b64 exec, s[58:59]
  v_max_f32 v113, v113, v120
  v_min_f32 v117, v117, v121
  s_mov_b64 exec, s[84:85]
  v_max_f32 v114, v114, v120
  v_min_f32 v118, v118, v121
  s_mov_b64 exec, s[86:87]
  v_max_f32 v115, v115, v120
  v_min_f32 v119, v119, v121
  s_mov_b64 exec, -1
  v_permlane16_swap_b32 v112, v113
  v_permlane16_swap_b32 v116, v117
  v_permlane16_swap_b32 v114, v115
  v_permlane16_swap_b32 v118, v119
  v_max_f32 v112, v112, v113
  v_min_f32 v116, v116, v117
  v_max_f32 v114, v114, v115
  v_min_f32 v118, v118, v119
  s_nop 0
  v_permlane32_swap_b32 v112, v114
  v_permlane32_swap_b32 v116, v118
  v_max_f32 v112, v112, v114
  v_min_f32 v116, v116, v118
  v_mov_b32 v120, v112
  v_mov_b32 v121, v116
  v_mov_b32 v113, v112
  v_mov_b32 v117, v116
  s_nop 0
  v_permlane32_swap_b32 v112, v113
  v_permlane32_swap_b32 v116, v117
  v_mov_b32 v114, v112
  v_mov_b32 v118, v116
  v_mov_b32 v115, v113
  v_mov_b32 v119, v117
  v_permlane16_swap_b32 v112, v114
  v_permlane16_swap_b32 v116, v118
  v_permlane16_swap_b32 v113, v115
  v_permlane16_swap_b32 v117, v119
  v_mul_f32 v122, v112, v111
  v_mul_f32 v123, v116, v110
  v_mul_f32 v124, v114, v111
  v_mul_f32 v125, v118, v110
  v_mul_f32 v126, v113, v111
  v_mul_f32 v127, v117, v110
  v_mul_f32 v128, v115, v111
  v_mul_f32 v129, v119, v110
  v_mul_f32 v130, v120, v111
  v_mul_f32 v131, v121, v110
  v_pk_fma_f32 v[112:113], v[90:91], v[110:111], v[122:123] op_sel:[0,1,1] op_sel_hi:[1,1,1]
  v_pk_fma_f32 v[114:115], v[92:93], v[110:111], v[122:123] op_sel:[0,1,1] op_sel_hi:[1,1,1]
  v_pk_fma_f32 v[90:91], v[90:91], v[110:111], v[122:123] op_sel_hi:[1,0,0]
  v_pk_fma_f32 v[92:93], v[92:93], v[110:111], v[122:123] op_sel_hi:[1,0,0]
  v_pk_fma_f32 v[116:117], v[94:95], v[110:111], v[124:125] op_sel:[0,1,1] op_sel_hi:[1,1,1]
  v_pk_fma_f32 v[118:119], v[96:97], v[110:111], v[124:125] op_sel:[0,1,1] op_sel_hi:[1,1,1]
  v_pk_fma_f32 v[94:95], v[94:95], v[110:111], v[124:125] op_sel_hi:[1,0,0]
  v_pk_fma_f32 v[96:97], v[96:97], v[110:111], v[124:125] op_sel_hi:[1,0,0]
  v_pk_fma_f32 v[132:133], v[98:99], v[110:111], v[126:127] op_sel:[0,1,1] op_sel_hi:[1,1,1]
  v_pk_fma_f32 v[134:135], v[100:101], v[110:111], v[126:127] op_sel:[0,1,1] op_sel_hi:[1,1,1]
  v_pk_fma_f32 v[98:99], v[98:99], v[110:111], v[126:127] op_sel_hi:[1,0,0]
  v_pk_fma_f32 v[100:101], v[100:101], v[110:111], v[126:127] op_sel_hi:[1,0,0]
  v_pk_fma_f32 v[136:137], v[102:103], v[110:111], v[128:129] op_sel:[0,1,1] op_sel_hi:[1,1,1]
  v_pk_fma_f32 v[138:139], v[104:105], v[110:111], v[128:129] op_sel:[0,1,1] op_sel_hi:[1,1,1]
  v_pk_fma_f32 v[102:103], v[102:103], v[110:111], v[128:129] op_sel_hi:[1,0,0]
  v_pk_fma_f32 v[104:105], v[104:105], v[110:111], v[128:129] op_sel_hi:[1,0,0]
  v_pk_fma_f32 v[140:141], v[106:107], v[110:111], v[130:131] op_sel:[0,1,1] op_sel_hi:[1,1,1]
  v_pk_fma_f32 v[142:143], v[108:109], v[110:111], v[130:131] op_sel:[0,1,1] op_sel_hi:[1,1,1]
  v_pk_fma_f32 v[106:107], v[106:107], v[110:111], v[130:131] op_sel_hi:[1,0,0]
  v_pk_fma_f32 v[108:109], v[108:109], v[110:111], v[130:131] op_sel_hi:[1,0,0]
  v_exp_f32 v90, v90
  v_exp_f32 v91, v91
  v_exp_f32 v92, v92
  v_exp_f32 v93, v93
  v_exp_f32 v112, v112
  v_exp_f32 v113, v113
  v_exp_f32 v114, v114
  v_exp_f32 v115, v115
  v_exp_f32 v94, v94
  v_exp_f32 v95, v95
  v_exp_f32 v96, v96
  v_exp_f32 v97, v97
  v_exp_f32 v116, v116
  v_exp_f32 v117, v117
  v_exp_f32 v118, v118
  v_exp_f32 v119, v119
  v_exp_f32 v98, v98
  v_exp_f32 v99, v99
  v_exp_f32 v100, v100
  v_exp_f32 v101, v101
  v_exp_f32 v132, v132
  v_exp_f32 v133, v133
  v_exp_f32 v134, v134
  v_exp_f32 v135, v135
  v_exp_f32 v102, v102
  v_exp_f32 v103, v103
  v_exp_f32 v104, v104
  v_exp_f32 v105, v105
  v_exp_f32 v136, v136
  v_exp_f32 v137, v137
  v_exp_f32 v138, v138
  v_exp_f32 v139, v139
  v_exp_f32 v106, v106
  v_exp_f32 v107, v107
  v_exp_f32 v108, v108
  v_exp_f32 v109, v109
  v_exp_f32 v140, v140
  v_exp_f32 v141, v141
  v_exp_f32 v142, v142
  v_exp_f32 v143, v143
  v_pk_add_f32 v[120:121], v[90:91], v[92:93]
  v_pk_add_f32 v[144:145], v[112:113], v[114:115]
  v_add_f32 v146, v120, v121
  v_add_f32 v150, v144, v145
  v_pk_add_f32 v[120:121], v[94:95], v[96:97]
  v_pk_add_f32 v[144:145], v[116:117], v[118:119]
  v_add_f32 v147, v120, v121
  v_add_f32 v151, v144, v145
  v_pk_add_f32 v[120:121], v[98:99], v[100:101]
  v_pk_add_f32 v[144:145], v[132:133], v[134:135]
  v_add_f32 v148, v120, v121
  v_add_f32 v152, v144, v145
  v_pk_add_f32 v[120:121], v[102:103], v[104:105]
  v_pk_add_f32 v[144:145], v[136:137], v[138:139]
  v_add_f32 v149, v120, v121
  v_add_f32 v153, v144, v145
  v_pk_add_f32 v[120:121], v[106:107], v[108:109]
  v_pk_add_f32 v[144:145], v[140:141], v[142:143]
  v_add_f32 v154, v120, v121
  v_add_f32 v155, v144, v145
  s_mov_b64 exec, s[56:57]
  v_add_f32 v146, v146, v154
  v_add_f32 v150, v150, v155
  s_mov_b64 exec, s[58:59]
  v_add_f32 v147, v147, v154
  v_add_f32 v151, v151, v155
  s_mov_b64 exec, s[84:85]
  v_add_f32 v148, v148, v154
  v_add_f32 v152, v152, v155
  s_mov_b64 exec, s[86:87]
  v_add_f32 v149, v149, v154
  v_add_f32 v153, v153, v155
  s_mov_b64 exec, -1
  v_permlane16_swap_b32 v146, v147
  v_permlane16_swap_b32 v150, v151
  v_permlane16_swap_b32 v148, v149
  v_permlane16_swap_b32 v152, v153
  v_add_f32 v146, v146, v147
  v_add_f32 v150, v150, v151
  v_add_f32 v148, v148, v149
  v_add_f32 v152, v152, v153
  s_nop 0
  v_permlane32_swap_b32 v146, v148
  v_permlane32_swap_b32 v150, v152
  v_add_f32 v146, v146, v148
  v_add_f32 v150, v150, v152
  v_mov_b32 v120, v146
  v_mov_b32 v121, v150
  v_mov_b32 v147, v146
  v_mov_b32 v151, v150
  s_nop 0
  v_permlane32_swap_b32 v146, v147
  v_permlane32_swap_b32 v150, v151
  v_mov_b32 v148, v146
  v_mov_b32 v152, v150
  v_mov_b32 v149, v147
  v_mov_b32 v153, v151
  v_permlane16_swap_b32 v146, v148
  v_permlane16_swap_b32 v150, v152
  v_permlane16_swap_b32 v147, v149
  v_permlane16_swap_b32 v151, v153
  v_rcp_f32 v122, v146
  v_rcp_f32 v123, v150
  v_rcp_f32 v124, v148
  v_rcp_f32 v125, v152
  v_rcp_f32 v126, v147
  v_rcp_f32 v127, v151
  v_rcp_f32 v128, v149
  v_rcp_f32 v129, v153
  v_rcp_f32 v130, v120
  v_rcp_f32 v131, v121
  v_pk_mul_f32 v[90:91], v[90:91], v[122:123] op_sel_hi:[1,0]
  v_pk_mul_f32 v[92:93], v[92:93], v[122:123] op_sel_hi:[1,0]
  v_pk_mul_f32 v[112:113], v[112:113], v[122:123] op_sel:[0,1] op_sel_hi:[1,1]
  v_pk_mul_f32 v[114:115], v[114:115], v[122:123] op_sel:[0,1] op_sel_hi:[1,1]
  v_pk_mul_f32 v[94:95], v[94:95], v[124:125] op_sel_hi:[1,0]
  v_pk_mul_f32 v[96:97], v[96:97], v[124:125] op_sel_hi:[1,0]
  v_pk_mul_f32 v[116:117], v[116:117], v[124:125] op_sel:[0,1] op_sel_hi:[1,1]
  v_pk_mul_f32 v[118:119], v[118:119], v[124:125] op_sel:[0,1] op_sel_hi:[1,1]
  v_pk_mul_f32 v[98:99], v[98:99], v[126:127] op_sel_hi:[1,0]
  v_pk_mul_f32 v[100:101], v[100:101], v[126:127] op_sel_hi:[1,0]
  v_pk_mul_f32 v[132:133], v[132:133], v[126:127] op_sel:[0,1] op_sel_hi:[1,1]
  v_pk_mul_f32 v[134:135], v[134:135], v[126:127] op_sel:[0,1] op_sel_hi:[1,1]
  v_pk_mul_f32 v[102:103], v[102:103], v[128:129] op_sel_hi:[1,0]
  v_pk_mul_f32 v[104:105], v[104:105], v[128:129] op_sel_hi:[1,0]
  v_pk_mul_f32 v[136:137], v[136:137], v[128:129] op_sel:[0,1] op_sel_hi:[1,1]
  v_pk_mul_f32 v[138:139], v[138:139], v[128:129] op_sel:[0,1] op_sel_hi:[1,1]
  v_pk_mul_f32 v[106:107], v[106:107], v[130:131] op_sel_hi:[1,0]
  v_pk_mul_f32 v[108:109], v[108:109], v[130:131] op_sel_hi:[1,0]
  v_pk_mul_f32 v[140:141], v[140:141], v[130:131] op_sel:[0,1] op_sel_hi:[1,1]
  v_pk_mul_f32 v[142:143], v[142:143], v[130:131] op_sel:[0,1] op_sel_hi:[1,1]
  v_cvt_pk_bf16_f32 v212, v90, v91
  v_cvt_pk_bf16_f32 v213, v92, v93
  v_cvt_pk_bf16_f32 v214, v112, v113
  v_cvt_pk_bf16_f32 v215, v114, v115
  v_cvt_pk_bf16_f32 v216, v94, v95
  v_cvt_pk_bf16_f32 v217, v96, v97
  v_cvt_pk_bf16_f32 v218, v116, v117
  v_cvt_pk_bf16_f32 v219, v118, v119
  v_cvt_pk_bf16_f32 v220, v98, v99
  v_cvt_pk_bf16_f32 v221, v100, v101
  v_cvt_pk_bf16_f32 v222, v132, v133
  v_cvt_pk_bf16_f32 v223, v134, v135
  v_cvt_pk_bf16_f32 v224, v102, v103
  v_cvt_pk_bf16_f32 v225, v104, v105
  v_cvt_pk_bf16_f32 v226, v136, v137
  v_cvt_pk_bf16_f32 v227, v138, v139
  v_cvt_pk_bf16_f32 v228, v106, v107
  v_cvt_pk_bf16_f32 v229, v108, v109
  v_cvt_pk_bf16_f32 v230, v140, v141
  v_cvt_pk_bf16_f32 v231, v142, v143
  s_waitcnt lgkmcnt(0)
  s_nop 7
L_ee_6:
  buffer_load_dwordx4 v[6:9], v12, s[8:11], 0 offen
  buffer_load_dwordx4 v[14:17], v13, s[8:11], 0 offen
  buffer_load_dwordx4 v[18:21], v184, s[8:11], 0 offen
  s_mul_i32 s8, s6, 0xa00
  s_add_u32 s8, s8, 0x24000
  v_lshl_add_u32 v22, v1, 4, s8
  v_mul_u32_u24 v23, 0xa0, v2
  v_lshl_add_u32 v23, v3, 3, v23
  v_add_u32 v24, s8, v23
  s_waitcnt vmcnt(2)
  ds_write_b128 v22, v[6:9]
  s_waitcnt vmcnt(1)
  ds_write_b128 v22, v[14:17] offset:1024
  s_mov_b32 exec_hi, 0
  s_waitcnt vmcnt(0)
  ds_write_b128 v22, v[18:21] offset:2048
  s_mov_b64 exec, -1
  ds_read_b64 v[26:27], v24 offset:0
  ds_read_b64 v[28:29], v24 offset:32
  ds_read_b64 v[30:31], v24 offset:64
  ds_read_b64 v[32:33], v24 offset:96
  ds_read_b64 v[38:39], v24 offset:128
  s_add_u32 s9, s64, 0
  s_and_b32 s9, s9, 1
  s_mul_i32 s9, s9, 0x5000
  s_mul_i32 s10, s64, 0x2800
  s_add_u32 s10, s10, s9
  s_add_u32 s10, s10, 0x1a4000
  s_add_u32 s9, s64, 1
  s_and_b32 s9, s9, 1
  s_mul_i32 s9, s9, 0x5000
  s_mul_i32 s11, s64, 0x2800
  s_add_u32 s11, s11, s9
  s_add_u32 s11, s11, 0x1a4000
  s_add_u32 s9, s64, 0
  s_and_b32 s9, s9, 1
  s_mul_i32 s9, s9, 0x5000
  s_mul_i32 s67, s64, 0x2800
  s_add_u32 s67, s67, s9
  s_add_u32 s67, s67, 0x1a5400
  s_add_u32 s9, s64, 1
  s_and_b32 s9, s9, 1
  s_mul_i32 s9, s9, 0x5000
  s_mul_i32 s68, s64, 0x2800
  s_add_u32 s68, s68, s9
  s_add_u32 s68, s68, 0x1a5400
  s_mul_i32 s66, s64, 0xc800
  v_add_u32 v22, s66, v10
  s_waitcnt lgkmcnt(0)
  s_barrier
  buffer_load_dwordx4 v[6:9], v185, s[20:23], s10 offen offset:0 sc1
  buffer_load_dwordx4 v[14:17], v185, s[20:23], s11 offen offset:0 sc1
  buffer_load_dwordx4 v[18:21], v185, s[20:23], s10 offen offset:1024 sc1
  buffer_load_dwordx4 v[40:43], v185, s[20:23], s11 offen offset:1024 sc1
  buffer_load_dwordx4 v[44:47], v185, s[20:23], s10 offen offset:2048 sc1
  buffer_load_dwordx4 v[48:51], v185, s[20:23], s11 offen offset:2048 sc1
  buffer_load_dwordx4 v[52:55], v185, s[20:23], s10 offen offset:3072 sc1
  buffer_load_dwordx4 v[56:59], v185, s[20:23], s11 offen offset:3072 sc1
  s_add_u32 s10, s10, 0x1000
  buffer_load_dwordx4 v[60:63], v185, s[20:23], s10 offen offset:0 sc1
  s_add_u32 s11, s11, 0x1000
  buffer_load_dwordx4 v[64:67], v185, s[20:23], s11 offen offset:0 sc1
  ds_read_b64_tr_b16 v[68:69], v22 offset:0
  ds_read_b64_tr_b16 v[70:71], v22 offset:1280
  ds_read_b64_tr_b16 v[72:73], v22 offset:32
  ds_read_b64_tr_b16 v[74:75], v22 offset:1312
  ds_read_b64_tr_b16 v[76:77], v22 offset:64
  ds_read_b64_tr_b16 v[78:79], v22 offset:1344
  ds_read_b64_tr_b16 v[80:81], v22 offset:96
  ds_read_b64_tr_b16 v[82:83], v22 offset:1376
  ds_read_b64_tr_b16 v[84:85], v22 offset:128
  ds_read_b64_tr_b16 v[86:87], v22 offset:1408
  s_waitcnt lgkmcnt(6)
  s_waitcnt vmcnt(9)
  v_mfma_f32_16x16x32_bf16 v[108:111], v[68:71], v[6:9], 0
  ds_read_b64_tr_b16 v[88:89], v22 offset:5120
  s_waitcnt vmcnt(8)
  v_mfma_f32_16x16x32_bf16 v[112:115], v[68:71], v[14:17], 0
  ds_read_b64_tr_b16 v[90:91], v22 offset:6400
  v_mfma_f32_16x16x32_bf16 v[116:119], v[72:75], v[6:9], 0
  ds_read_b64_tr_b16 v[92:93], v22 offset:5152
  v_mfma_f32_16x16x32_bf16 v[120:123], v[72:75], v[14:17], 0
  ds_read_b64_tr_b16 v[94:95], v22 offset:6432
  s_waitcnt lgkmcnt(6)
  v_mfma_f32_16x16x32_bf16 v[124:127], v[76:79], v[6:9], 0
  ds_read_b64_tr_b16 v[96:97], v22 offset:5184
  v_mfma_f32_16x16x32_bf16 v[128:131], v[76:79], v[14:17], 0
  ds_read_b64_tr_b16 v[98:99], v22 offset:6464
  v_mfma_f32_16x16x32_bf16 v[132:135], v[80:83], v[6:9], 0
  ds_read_b64_tr_b16 v[100:101], v22 offset:5216
  v_mfma_f32_16x16x32_bf16 v[136:139], v[80:83], v[14:17], 0
  ds_read_b64_tr_b16 v[102:103], v22 offset:6496
  s_waitcnt lgkmcnt(8)
  v_mfma_f32_16x16x32_bf16 v[140:143], v[84:87], v[6:9], 0
  ds_read_b64_tr_b16 v[104:105], v22 offset:5248
  v_mfma_f32_16x16x32_bf16 v[144:147], v[84:87], v[14:17], 0
  ds_read_b64_tr_b16 v[106:107], v22 offset:6528
  s_waitcnt lgkmcnt(6)
  s_waitcnt vmcnt(7)
  v_mfma_f32_16x16x32_bf16 v[108:111], v[88:91], v[18:21], v[108:111]
  ds_read_b64_tr_b16 v[68:69], v22 offset:10240
  s_waitcnt vmcnt(6)
  v_mfma_f32_16x16x32_bf16 v[112:115], v[88:91], v[40:43], v[112:115]
  ds_read_b64_tr_b16 v[70:71], v22 offset:11520
  v_mfma_f32_16x16x32_bf16 v[116:119], v[92:95], v[18:21], v[116:119]
  ds_read_b64_tr_b16 v[72:73], v22 offset:10272
  buffer_load_dwordx4 v[6:9], v186, s[20:23], s67 offen offset:0 sc1
  v_mfma_f32_16x16x32_bf16 v[120:123], v[92:95], v[40:43], v[120:123]
  ds_read_b64_tr_b16 v[74:75], v22 offset:11552
  s_waitcnt lgkmcnt(6)
  v_mfma_f32_16x16x32_bf16 v[124:127], v[96:99], v[18:21], v[124:127]
  ds_read_b64_tr_b16 v[76:77], v22 offset:10304
  v_mfma_f32_16x16x32_bf16 v[128:131], v[96:99], v[40:43], v[128:131]
  ds_read_b64_tr_b16 v[78:79], v22 offset:11584
  buffer_load_dwordx4 v[14:17], v186, s[20:23], s68 offen offset:0 sc1
  v_mfma_f32_16x16x32_bf16 v[132:135], v[100:103], v[18:21], v[132:135]
  ds_read_b64_tr_b16 v[80:81], v22 offset:10336
  v_mfma_f32_16x16x32_bf16 v[136:139], v[100:103], v[40:43], v[136:139]
  ds_read_b64_tr_b16 v[82:83], v22 offset:11616
  s_waitcnt lgkmcnt(8)
  v_mfma_f32_16x16x32_bf16 v[140:143], v[104:107], v[18:21], v[140:143]
  ds_read_b64_tr_b16 v[84:85], v22 offset:10368
  v_mfma_f32_16x16x32_bf16 v[144:147], v[104:107], v[40:43], v[144:147]
  ds_read_b64_tr_b16 v[86:87], v22 offset:11648
  s_waitcnt lgkmcnt(6)
  s_waitcnt vmcnt(7)
  v_mfma_f32_16x16x32_bf16 v[108:111], v[68:71], v[44:47], v[108:111]
  ds_read_b64_tr_b16 v[88:89], v22 offset:15360
  s_waitcnt vmcnt(6)
  v_mfma_f32_16x16x32_bf16 v[112:115], v[68:71], v[48:51], v[112:115]
  ds_read_b64_tr_b16 v[90:91], v22 offset:16640
  v_mfma_f32_16x16x32_bf16 v[116:119], v[72:75], v[44:47], v[116:119]
  ds_read_b64_tr_b16 v[92:93], v22 offset:15392
  buffer_load_dwordx4 v[18:21], v186, s[20:23], s67 offen offset:1024 sc1
  v_mfma_f32_16x16x32_bf16 v[120:123], v[72:75], v[48:51], v[120:123]
  ds_read_b64_tr_b16 v[94:95], v22 offset:16672
  s_waitcnt lgkmcnt(6)
  v_mfma_f32_16x16x32_bf16 v[124:127], v[76:79], v[44:47], v[124:127]
  ds_read_b64_tr_b16 v[96:97], v22 offset:15424
  v_mfma_f32_16x16x32_bf16 v[128:131], v[76:79], v[48:51], v[128:131]
  ds_read_b64_tr_b16 v[98:99], v22 offset:16704
  buffer_load_dwordx4 v[40:43], v186, s[20:23], s68 offen offset:1024 sc1
  v_mfma_f32_16x16x32_bf16 v[132:135], v[80:83], v[44:47], v[132:135]
  ds_read_b64_tr_b16 v[100:101], v22 offset:15456
  v_mfma_f32_16x16x32_bf16 v[136:139], v[80:83], v[48:51], v[136:139]
  ds_read_b64_tr_b16 v[102:103], v22 offset:16736
  s_waitcnt lgkmcnt(8)
  v_mfma_f32_16x16x32_bf16 v[140:143], v[84:87], v[44:47], v[140:143]
  ds_read_b64_tr_b16 v[104:105], v22 offset:15488
  v_mfma_f32_16x16x32_bf16 v[144:147], v[84:87], v[48:51], v[144:147]
  ds_read_b64_tr_b16 v[106:107], v22 offset:16768
  s_waitcnt lgkmcnt(6)
  s_waitcnt vmcnt(7)
  v_mfma_f32_16x16x32_bf16 v[108:111], v[88:91], v[52:55], v[108:111]
  ds_read_b64_tr_b16 v[68:69], v22 offset:20480
  s_waitcnt vmcnt(6)
  v_mfma_f32_16x16x32_bf16 v[112:115], v[88:91], v[56:59], v[112:115]
  ds_read_b64_tr_b16 v[70:71], v22 offset:21760
  v_mfma_f32_16x16x32_bf16 v[116:119], v[92:95], v[52:55], v[116:119]
  ds_read_b64_tr_b16 v[72:73], v22 offset:20512
  buffer_load_dwordx4 v[44:47], v186, s[20:23], s67 offen offset:2048 sc1
  v_mfma_f32_16x16x32_bf16 v[120:123], v[92:95], v[56:59], v[120:123]
  ds_read_b64_tr_b16 v[74:75], v22 offset:21792
  s_waitcnt lgkmcnt(6)
  v_mfma_f32_16x16x32_bf16 v[124:127], v[96:99], v[52:55], v[124:127]
  ds_read_b64_tr_b16 v[76:77], v22 offset:20544
  v_mfma_f32_16x16x32_bf16 v[128:131], v[96:99], v[56:59], v[128:131]
  ds_read_b64_tr_b16 v[78:79], v22 offset:21824
  buffer_load_dwordx4 v[48:51], v186, s[20:23], s68 offen offset:2048 sc1
  v_mfma_f32_16x16x32_bf16 v[132:135], v[100:103], v[52:55], v[132:135]
  ds_read_b64_tr_b16 v[80:81], v22 offset:20576
  v_mfma_f32_16x16x32_bf16 v[136:139], v[100:103], v[56:59], v[136:139]
  ds_read_b64_tr_b16 v[82:83], v22 offset:21856
  s_waitcnt lgkmcnt(8)
  v_mfma_f32_16x16x32_bf16 v[140:143], v[104:107], v[52:55], v[140:143]
  ds_read_b64_tr_b16 v[84:85], v22 offset:20608
  v_mfma_f32_16x16x32_bf16 v[144:147], v[104:107], v[56:59], v[144:147]
  ds_read_b64_tr_b16 v[86:87], v22 offset:21888
  s_waitcnt lgkmcnt(6)
  s_waitcnt vmcnt(7)
  v_mfma_f32_16x16x32_bf16 v[108:111], v[68:71], v[60:63], v[108:111]
  ds_read_b64_tr_b16 v[88:89], v22 offset:25600
  s_waitcnt vmcnt(6)
  v_mfma_f32_16x16x32_bf16 v[112:115], v[68:71], v[64:67], v[112:115]
  ds_read_b64_tr_b16 v[90:91], v22 offset:26880
  v_mfma_f32_16x16x32_bf16 v[116:119], v[72:75], v[60:63], v[116:119]
  ds_read_b64_tr_b16 v[92:93], v22 offset:25632
  buffer_load_dwordx4 v[52:55], v186, s[20:23], s67 offen offset:3072 sc1
  v_mfma_f32_16x16x32_bf16 v[120:123], v[72:75], v[64:67], v[120:123]
  ds_read_b64_tr_b16 v[94:95], v22 offset:26912
  s_waitcnt lgkmcnt(6)
  v_mfma_f32_16x16x32_bf16 v[124:127], v[76:79], v[60:63], v[124:127]
  ds_read_b64_tr_b16 v[96:97], v22 offset:25664
  v_mfma_f32_16x16x32_bf16 v[128:131], v[76:79], v[64:67], v[128:131]
  ds_read_b64_tr_b16 v[98:99], v22 offset:26944
  buffer_load_dwordx4 v[56:59], v186, s[20:23], s68 offen offset:3072 sc1
  v_mfma_f32_16x16x32_bf16 v[132:135], v[80:83], v[60:63], v[132:135]
  ds_read_b64_tr_b16 v[100:101], v22 offset:25696
  v_mfma_f32_16x16x32_bf16 v[136:139], v[80:83], v[64:67], v[136:139]
  ds_read_b64_tr_b16 v[102:103], v22 offset:26976
  s_waitcnt lgkmcnt(8)
  v_mfma_f32_16x16x32_bf16 v[140:143], v[84:87], v[60:63], v[140:143]
  ds_read_b64_tr_b16 v[104:105], v22 offset:25728
  v_mfma_f32_16x16x32_bf16 v[144:147], v[84:87], v[64:67], v[144:147]
  ds_read_b64_tr_b16 v[106:107], v22 offset:27008
  s_barrier
  s_waitcnt lgkmcnt(6)
  s_waitcnt vmcnt(7)
  v_mfma_f32_16x16x32_bf16 v[108:111], v[88:91], v[6:9], v[108:111]
  ds_read_b64_tr_b16 v[68:69], v22 offset:30720
  s_waitcnt vmcnt(6)
  v_mfma_f32_16x16x32_bf16 v[112:115], v[88:91], v[14:17], v[112:115]
  ds_read_b64_tr_b16 v[70:71], v22 offset:32000
  s_add_u32 s67, s67, 0x1000
  v_mfma_f32_16x16x32_bf16 v[116:119], v[92:95], v[6:9], v[116:119]
  ds_read_b64_tr_b16 v[72:73], v22 offset:30752
  v_mfma_f32_16x16x32_bf16 v[120:123], v[92:95], v[14:17], v[120:123]
  ds_read_b64_tr_b16 v[74:75], v22 offset:32032
  buffer_load_dwordx4 v[60:63], v186, s[20:23], s67 offen offset:0 sc1
  s_waitcnt lgkmcnt(6)
  v_mfma_f32_16x16x32_bf16 v[124:127], v[96:99], v[6:9], v[124:127]
  ds_read_b64_tr_b16 v[76:77], v22 offset:30784
  v_mfma_f32_16x16x32_bf16 v[128:131], v[96:99], v[14:17], v[128:131]
  ds_read_b64_tr_b16 v[78:79], v22 offset:32064
  s_add_u32 s68, s68, 0x1000
  v_mfma_f32_16x16x32_bf16 v[132:135], v[100:103], v[6:9], v[132:135]
  ds_read_b64_tr_b16 v[80:81], v22 offset:30816
  v_mfma_f32_16x16x32_bf16 v[136:139], v[100:103], v[14:17], v[136:139]
  ds_read_b64_tr_b16 v[82:83], v22 offset:32096
  buffer_load_dwordx4 v[64:67], v186, s[20:23], s68 offen offset:0 sc1
  s_waitcnt lgkmcnt(8)
  v_mfma_f32_16x16x32_bf16 v[140:143], v[104:107], v[6:9], v[140:143]
  ds_read_b64_tr_b16 v[84:85], v22 offset:30848
  v_mfma_f32_16x16x32_bf16 v[144:147], v[104:107], v[14:17], v[144:147]
  ds_read_b64_tr_b16 v[86:87], v22 offset:32128
  s_waitcnt lgkmcnt(6)
  s_waitcnt vmcnt(7)
  v_mfma_f32_16x16x32_bf16 v[108:111], v[68:71], v[18:21], v[108:111]
  ds_read_b64_tr_b16 v[88:89], v22 offset:35840
  s_waitcnt vmcnt(6)
  v_mfma_f32_16x16x32_bf16 v[112:115], v[68:71], v[40:43], v[112:115]
  ds_read_b64_tr_b16 v[90:91], v22 offset:37120
  v_mfma_f32_16x16x32_bf16 v[116:119], v[72:75], v[18:21], v[116:119]
  ds_read_b64_tr_b16 v[92:93], v22 offset:35872
  v_mfma_f32_16x16x32_bf16 v[120:123], v[72:75], v[40:43], v[120:123]
  ds_read_b64_tr_b16 v[94:95], v22 offset:37152
  s_waitcnt lgkmcnt(6)
  v_mfma_f32_16x16x32_bf16 v[124:127], v[76:79], v[18:21], v[124:127]
  ds_read_b64_tr_b16 v[96:97], v22 offset:35904
  v_mfma_f32_16x16x32_bf16 v[128:131], v[76:79], v[40:43], v[128:131]
  ds_read_b64_tr_b16 v[98:99], v22 offset:37184
  v_mfma_f32_16x16x32_bf16 v[132:135], v[80:83], v[18:21], v[132:135]
  ds_read_b64_tr_b16 v[100:101], v22 offset:35936
  v_mfma_f32_16x16x32_bf16 v[136:139], v[80:83], v[40:43], v[136:139]
  ds_read_b64_tr_b16 v[102:103], v22 offset:37216
  s_waitcnt lgkmcnt(8)
  v_mfma_f32_16x16x32_bf16 v[140:143], v[84:87], v[18:21], v[140:143]
  ds_read_b64_tr_b16 v[104:105], v22 offset:35968
  v_mfma_f32_16x16x32_bf16 v[144:147], v[84:87], v[40:43], v[144:147]
  ds_read_b64_tr_b16 v[106:107], v22 offset:37248
  s_waitcnt lgkmcnt(6)
  s_waitcnt vmcnt(5)
  v_mfma_f32_16x16x32_bf16 v[108:111], v[88:91], v[44:47], v[108:111]
  ds_read_b64_tr_b16 v[68:69], v22 offset:40960
  s_waitcnt vmcnt(4)
  v_mfma_f32_16x16x32_bf16 v[112:115], v[88:91], v[48:51], v[112:115]
  ds_read_b64_tr_b16 v[70:71], v22 offset:42240
  v_mfma_f32_16x16x32_bf16 v[116:119], v[92:95], v[44:47], v[116:119]
  ds_read_b64_tr_b16 v[72:73], v22 offset:40992
  v_mfma_f32_16x16x32_bf16 v[120:123], v[92:95], v[48:51], v[120:123]
  ds_read_b64_tr_b16 v[74:75], v22 offset:42272
  s_waitcnt lgkmcnt(6)
  v_mfma_f32_16x16x32_bf16 v[124:127], v[96:99], v[44:47], v[124:127]
  ds_read_b64_tr_b16 v[76:77], v22 offset:41024
  v_mfma_f32_16x16x32_bf16 v[128:131], v[96:99], v[48:51], v[128:131]
  ds_read_b64_tr_b16 v[78:79], v22 offset:42304
  v_mfma_f32_16x16x32_bf16 v[132:135], v[100:103], v[44:47], v[132:135]
  ds_read_b64_tr_b16 v[80:81], v22 offset:41056
  v_mfma_f32_16x16x32_bf16 v[136:139], v[100:103], v[48:51], v[136:139]
  ds_read_b64_tr_b16 v[82:83], v22 offset:42336
  s_waitcnt lgkmcnt(8)
  v_mfma_f32_16x16x32_bf16 v[140:143], v[104:107], v[44:47], v[140:143]
  ds_read_b64_tr_b16 v[84:85], v22 offset:41088
  v_mfma_f32_16x16x32_bf16 v[144:147], v[104:107], v[48:51], v[144:147]
  ds_read_b64_tr_b16 v[86:87], v22 offset:42368
  s_waitcnt lgkmcnt(6)
  s_waitcnt vmcnt(3)
  v_mfma_f32_16x16x32_bf16 v[108:111], v[68:71], v[52:55], v[108:111]
  ds_read_b64_tr_b16 v[88:89], v22 offset:46080
  s_waitcnt vmcnt(2)
  v_mfma_f32_16x16x32_bf16 v[112:115], v[68:71], v[56:59], v[112:115]
  ds_read_b64_tr_b16 v[90:91], v22 offset:47360
  v_mfma_f32_16x16x32_bf16 v[116:119], v[72:75], v[52:55], v[116:119]
  ds_read_b64_tr_b16 v[92:93], v22 offset:46112
  v_mfma_f32_16x16x32_bf16 v[120:123], v[72:75], v[56:59], v[120:123]
  ds_read_b64_tr_b16 v[94:95], v22 offset:47392
  s_waitcnt lgkmcnt(6)
  v_mfma_f32_16x16x32_bf16 v[124:127], v[76:79], v[52:55], v[124:127]
  ds_read_b64_tr_b16 v[96:97], v22 offset:46144
  v_mfma_f32_16x16x32_bf16 v[128:131], v[76:79], v[56:59], v[128:131]
  ds_read_b64_tr_b16 v[98:99], v22 offset:47424
  v_mfma_f32_16x16x32_bf16 v[132:135], v[80:83], v[52:55], v[132:135]
  ds_read_b64_tr_b16 v[100:101], v22 offset:46176
  v_mfma_f32_16x16x32_bf16 v[136:139], v[80:83], v[56:59], v[136:139]
  ds_read_b64_tr_b16 v[102:103], v22 offset:47456
  s_waitcnt lgkmcnt(8)
  v_mfma_f32_16x16x32_bf16 v[140:143], v[84:87], v[52:55], v[140:143]
  ds_read_b64_tr_b16 v[104:105], v22 offset:46208
  v_mfma_f32_16x16x32_bf16 v[144:147], v[84:87], v[56:59], v[144:147]
  ds_read_b64_tr_b16 v[106:107], v22 offset:47488
  s_waitcnt lgkmcnt(6)
  s_waitcnt vmcnt(1)
  v_mfma_f32_16x16x32_bf16 v[108:111], v[88:91], v[60:63], v[108:111]
  s_waitcnt vmcnt(0)
  v_mfma_f32_16x16x32_bf16 v[112:115], v[88:91], v[64:67], v[112:115]
  v_mfma_f32_16x16x32_bf16 v[116:119], v[92:95], v[60:63], v[116:119]
  v_mfma_f32_16x16x32_bf16 v[120:123], v[92:95], v[64:67], v[120:123]
  s_waitcnt lgkmcnt(2)
  v_mfma_f32_16x16x32_bf16 v[124:127], v[96:99], v[60:63], v[124:127]
  v_mfma_f32_16x16x32_bf16 v[128:131], v[96:99], v[64:67], v[128:131]
  v_mfma_f32_16x16x32_bf16 v[132:135], v[100:103], v[60:63], v[132:135]
  v_mfma_f32_16x16x32_bf16 v[136:139], v[100:103], v[64:67], v[136:139]
  s_waitcnt lgkmcnt(0)
  v_mfma_f32_16x16x32_bf16 v[140:143], v[104:107], v[60:63], v[140:143]
  v_mfma_f32_16x16x32_bf16 v[144:147], v[104:107], v[64:67], v[144:147]
  s_mul_i32 s9, s6, 0x1400
  s_add_u32 s9, s9, 0x227c0
  v_lshl_add_u32 v6, v1, 4, s9
  s_xor_b32 s9, s6, 2
  s_mul_i32 s9, s9, 0x1400
  s_add_u32 s9, s9, 0x227c0
  v_lshl_add_u32 v7, v1, 4, s9
  ds_write_b128 v6, v[112:115] offset:0
  ds_write_b128 v6, v[120:123] offset:1024
  ds_write_b128 v6, v[128:131] offset:2048
  ds_write_b128 v6, v[136:139] offset:3072
  ds_write_b128 v6, v[144:147] offset:4096
  s_waitcnt lgkmcnt(0)
  s_barrier
  ds_read_b128 v[112:115], v7 offset:0
  ds_read_b128 v[120:123], v7 offset:1024
  ds_read_b128 v[128:131], v7 offset:2048
  ds_read_b128 v[136:139], v7 offset:3072
  ds_read_b128 v[144:147], v7 offset:4096
  s_waitcnt lgkmcnt(4)
  v_pk_add_f32 v[108:109], v[108:109], v[112:113]
  v_pk_add_f32 v[110:111], v[110:111], v[114:115]
  s_waitcnt lgkmcnt(3)
  v_pk_add_f32 v[116:117], v[116:117], v[120:121]
  v_pk_add_f32 v[118:119], v[118:119], v[122:123]
  s_waitcnt lgkmcnt(2)
  v_pk_add_f32 v[124:125], v[124:125], v[128:129]
  v_pk_add_f32 v[126:127], v[126:127], v[130:131]
  s_waitcnt lgkmcnt(1)
  v_pk_add_f32 v[132:133], v[132:133], v[136:137]
  v_pk_add_f32 v[134:135], v[134:135], v[138:139]
  s_waitcnt lgkmcnt(0)
  v_pk_add_f32 v[140:141], v[140:141], v[144:145]
  v_pk_add_f32 v[142:143], v[142:143], v[146:147]
  s_add_u32 s66, s65, s64
  s_and_b32 s66, s66, 7
  s_lshl_b32 s66, s66, 7
  s_add_u32 s66, s66, 0x27c00
  v_lshl_add_u32 v8, v2, 3, s66
  ds_read_b64 v[6:7], v8
  v_lshlrev_b32 v14, 16, v26
  v_and_b32 v15, 0xffff0000, v26
  v_lshlrev_b32 v16, 16, v27
  v_and_b32 v17, 0xffff0000, v27
  v_lshlrev_b32 v18, 16, v28
  v_and_b32 v19, 0xffff0000, v28
  v_lshlrev_b32 v20, 16, v29
  v_and_b32 v21, 0xffff0000, v29
  v_lshlrev_b32 v40, 16, v30
  v_and_b32 v41, 0xffff0000, v30
  v_lshlrev_b32 v42, 16, v31
  v_and_b32 v43, 0xffff0000, v31
  v_lshlrev_b32 v44, 16, v32
  v_and_b32 v45, 0xffff0000, v32
  v_lshlrev_b32 v46, 16, v33
  v_and_b32 v47, 0xffff0000, v33
  v_lshlrev_b32 v48, 16, v38
  v_and_b32 v49, 0xffff0000, v38
  v_lshlrev_b32 v50, 16, v39
  v_and_b32 v51, 0xffff0000, v39
  s_waitcnt lgkmcnt(0)
  v_pk_add_f32 v[26:27], v[14:15], v[6:7] op_sel_hi:[1,0]
  v_pk_fma_f32 v[108:109], v[26:27], v[6:7], v[108:109] op_sel:[0,1,0] op_sel_hi:[1,1,1]
  v_pk_add_f32 v[14:15], v[14:15], v[108:109]
  v_pk_mul_f32 v[30:31], v[108:109], v[108:109]
  v_mov_b32 v28, v108
  v_mov_b32 v29, v109
  v_pk_add_f32 v[26:27], v[16:17], v[6:7] op_sel_hi:[1,0]
  v_pk_fma_f32 v[110:111], v[26:27], v[6:7], v[110:111] op_sel:[0,1,0] op_sel_hi:[1,1,1]
  v_pk_add_f32 v[16:17], v[16:17], v[110:111]
  v_pk_fma_f32 v[30:31], v[110:111], v[110:111], v[30:31]
  v_pk_add_f32 v[28:29], v[28:29], v[110:111]
  v_pk_add_f32 v[26:27], v[18:19], v[6:7] op_sel_hi:[1,0]
  v_pk_fma_f32 v[116:117], v[26:27], v[6:7], v[116:117] op_sel:[0,1,0] op_sel_hi:[1,1,1]
  v_pk_add_f32 v[18:19], v[18:19], v[116:117]
  v_pk_fma_f32 v[30:31], v[116:117], v[116:117], v[30:31]
  v_pk_add_f32 v[28:29], v[28:29], v[116:117]
  v_pk_add_f32 v[26:27], v[20:21], v[6:7] op_sel_hi:[1,0]
  v_pk_fma_f32 v[118:119], v[26:27], v[6:7], v[118:119] op_sel:[0,1,0] op_sel_hi:[1,1,1]
  v_pk_add_f32 v[20:21], v[20:21], v[118:119]
  v_pk_fma_f32 v[30:31], v[118:119], v[118:119], v[30:31]
  v_pk_add_f32 v[28:29], v[28:29], v[118:119]
  v_pk_add_f32 v[26:27], v[40:41], v[6:7] op_sel_hi:[1,0]
  v_pk_fma_f32 v[124:125], v[26:27], v[6:7], v[124:125] op_sel:[0,1,0] op_sel_hi:[1,1,1]
  v_pk_add_f32 v[40:41], v[40:41], v[124:125]
  v_pk_fma_f32 v[30:31], v[124:125], v[124:125], v[30:31]
  v_pk_add_f32 v[28:29], v[28:29], v[124:125]
  v_pk_add_f32 v[26:27], v[42:43], v[6:7] op_sel_hi:[1,0]
  v_pk_fma_f32 v[126:127], v[26:27], v[6:7], v[126:127] op_sel:[0,1,0] op_sel_hi:[1,1,1]
  v_pk_add_f32 v[42:43], v[42:43], v[126:127]
  v_pk_fma_f32 v[30:31], v[126:127], v[126:127], v[30:31]
  v_pk_add_f32 v[28:29], v[28:29], v[126:127]
  v_pk_add_f32 v[26:27], v[44:45], v[6:7] op_sel_hi:[1,0]
  v_pk_fma_f32 v[132:133], v[26:27], v[6:7], v[132:133] op_sel:[0,1,0] op_sel_hi:[1,1,1]
  v_pk_add_f32 v[44:45], v[44:45], v[132:133]
  v_pk_fma_f32 v[30:31], v[132:133], v[132:133], v[30:31]
  v_pk_add_f32 v[28:29], v[28:29], v[132:133]
  v_pk_add_f32 v[26:27], v[46:47], v[6:7] op_sel_hi:[1,0]
  v_pk_fma_f32 v[134:135], v[26:27], v[6:7], v[134:135] op_sel:[0,1,0] op_sel_hi:[1,1,1]
  v_pk_add_f32 v[46:47], v[46:47], v[134:135]
  v_pk_fma_f32 v[30:31], v[134:135], v[134:135], v[30:31]
  v_pk_add_f32 v[28:29], v[28:29], v[134:135]
  v_pk_add_f32 v[26:27], v[48:49], v[6:7] op_sel_hi:[1,0]
  v_pk_fma_f32 v[140:141], v[26:27], v[6:7], v[140:141] op_sel:[0,1,0] op_sel_hi:[1,1,1]
  v_pk_add_f32 v[48:49], v[48:49], v[140:141]
  v_pk_fma_f32 v[30:31], v[140:141], v[140:141], v[30:31]
  v_pk_add_f32 v[28:29], v[28:29], v[140:141]
  v_pk_add_f32 v[26:27], v[50:51], v[6:7] op_sel_hi:[1,0]
  v_pk_fma_f32 v[142:143], v[26:27], v[6:7], v[142:143] op_sel:[0,1,0] op_sel_hi:[1,1,1]
  v_pk_add_f32 v[50:51], v[50:51], v[142:143]
  v_pk_fma_f32 v[30:31], v[142:143], v[142:143], v[30:31]
  v_pk_add_f32 v[28:29], v[28:29], v[142:143]
  v_add_f32 v28, v28, v29
  v_add_f32 v29, v30, v31
  s_nop 1
  v_permlane16_swap_b32 v28, v29
  v_add_f32 v28, v28, v29
  v_mov_b32 v29, v28
  s_nop 1
  v_permlane32_swap_b32 v28, v29
  v_add_f32 v28, v28, v29
  v_mov_b32 v29, v28
  s_nop 1
  v_permlane16_swap_b32 v28, v29
  v_cvt_pk_bf16_f32 v52, v108, v109
  v_cvt_pk_bf16_f32 v53, v110, v111
  v_cvt_pk_bf16_f32 v54, v116, v117
  v_cvt_pk_bf16_f32 v55, v118, v119
  v_cvt_pk_bf16_f32 v56, v124, v125
  v_cvt_pk_bf16_f32 v57, v126, v127
  v_cvt_pk_bf16_f32 v58, v132, v133
  v_cvt_pk_bf16_f32 v59, v134, v135
  v_cvt_pk_bf16_f32 v60, v140, v141
  v_cvt_pk_bf16_f32 v61, v142, v143
  v_mov_b32 v62, v60
  v_mov_b32 v63, v61
  v_permlane16_swap_b32 v52, v54
  v_permlane16_swap_b32 v53, v55
  v_permlane16_swap_b32 v56, v58
  v_permlane16_swap_b32 v57, v59
  v_permlane16_swap_b32 v60, v62
  v_permlane16_swap_b32 v61, v63
  v_lshrrev_b32 v8, 1, v3
  v_lshlrev_b32 v8, 8, v8
  v_lshl_add_u32 v9, v2, 4, v8
  v_add_u32 v9, 0x800, v9
  v_and_b32 v8, 1, v3
  v_cmp_eq_u32 vcc, 1, v8
  v_mov_b32 v8, 0x40000000
  s_nop 0
  v_cndmask_b32 v9, v9, v8, vcc
  v_lshlrev_b32 v11, 3, v2
  v_cmp_eq_u32 vcc, 0, v3
  s_nop 1
  v_cndmask_b32 v11, v8, v11, vcc
  s_add_u32 s66, s65, s64
  s_mul_i32 s9, s66, 0x5000
  s_mul_i32 s10, s52, 0xa00
  s_add_u32 s9, s9, s10
  s_add_u32 s9, s9, 0x42e000
  buffer_store_dwordx4 v[52:55], v189, s[20:23], s9 offen offset:0 sc1
  buffer_store_dwordx4 v[56:59], v189, s[20:23], s9 offen offset:1024 sc1
  buffer_store_dwordx4 v[60:63], v9, s[20:23], s9 offen sc1
  s_lshl_b32 s10, s66, 10
  s_lshl_b32 s66, s52, 7
  s_add_u32 s10, s10, s66
  s_add_u32 s10, s10, 0x184000
  buffer_store_dwordx2 v[28:29], v11, s[20:23], s10 offen sc1
  s_nop 1
  s_nop 7
  s_cmp_lg_u32 s53, 0
  s_cbranch_scc1 L_qb_20
  s_waitcnt vmcnt(0)
  s_barrier
  v_mfma_f32_16x16x32_bf16 v[6:9], v[212:215], v[244:247], 0
  v_mfma_f32_16x16x32_bf16 v[76:79], v[228:231], v[244:247], 0
  v_mfma_f32_16x16x32_bf16 v[26:29], v[216:219], v[246:249], 0
  v_mfma_f32_16x16x32_bf16 v[76:79], v[232:235], v[246:249], v[76:79]
  v_mfma_f32_16x16x32_bf16 v[30:33], v[220:223], v[248:251], 0
  v_mfma_f32_16x16x32_bf16 v[76:79], v[236:239], v[248:251], v[76:79]
  v_mfma_f32_16x16x32_bf16 v[72:75], v[224:227], v[250:253], 0
  v_mfma_f32_16x16x32_bf16 v[76:79], v[240:243], v[250:253], v[76:79]
  v_mul_f32 v38, 0x3fb8aa3b, v36
  v_mul_f32 v39, 0xbfb8aa3b, v36
  v_max3_f32 v11, v6, v7, v8
  v_min3_f32 v81, v6, v7, v8
  v_max3_f32 v23, v26, v27, v28
  v_min3_f32 v82, v26, v27, v28
  v_max3_f32 v25, v30, v31, v32
  v_min3_f32 v83, v30, v31, v32
  v_max3_f32 v80, v72, v73, v74
  v_min3_f32 v84, v72, v73, v74
  v_max3_f32 v85, v76, v77, v78
  v_min3_f32 v86, v76, v77, v78
  v_max_f32 v11, v11, v9
  v_min_f32 v81, v81, v9
  v_max_f32 v23, v23, v29
  v_min_f32 v82, v82, v29
  v_max_f32 v25, v25, v33
  v_min_f32 v83, v83, v33
  v_max_f32 v80, v80, v75
  v_min_f32 v84, v84, v75
  v_max_f32 v85, v85, v79
  v_min_f32 v86, v86, v79
  s_mov_b64 exec, s[56:57]
  v_max_f32 v11, v11, v85
  v_min_f32 v81, v81, v86
  s_mov_b64 exec, s[58:59]
  v_max_f32 v23, v23, v85
  v_min_f32 v82, v82, v86
  s_mov_b64 exec, s[84:85]
  v_max_f32 v25, v25, v85
  v_min_f32 v83, v83, v86
  s_mov_b64 exec, s[86:87]
  v_max_f32 v80, v80, v85
  v_min_f32 v84, v84, v86
  s_mov_b64 exec, -1
  v_permlane16_swap_b32 v11, v23
  v_permlane16_swap_b32 v81, v82
  v_permlane16_swap_b32 v25, v80
  v_permlane16_swap_b32 v83, v84
  v_max_f32 v11, v11, v23
  v_min_f32 v81, v81, v82
  v_max_f32 v25, v25, v80
  v_min_f32 v83, v83, v84
  s_nop 0
  v_permlane32_swap_b32 v11, v25
  v_permlane32_swap_b32 v81, v83
  v_max_f32 v11, v11, v25
  v_min_f32 v81, v81, v83
  v_mov_b32 v85, v11
  v_mov_b32 v86, v81
  v_mov_b32 v23, v11
  v_mov_b32 v82, v81
  s_nop 0
  v_permlane32_swap_b32 v11, v23
  v_permlane32_swap_b32 v81, v82
  v_mov_b32 v25, v11
  v_mov_b32 v83, v81
  v_mov_b32 v80, v23
  v_mov_b32 v84, v82
  v_permlane16_swap_b32 v11, v25
  v_permlane16_swap_b32 v81, v83
  v_permlane16_swap_b32 v23, v80
  v_permlane16_swap_b32 v82, v84
  v_mul_f32 v88, v11, v39
  v_mul_f32 v89, v81, v38
  v_mul_f32 v90, v25, v39
  v_mul_f32 v91, v83, v38
  v_mul_f32 v92, v23, v39
  v_mul_f32 v93, v82, v38
  v_mul_f32 v94, v80, v39
  v_mul_f32 v95, v84, v38
  v_mul_f32 v96, v85, v39
  v_mul_f32 v97, v86, v38
  v_pk_fma_f32 v[80:81], v[6:7], v[38:39], v[88:89] op_sel:[0,1,1] op_sel_hi:[1,1,1]
  v_pk_fma_f32 v[82:83], v[8:9], v[38:39], v[88:89] op_sel:[0,1,1] op_sel_hi:[1,1,1]
  v_pk_fma_f32 v[6:7], v[6:7], v[38:39], v[88:89] op_sel_hi:[1,0,0]
  v_pk_fma_f32 v[8:9], v[8:9], v[38:39], v[88:89] op_sel_hi:[1,0,0]
  v_pk_fma_f32 v[84:85], v[26:27], v[38:39], v[90:91] op_sel:[0,1,1] op_sel_hi:[1,1,1]
  v_pk_fma_f32 v[86:87], v[28:29], v[38:39], v[90:91] op_sel:[0,1,1] op_sel_hi:[1,1,1]
  v_pk_fma_f32 v[26:27], v[26:27], v[38:39], v[90:91] op_sel_hi:[1,0,0]
  v_pk_fma_f32 v[28:29], v[28:29], v[38:39], v[90:91] op_sel_hi:[1,0,0]
  v_pk_fma_f32 v[98:99], v[30:31], v[38:39], v[92:93] op_sel:[0,1,1] op_sel_hi:[1,1,1]
  v_pk_fma_f32 v[100:101], v[32:33], v[38:39], v[92:93] op_sel:[0,1,1] op_sel_hi:[1,1,1]
  v_pk_fma_f32 v[30:31], v[30:31], v[38:39], v[92:93] op_sel_hi:[1,0,0]
  v_pk_fma_f32 v[32:33], v[32:33], v[38:39], v[92:93] op_sel_hi:[1,0,0]
  v_pk_fma_f32 v[102:103], v[72:73], v[38:39], v[94:95] op_sel:[0,1,1] op_sel_hi:[1,1,1]
  v_pk_fma_f32 v[104:105], v[74:75], v[38:39], v[94:95] op_sel:[0,1,1] op_sel_hi:[1,1,1]
  v_pk_fma_f32 v[72:73], v[72:73], v[38:39], v[94:95] op_sel_hi:[1,0,0]
  v_pk_fma_f32 v[74:75], v[74:75], v[38:39], v[94:95] op_sel_hi:[1,0,0]
  v_pk_fma_f32 v[106:107], v[76:77], v[38:39], v[96:97] op_sel:[0,1,1] op_sel_hi:[1,1,1]
  v_pk_fma_f32 v[108:109], v[78:79], v[38:39], v[96:97] op_sel:[0,1,1] op_sel_hi:[1,1,1]
  v_pk_fma_f32 v[76:77], v[76:77], v[38:39], v[96:97] op_sel_hi:[1,0,0]
  v_pk_fma_f32 v[78:79], v[78:79], v[38:39], v[96:97] op_sel_hi:[1,0,0]
  v_exp_f32 v6, v6
  v_exp_f32 v7, v7
  v_exp_f32 v8, v8
  v_exp_f32 v9, v9
  v_exp_f32 v80, v80
  v_exp_f32 v81, v81
  v_exp_f32 v82, v82
  v_exp_f32 v83, v83
  v_exp_f32 v26, v26
  v_exp_f32 v27, v27
  v_exp_f32 v28, v28
  v_exp_f32 v29, v29
  v_exp_f32 v84, v84
  v_exp_f32 v85, v85
  v_exp_f32 v86, v86
  v_exp_f32 v87, v87
  v_exp_f32 v30, v30
  v_exp_f32 v31, v31
  v_exp_f32 v32, v32
  v_exp_f32 v33, v33
  v_exp_f32 v98, v98
  v_exp_f32 v99, v99
  v_exp_f32 v100, v100
  v_exp_f32 v101, v101
  v_exp_f32 v72, v72
  v_exp_f32 v73, v73
  v_exp_f32 v74, v74
  v_exp_f32 v75, v75
  v_exp_f32 v102, v102
  v_exp_f32 v103, v103
  v_exp_f32 v104, v104
  v_exp_f32 v105, v105
  v_exp_f32 v76, v76
  v_exp_f32 v77, v77
  v_exp_f32 v78, v78
  v_exp_f32 v79, v79
  v_exp_f32 v106, v106
  v_exp_f32 v107, v107
  v_exp_f32 v108, v108
  v_exp_f32 v109, v109
  v_pk_add_f32 v[110:111], v[6:7], v[8:9]
  v_pk_add_f32 v[112:113], v[80:81], v[82:83]
  v_add_f32 v11, v110, v111
  v_add_f32 v115, v112, v113
  v_pk_add_f32 v[110:111], v[26:27], v[28:29]
  v_pk_add_f32 v[112:113], v[84:85], v[86:87]
  v_add_f32 v23, v110, v111
  v_add_f32 v116, v112, v113
  v_pk_add_f32 v[110:111], v[30:31], v[32:33]
  v_pk_add_f32 v[112:113], v[98:99], v[100:101]
  v_add_f32 v25, v110, v111
  v_add_f32 v117, v112, v113
  v_pk_add_f32 v[110:111], v[72:73], v[74:75]
  v_pk_add_f32 v[112:113], v[102:103], v[104:105]
  v_add_f32 v114, v110, v111
  v_add_f32 v118, v112, v113
  v_pk_add_f32 v[110:111], v[76:77], v[78:79]
  v_pk_add_f32 v[112:113], v[106:107], v[108:109]
  v_add_f32 v119, v110, v111
  v_add_f32 v120, v112, v113
  s_mov_b64 exec, s[56:57]
  v_add_f32 v11, v11, v119
  v_add_f32 v115, v115, v120
  s_mov_b64 exec, s[58:59]
  v_add_f32 v23, v23, v119
  v_add_f32 v116, v116, v120
  s_mov_b64 exec, s[84:85]
  v_add_f32 v25, v25, v119
  v_add_f32 v117, v117, v120
  s_mov_b64 exec, s[86:87]
  v_add_f32 v114, v114, v119
  v_add_f32 v118, v118, v120
  s_mov_b64 exec, -1
  v_permlane16_swap_b32 v11, v23
  v_permlane16_swap_b32 v115, v116
  v_permlane16_swap_b32 v25, v114
  v_permlane16_swap_b32 v117, v118
  v_add_f32 v11, v11, v23
  v_add_f32 v115, v115, v116
  v_add_f32 v25, v25, v114
  v_add_f32 v117, v117, v118
  s_nop 0
  v_permlane32_swap_b32 v11, v25
  v_permlane32_swap_b32 v115, v117
  v_add_f32 v11, v11, v25
  v_add_f32 v115, v115, v117
  v_mov_b32 v110, v11
  v_mov_b32 v111, v115
  v_mov_b32 v23, v11
  v_mov_b32 v116, v115
  s_nop 0
  v_permlane32_swap_b32 v11, v23
  v_permlane32_swap_b32 v115, v116
  v_mov_b32 v25, v11
  v_mov_b32 v117, v115
  v_mov_b32 v114, v23
  v_mov_b32 v118, v116
  v_permlane16_swap_b32 v11, v25
  v_permlane16_swap_b32 v115, v117
  v_permlane16_swap_b32 v23, v114
  v_permlane16_swap_b32 v116, v118
  v_rcp_f32 v88, v11
  v_rcp_f32 v89, v115
  v_rcp_f32 v90, v25
  v_rcp_f32 v91, v117
  v_rcp_f32 v92, v23
  v_rcp_f32 v93, v116
  v_rcp_f32 v94, v114
  v_rcp_f32 v95, v118
  v_rcp_f32 v96, v110
  v_rcp_f32 v97, v111
  v_pk_mul_f32 v[6:7], v[6:7], v[88:89] op_sel_hi:[1,0]
  v_pk_mul_f32 v[8:9], v[8:9], v[88:89] op_sel_hi:[1,0]
  v_pk_mul_f32 v[80:81], v[80:81], v[88:89] op_sel:[0,1] op_sel_hi:[1,1]
  v_pk_mul_f32 v[82:83], v[82:83], v[88:89] op_sel:[0,1] op_sel_hi:[1,1]
  v_pk_mul_f32 v[26:27], v[26:27], v[90:91] op_sel_hi:[1,0]
  v_pk_mul_f32 v[28:29], v[28:29], v[90:91] op_sel_hi:[1,0]
  v_pk_mul_f32 v[84:85], v[84:85], v[90:91] op_sel:[0,1] op_sel_hi:[1,1]
  v_pk_mul_f32 v[86:87], v[86:87], v[90:91] op_sel:[0,1] op_sel_hi:[1,1]
  v_pk_mul_f32 v[30:31], v[30:31], v[92:93] op_sel_hi:[1,0]
  v_pk_mul_f32 v[32:33], v[32:33], v[92:93] op_sel_hi:[1,0]
  v_pk_mul_f32 v[98:99], v[98:99], v[92:93] op_sel:[0,1] op_sel_hi:[1,1]
  v_pk_mul_f32 v[100:101], v[100:101], v[92:93] op_sel:[0,1] op_sel_hi:[1,1]
  v_pk_mul_f32 v[72:73], v[72:73], v[94:95] op_sel_hi:[1,0]
  v_pk_mul_f32 v[74:75], v[74:75], v[94:95] op_sel_hi:[1,0]
  v_pk_mul_f32 v[102:103], v[102:103], v[94:95] op_sel:[0,1] op_sel_hi:[1,1]
  v_pk_mul_f32 v[104:105], v[104:105], v[94:95] op_sel:[0,1] op_sel_hi:[1,1]
  v_pk_mul_f32 v[76:77], v[76:77], v[96:97] op_sel_hi:[1,0]
  v_pk_mul_f32 v[78:79], v[78:79], v[96:97] op_sel_hi:[1,0]
  v_pk_mul_f32 v[106:107], v[106:107], v[96:97] op_sel:[0,1] op_sel_hi:[1,1]
  v_pk_mul_f32 v[108:109], v[108:109], v[96:97] op_sel:[0,1] op_sel_hi:[1,1]
  v_cvt_pk_bf16_f32 v52, v6, v7
  v_cvt_pk_bf16_f32 v53, v8, v9
  v_cvt_pk_bf16_f32 v54, v80, v81
  v_cvt_pk_bf16_f32 v55, v82, v83
  v_cvt_pk_bf16_f32 v56, v26, v27
  v_cvt_pk_bf16_f32 v57, v28, v29
  v_cvt_pk_bf16_f32 v58, v84, v85
  v_cvt_pk_bf16_f32 v59, v86, v87
  v_cvt_pk_bf16_f32 v60, v30, v31
  v_cvt_pk_bf16_f32 v61, v32, v33
  v_cvt_pk_bf16_f32 v62, v98, v99
  v_cvt_pk_bf16_f32 v63, v100, v101
  v_cvt_pk_bf16_f32 v64, v72, v73
  v_cvt_pk_bf16_f32 v65, v74, v75
  v_cvt_pk_bf16_f32 v66, v102, v103
  v_cvt_pk_bf16_f32 v67, v104, v105
  v_cvt_pk_bf16_f32 v68, v76, v77
  v_cvt_pk_bf16_f32 v69, v78, v79
  v_cvt_pk_bf16_f32 v70, v106, v107
  v_cvt_pk_bf16_f32 v71, v108, v109
  s_waitcnt lgkmcnt(0)
  s_nop 7
  s_branch L_qe_21
L_qb_20:
  s_lshl_b32 s9, s6, 4
  v_add_u32 v6, s9, v2
  v_mul_u32_u24 v6, 0x1f0, v6
  v_add_u32 v6, 0x1fbc0, v6
  v_lshl_add_u32 v7, v3, 3, v6
  v_lshl_add_u32 v23, v3, 4, v6
  v_mov_b32 v26, 0x3f80
  v_mov_b32 v27, 0
  v_bfe_u32 v8, v1, 2, 2
  v_lshlrev_b32 v8, 1, v8
  v_lshl_add_u32 v8, v3, 3, v8
  v_mul_u32_u24 v8, 0x1f0, v8
  v_add_u32 v8, 0x1fbc0, v8
  v_and_b32 v9, 3, v1
  v_lshl_add_u32 v11, v9, 3, v8
  s_lshl_b32 s9, s6, 6
  v_add_u32 v25, s9, v11
  s_lshl_b32 s9, s6, 4
  s_add_u32 s9, s9, 0x100
  v_add_u32 v28, s9, v11
  s_mul_i32 s9, s6, 40
  s_add_u32 s9, s9, 0x140
  v_add_u32 v29, s9, v11
  s_add_u32 s9, s9, 32
  v_add_u32 v11, s9, v8
  v_add_u32 v8, 0x1e0, v8
  v_cmp_eq_u32 vcc, 0, v9
  s_nop 1
  v_cndmask_b32 v30, v8, v11, vcc
  s_waitcnt vmcnt(0)
  s_barrier
  ds_write_b64 v7, v[232:233] offset:320
  ds_write_b64 v7, v[234:235] offset:352
  ds_write_b64 v7, v[236:237] offset:384
  ds_write_b64 v7, v[238:239] offset:416
  ds_write_b64 v7, v[240:241] offset:448
  ds_write_b64 v6, v[26:27] offset:480
  ds_write_b64 v7, v[192:193] offset:0
  ds_write_b64 v7, v[194:195] offset:32
  ds_write_b64 v7, v[196:197] offset:64
  ds_write_b64 v7, v[198:199] offset:96
  ds_write_b64 v7, v[200:201] offset:128
  ds_write_b64 v7, v[202:203] offset:160
  ds_write_b64 v7, v[204:205] offset:192
  ds_write_b64 v7, v[206:207] offset:224
  ds_write_b128 v23, v[208:211] offset:256
  s_waitcnt lgkmcnt(0)
  s_barrier
  ds_read_b64_tr_b16 v[108:109], v29 offset:0
  ds_read_b64_tr_b16 v[96:97], v25 offset:0
  ds_read_b64_tr_b16 v[100:101], v25 offset:32
  ds_read_b64_tr_b16 v[104:105], v28 offset:0
  ds_read_b64_tr_b16 v[112:113], v30 offset:0
  ds_read_b64_tr_b16 v[110:111], v29 offset:496
  ds_read_b64_tr_b16 v[98:99], v25 offset:496
  ds_read_b64_tr_b16 v[102:103], v25 offset:528
  ds_read_b64_tr_b16 v[106:107], v28 offset:496
  ds_read_b64_tr_b16 v[114:115], v30 offset:496
  s_waitcnt lgkmcnt(3)
  v_mfma_f32_16x16x32_bf16 v[72:75], v[96:99], v[108:111], 0
  s_waitcnt lgkmcnt(2)
  v_mfma_f32_16x16x32_bf16 v[76:79], v[100:103], v[108:111], 0
  s_waitcnt lgkmcnt(1)
  v_mfma_f32_16x16x32_bf16 v[80:83], v[104:107], v[108:111], 0
  s_waitcnt lgkmcnt(0)
  v_mfma_f32_16x16x32_bf16 v[84:87], v[96:99], v[112:115], 0
  v_mfma_f32_16x16x32_bf16 v[88:91], v[100:103], v[112:115], 0
  v_mfma_f32_16x16x32_bf16 v[92:95], v[104:107], v[112:115], 0
  ds_read_b64_tr_b16 v[128:129], v29 offset:15872
  ds_read_b64_tr_b16 v[116:117], v25 offset:15872
  ds_read_b64_tr_b16 v[120:121], v25 offset:15904
  ds_read_b64_tr_b16 v[124:125], v28 offset:15872
  ds_read_b64_tr_b16 v[132:133], v30 offset:15872
  ds_read_b64_tr_b16 v[130:131], v29 offset:16368
  ds_read_b64_tr_b16 v[118:119], v25 offset:16368
  ds_read_b64_tr_b16 v[122:123], v25 offset:16400
  ds_read_b64_tr_b16 v[126:127], v28 offset:16368
  ds_read_b64_tr_b16 v[134:135], v30 offset:16368
  s_waitcnt lgkmcnt(3)
  v_mfma_f32_16x16x32_bf16 v[72:75], v[116:119], v[128:131], v[72:75]
  s_waitcnt lgkmcnt(2)
  v_mfma_f32_16x16x32_bf16 v[76:79], v[120:123], v[128:131], v[76:79]
  s_waitcnt lgkmcnt(1)
  v_mfma_f32_16x16x32_bf16 v[80:83], v[124:127], v[128:131], v[80:83]
  s_waitcnt lgkmcnt(0)
  v_mfma_f32_16x16x32_bf16 v[84:87], v[116:119], v[132:135], v[84:87]
  v_mfma_f32_16x16x32_bf16 v[88:91], v[120:123], v[132:135], v[88:91]
  v_mfma_f32_16x16x32_bf16 v[92:95], v[124:127], v[132:135], v[92:95]
  s_waitcnt lgkmcnt(0)
  s_barrier
  ds_write_b64 v7, v[242:243] offset:320
  ds_write_b64 v7, v[244:245] offset:352
  ds_write_b64 v7, v[246:247] offset:384
  ds_write_b64 v7, v[248:249] offset:416
  ds_write_b64 v7, v[250:251] offset:448
  ds_write_b64 v6, v[26:27] offset:480
  ds_write_b64 v7, v[212:213] offset:0
  ds_write_b64 v7, v[214:215] offset:32
  ds_write_b64 v7, v[216:217] offset:64
  ds_write_b64 v7, v[218:219] offset:96
  ds_write_b64 v7, v[220:221] offset:128
  ds_write_b64 v7, v[222:223] offset:160
  ds_write_b64 v7, v[224:225] offset:192
  ds_write_b64 v7, v[226:227] offset:224
  ds_write_b128 v23, v[228:231] offset:256
  s_waitcnt lgkmcnt(0)
  s_barrier
  ds_read_b64_tr_b16 v[108:109], v29 offset:0
  ds_read_b64_tr_b16 v[96:97], v25 offset:0
  ds_read_b64_tr_b16 v[100:101], v25 offset:32
  ds_read_b64_tr_b16 v[104:105], v28 offset:0
  ds_read_b64_tr_b16 v[112:113], v30 offset:0
  ds_read_b64_tr_b16 v[110:111], v29 offset:496
  ds_read_b64_tr_b16 v[98:99], v25 offset:496
  ds_read_b64_tr_b16 v[102:103], v25 offset:528
  ds_read_b64_tr_b16 v[106:107], v28 offset:496
  ds_read_b64_tr_b16 v[114:115], v30 offset:496
  s_waitcnt lgkmcnt(3)
  v_mfma_f32_16x16x32_bf16 v[72:75], v[96:99], v[108:111], v[72:75]
  s_waitcnt lgkmcnt(2)
  v_mfma_f32_16x16x32_bf16 v[76:79], v[100:103], v[108:111], v[76:79]
  s_waitcnt lgkmcnt(1)
  v_mfma_f32_16x16x32_bf16 v[80:83], v[104:107], v[108:111], v[80:83]
  s_waitcnt lgkmcnt(0)
  v_mfma_f32_16x16x32_bf16 v[84:87], v[96:99], v[112:115], v[84:87]
  v_mfma_f32_16x16x32_bf16 v[88:91], v[100:103], v[112:115], v[88:91]
  v_mfma_f32_16x16x32_bf16 v[92:95], v[104:107], v[112:115], v[92:95]
  ds_read_b64_tr_b16 v[128:129], v29 offset:15872
  ds_read_b64_tr_b16 v[116:117], v25 offset:15872
  ds_read_b64_tr_b16 v[120:121], v25 offset:15904
  ds_read_b64_tr_b16 v[124:125], v28 offset:15872
  ds_read_b64_tr_b16 v[132:133], v30 offset:15872
  ds_read_b64_tr_b16 v[130:131], v29 offset:16368
  ds_read_b64_tr_b16 v[118:119], v25 offset:16368
  ds_read_b64_tr_b16 v[122:123], v25 offset:16400
  ds_read_b64_tr_b16 v[126:127], v28 offset:16368
  ds_read_b64_tr_b16 v[134:135], v30 offset:16368
  s_waitcnt lgkmcnt(3)
  v_mfma_f32_16x16x32_bf16 v[72:75], v[116:119], v[128:131], v[72:75]
  s_waitcnt lgkmcnt(2)
  v_mfma_f32_16x16x32_bf16 v[76:79], v[120:123], v[128:131], v[76:79]
  s_waitcnt lgkmcnt(1)
  v_mfma_f32_16x16x32_bf16 v[80:83], v[124:127], v[128:131], v[80:83]
  s_waitcnt lgkmcnt(0)
  v_mfma_f32_16x16x32_bf16 v[84:87], v[116:119], v[132:135], v[84:87]
  v_mfma_f32_16x16x32_bf16 v[88:91], v[120:123], v[132:135], v[88:91]
  v_mfma_f32_16x16x32_bf16 v[92:95], v[124:127], v[132:135], v[92:95]
  s_waitcnt lgkmcnt(0)
  v_cvt_pk_bf16_f32 v6, v72, v73
  v_cvt_pk_bf16_f32 v7, v74, v75
  v_cvt_pk_bf16_f32 v8, v76, v77
  v_cvt_pk_bf16_f32 v9, v78, v79
  v_cvt_pk_bf16_f32 v30, v80, v81
  v_cvt_pk_bf16_f32 v31, v82, v83
  v_cvt_pk_bf16_f32 v26, v84, v85
  v_cvt_pk_bf16_f32 v27, v86, v87
  v_cvt_pk_bf16_f32 v28, v88, v89
  v_cvt_pk_bf16_f32 v29, v90, v91
  v_cvt_pk_bf16_f32 v32, v92, v93
  v_cvt_pk_bf16_f32 v33, v94, v95
  v_lshlrev_b32 v11, 6, v2
  v_lshl_add_u32 v11, v3, 4, v11
  v_lshlrev_b32 v25, 4, v2
  v_lshl_add_u32 v25, v3, 3, v25
  v_add_u32 v25, 0x540, v25
  v_mov_b32 v39, 0x40000000
  v_cmp_gt_u32 s[10:11], 5, v2
  v_cmp_gt_u32 s[66:67], 2, v3
  v_add_u32 v23, 0x400, v11
  v_cndmask_b32 v23, v39, v23, s[10:11]
  v_cndmask_b32 v25, v39, v25, s[66:67]
  v_add_u32 v38, 0x100, v25
  v_cndmask_b32 v38, v39, v38, s[10:11]
  s_lshl_b32 s68, s52, 4
  s_add_u32 s68, s68, s4
  s_mul_i32 s68, s68, 0x1a40
  s_mul_i32 s69, s6, 0x690
  s_add_u32 s68, s68, s69
  s_add_u32 s68, s68, 0x4000
  buffer_store_dwordx4 v[6:9], v11, s[20:23], s68 offen sc1
  buffer_store_dwordx4 v[26:29], v23, s[20:23], s68 offen sc1
  buffer_store_dwordx2 v[30:31], v25, s[20:23], s68 offen sc1
  buffer_store_dwordx2 v[32:33], v38, s[20:23], s68 offen sc1
  s_nop 1
  s_barrier
  s_waitcnt lgkmcnt(0)
  s_nop 7
L_qe_21:
  s_lshl_b32 s9, s4, 2
  s_add_u32 s9, s9, s6
  s_lshl_b32 s9, s9, 1
  s_add_u32 s66, s9, 0
  s_mul_i32 s66, s66, 0x5000
  s_add_u32 s10, s66, 0x42e000
  s_add_u32 s66, s9, 1
  s_mul_i32 s66, s66, 0x5000
  s_add_u32 s11, s66, 0x42e000
  v_lshrrev_b32 v11, 1, v3
  v_lshlrev_b32 v11, 4, v11
  v_and_b32 v23, 1, v3
  v_lshl_add_u32 v11, v23, 2, v11
  v_bfe_u32 v23, v1, 2, 2
  v_add_u32 v11, v11, v23
  v_mul_u32_u24 v11, 0xe0, v11
  v_and_b32 v23, 3, v1
  v_lshl_add_u32 v11, v23, 3, v11
  v_add_u32 v23, 0xe000, v11
  v_add_u32 v25, 0x1c000, v11
  v_lshlrev_b32 v38, 8, v3
  v_lshl_add_u32 v38, v2, 3, v38
  s_add_u32 s66, s9, 0
  s_lshl_b32 s66, s66, 10
  s_add_u32 s67, s66, 0x184000
  s_add_u32 s66, s9, 1
  s_lshl_b32 s66, s66, 10
  s_add_u32 s68, s66, 0x184000
  s_waitcnt vmcnt(0)
  s_barrier
  buffer_load_dwordx4 v[6:9], v190, s[20:23], s10 offen offset:0 sc1
  buffer_load_dwordx4 v[26:29], v190, s[20:23], s11 offen offset:0 sc1
  buffer_load_dwordx4 v[30:33], v190, s[20:23], s10 offen offset:1024 sc1
  buffer_load_dwordx4 v[34:37], v190, s[20:23], s11 offen offset:1024 sc1
  buffer_load_dwordx4 v[72:75], v190, s[20:23], s10 offen offset:2048 sc1
  buffer_load_dwordx4 v[76:79], v190, s[20:23], s11 offen offset:2048 sc1
  buffer_load_dwordx4 v[80:83], v190, s[20:23], s10 offen offset:3072 sc1
  buffer_load_dwordx4 v[84:87], v190, s[20:23], s11 offen offset:3072 sc1
  buffer_load_dwordx2 v[186:187], v38, s[20:23], s67 offen offset:0 sc1
  buffer_load_dwordx2 v[224:225], v38, s[20:23], s67 offen offset:128 sc1
  buffer_load_dwordx2 v[226:227], v38, s[20:23], s68 offen offset:0 sc1
  buffer_load_dwordx2 v[228:229], v38, s[20:23], s68 offen offset:128 sc1
  ds_read_b64_tr_b16 v[112:113], v11 offset:0
  ds_read_b64_tr_b16 v[114:115], v11 offset:1792
  ds_read_b64_tr_b16 v[116:117], v11 offset:32
  ds_read_b64_tr_b16 v[118:119], v11 offset:1824
  ds_read_b64_tr_b16 v[120:121], v11 offset:64
  ds_read_b64_tr_b16 v[122:123], v11 offset:1856
  ds_read_b64_tr_b16 v[124:125], v11 offset:96
  ds_read_b64_tr_b16 v[126:127], v11 offset:1888
  ds_read_b64_tr_b16 v[128:129], v11 offset:128
  ds_read_b64_tr_b16 v[130:131], v11 offset:1920
  ds_read_b64_tr_b16 v[132:133], v11 offset:160
  ds_read_b64_tr_b16 v[134:135], v11 offset:1952
  ds_read_b64_tr_b16 v[136:137], v11 offset:192
  ds_read_b64_tr_b16 v[138:139], v11 offset:1984
  s_waitcnt lgkmcnt(10)
  s_waitcnt vmcnt(11)
  v_mfma_f32_16x16x32_bf16 v[140:143], v[112:115], v[6:9], 0
  s_waitcnt vmcnt(10)
  v_mfma_f32_16x16x32_bf16 v[144:147], v[112:115], v[26:29], 0
  v_mfma_f32_16x16x32_bf16 v[148:151], v[116:119], v[6:9], 0
  s_add_u32 s10, s10, 0x1000
  buffer_load_dwordx4 v[88:91], v190, s[20:23], s10 offen offset:0 sc1
  v_mfma_f32_16x16x32_bf16 v[152:155], v[116:119], v[26:29], 0
  ds_read_b64_tr_b16 v[112:113], v11 offset:7168
  ds_read_b64_tr_b16 v[114:115], v11 offset:8960
  s_waitcnt lgkmcnt(8)
  v_mfma_f32_16x16x32_bf16 v[156:159], v[120:123], v[6:9], 0
  s_add_u32 s11, s11, 0x1000
  buffer_load_dwordx4 v[92:95], v190, s[20:23], s11 offen offset:0 sc1
  v_mfma_f32_16x16x32_bf16 v[160:163], v[120:123], v[26:29], 0
  ds_read_b64_tr_b16 v[116:117], v11 offset:7200
  ds_read_b64_tr_b16 v[118:119], v11 offset:8992
  v_mfma_f32_16x16x32_bf16 v[164:167], v[124:127], v[6:9], 0
  ds_read_b64_tr_b16 v[120:121], v11 offset:7232
  v_mfma_f32_16x16x32_bf16 v[168:171], v[124:127], v[26:29], 0
  ds_read_b64_tr_b16 v[122:123], v11 offset:9024
  s_waitcnt lgkmcnt(8)
  v_mfma_f32_16x16x32_bf16 v[172:175], v[128:131], v[6:9], 0
  buffer_load_dwordx4 v[96:99], v190, s[20:23], s10 offen offset:1024 sc1
  v_mfma_f32_16x16x32_bf16 v[176:179], v[128:131], v[26:29], 0
  ds_read_b64_tr_b16 v[124:125], v11 offset:7264
  ds_read_b64_tr_b16 v[126:127], v11 offset:9056
  v_mfma_f32_16x16x32_bf16 v[180:183], v[132:135], v[6:9], 0
  buffer_load_dwordx4 v[100:103], v190, s[20:23], s11 offen offset:1024 sc1
  v_mfma_f32_16x16x32_bf16 v[212:215], v[132:135], v[26:29], 0
  ds_read_b64_tr_b16 v[128:129], v11 offset:7296
  ds_read_b64_tr_b16 v[130:131], v11 offset:9088
  s_waitcnt lgkmcnt(10)
  v_mfma_f32_16x16x32_bf16 v[216:219], v[136:139], v[6:9], 0
  ds_read_b64_tr_b16 v[132:133], v11 offset:7328
  v_mfma_f32_16x16x32_bf16 v[220:223], v[136:139], v[26:29], 0
  ds_read_b64_tr_b16 v[134:135], v11 offset:9120
  s_waitcnt lgkmcnt(8)
  s_waitcnt vmcnt(13)
  v_mfma_f32_16x16x32_bf16 v[140:143], v[112:115], v[30:33], v[140:143]
  ds_read_b64_tr_b16 v[136:137], v11 offset:7360
  s_waitcnt vmcnt(12)
  v_mfma_f32_16x16x32_bf16 v[144:147], v[112:115], v[34:37], v[144:147]
  ds_read_b64_tr_b16 v[138:139], v11 offset:9152
  v_mfma_f32_16x16x32_bf16 v[148:151], v[116:119], v[30:33], v[148:151]
  buffer_load_dwordx4 v[104:107], v190, s[20:23], s10 offen offset:2048 sc1
  v_mfma_f32_16x16x32_bf16 v[152:155], v[116:119], v[34:37], v[152:155]
  ds_read_b64_tr_b16 v[112:113], v11 offset:14336
  ds_read_b64_tr_b16 v[114:115], v11 offset:16128
  s_waitcnt lgkmcnt(8)
  v_mfma_f32_16x16x32_bf16 v[156:159], v[120:123], v[30:33], v[156:159]
  buffer_load_dwordx4 v[108:111], v190, s[20:23], s11 offen offset:2048 sc1
  v_mfma_f32_16x16x32_bf16 v[160:163], v[120:123], v[34:37], v[160:163]
  ds_read_b64_tr_b16 v[116:117], v11 offset:14368
  ds_read_b64_tr_b16 v[118:119], v11 offset:16160
  v_mfma_f32_16x16x32_bf16 v[164:167], v[124:127], v[30:33], v[164:167]
  ds_read_b64_tr_b16 v[120:121], v11 offset:14400
  v_mfma_f32_16x16x32_bf16 v[168:171], v[124:127], v[34:37], v[168:171]
  ds_read_b64_tr_b16 v[122:123], v11 offset:16192
  s_waitcnt lgkmcnt(8)
  v_mfma_f32_16x16x32_bf16 v[172:175], v[128:131], v[30:33], v[172:175]
  buffer_load_dwordx4 v[6:9], v190, s[20:23], s10 offen offset:3072 sc1
  v_mfma_f32_16x16x32_bf16 v[176:179], v[128:131], v[34:37], v[176:179]
  ds_read_b64_tr_b16 v[124:125], v11 offset:14432
  ds_read_b64_tr_b16 v[126:127], v11 offset:16224
  v_mfma_f32_16x16x32_bf16 v[180:183], v[132:135], v[30:33], v[180:183]
  buffer_load_dwordx4 v[26:29], v190, s[20:23], s11 offen offset:3072 sc1
  v_mfma_f32_16x16x32_bf16 v[212:215], v[132:135], v[34:37], v[212:215]
  ds_read_b64_tr_b16 v[128:129], v11 offset:14464
  ds_read_b64_tr_b16 v[130:131], v11 offset:16256
  s_waitcnt lgkmcnt(10)
  v_mfma_f32_16x16x32_bf16 v[216:219], v[136:139], v[30:33], v[216:219]
  ds_read_b64_tr_b16 v[132:133], v11 offset:14496
  v_mfma_f32_16x16x32_bf16 v[220:223], v[136:139], v[34:37], v[220:223]
  ds_read_b64_tr_b16 v[134:135], v11 offset:16288
  s_waitcnt lgkmcnt(8)
  s_waitcnt vmcnt(15)
  v_mfma_f32_16x16x32_bf16 v[140:143], v[112:115], v[72:75], v[140:143]
  ds_read_b64_tr_b16 v[136:137], v11 offset:14528
  s_waitcnt vmcnt(14)
  v_mfma_f32_16x16x32_bf16 v[144:147], v[112:115], v[76:79], v[144:147]
  ds_read_b64_tr_b16 v[138:139], v11 offset:16320
  v_mfma_f32_16x16x32_bf16 v[148:151], v[116:119], v[72:75], v[148:151]
  s_add_u32 s10, s10, 0x1000
  buffer_load_dwordx4 v[30:33], v190, s[20:23], s10 offen offset:0 sc1
  v_mfma_f32_16x16x32_bf16 v[152:155], v[116:119], v[76:79], v[152:155]
  ds_read_b64_tr_b16 v[112:113], v11 offset:21504
  ds_read_b64_tr_b16 v[114:115], v11 offset:23296
  s_waitcnt lgkmcnt(8)
  v_mfma_f32_16x16x32_bf16 v[156:159], v[120:123], v[72:75], v[156:159]
  s_add_u32 s11, s11, 0x1000
  buffer_load_dwordx4 v[34:37], v190, s[20:23], s11 offen offset:0 sc1
  v_mfma_f32_16x16x32_bf16 v[160:163], v[120:123], v[76:79], v[160:163]
  ds_read_b64_tr_b16 v[116:117], v11 offset:21536
  ds_read_b64_tr_b16 v[118:119], v11 offset:23328
  v_mfma_f32_16x16x32_bf16 v[164:167], v[124:127], v[72:75], v[164:167]
  ds_read_b64_tr_b16 v[120:121], v11 offset:21568
  v_mfma_f32_16x16x32_bf16 v[168:171], v[124:127], v[76:79], v[168:171]
  ds_read_b64_tr_b16 v[122:123], v11 offset:23360
  s_waitcnt lgkmcnt(8)
  v_mfma_f32_16x16x32_bf16 v[172:175], v[128:131], v[72:75], v[172:175]
  ds_read_b64_tr_b16 v[124:125], v11 offset:21600
  v_mfma_f32_16x16x32_bf16 v[176:179], v[128:131], v[76:79], v[176:179]
  ds_read_b64_tr_b16 v[126:127], v11 offset:23392
  v_mfma_f32_16x16x32_bf16 v[180:183], v[132:135], v[72:75], v[180:183]
  ds_read_b64_tr_b16 v[128:129], v11 offset:21632
  v_mfma_f32_16x16x32_bf16 v[212:215], v[132:135], v[76:79], v[212:215]
  ds_read_b64_tr_b16 v[130:131], v11 offset:23424
  s_waitcnt lgkmcnt(10)
  v_mfma_f32_16x16x32_bf16 v[216:219], v[136:139], v[72:75], v[216:219]
  ds_read_b64_tr_b16 v[132:133], v11 offset:21664
  v_mfma_f32_16x16x32_bf16 v[220:223], v[136:139], v[76:79], v[220:223]
  ds_read_b64_tr_b16 v[134:135], v11 offset:23456
  s_waitcnt lgkmcnt(8)
  s_waitcnt vmcnt(15)
  v_mfma_f32_16x16x32_bf16 v[140:143], v[112:115], v[80:83], v[140:143]
  ds_read_b64_tr_b16 v[136:137], v11 offset:21696
  s_waitcnt vmcnt(14)
  v_mfma_f32_16x16x32_bf16 v[144:147], v[112:115], v[84:87], v[144:147]
  ds_read_b64_tr_b16 v[138:139], v11 offset:23488
  v_mfma_f32_16x16x32_bf16 v[148:151], v[116:119], v[80:83], v[148:151]
  buffer_load_dwordx4 v[72:75], v190, s[20:23], s10 offen offset:1024 sc1
  v_mfma_f32_16x16x32_bf16 v[152:155], v[116:119], v[84:87], v[152:155]
  ds_read_b64_tr_b16 v[112:113], v11 offset:28672
  ds_read_b64_tr_b16 v[114:115], v11 offset:30464
  s_waitcnt lgkmcnt(8)
  v_mfma_f32_16x16x32_bf16 v[156:159], v[120:123], v[80:83], v[156:159]
  buffer_load_dwordx4 v[76:79], v190, s[20:23], s11 offen offset:1024 sc1
  v_mfma_f32_16x16x32_bf16 v[160:163], v[120:123], v[84:87], v[160:163]
  ds_read_b64_tr_b16 v[116:117], v11 offset:28704
  ds_read_b64_tr_b16 v[118:119], v11 offset:30496
  v_mfma_f32_16x16x32_bf16 v[164:167], v[124:127], v[80:83], v[164:167]
  ds_read_b64_tr_b16 v[120:121], v11 offset:28736
  v_mfma_f32_16x16x32_bf16 v[168:171], v[124:127], v[84:87], v[168:171]
  ds_read_b64_tr_b16 v[122:123], v11 offset:30528
  s_waitcnt lgkmcnt(8)
  v_mfma_f32_16x16x32_bf16 v[172:175], v[128:131], v[80:83], v[172:175]
  ds_read_b64_tr_b16 v[124:125], v11 offset:28768
  v_mfma_f32_16x16x32_bf16 v[176:179], v[128:131], v[84:87], v[176:179]
  ds_read_b64_tr_b16 v[126:127], v11 offset:30560
  v_mfma_f32_16x16x32_bf16 v[180:183], v[132:135], v[80:83], v[180:183]
  ds_read_b64_tr_b16 v[128:129], v11 offset:28800
  v_mfma_f32_16x16x32_bf16 v[212:215], v[132:135], v[84:87], v[212:215]
  ds_read_b64_tr_b16 v[130:131], v11 offset:30592
  s_waitcnt lgkmcnt(10)
  v_mfma_f32_16x16x32_bf16 v[216:219], v[136:139], v[80:83], v[216:219]
  ds_read_b64_tr_b16 v[132:133], v11 offset:28832
  v_mfma_f32_16x16x32_bf16 v[220:223], v[136:139], v[84:87], v[220:223]
  ds_read_b64_tr_b16 v[134:135], v11 offset:30624
  s_barrier
  s_waitcnt lgkmcnt(8)
  s_waitcnt vmcnt(11)
  v_mfma_f32_16x16x32_bf16 v[140:143], v[112:115], v[88:91], v[140:143]
  ds_read_b64_tr_b16 v[136:137], v11 offset:28864
  s_waitcnt vmcnt(10)
  v_mfma_f32_16x16x32_bf16 v[144:147], v[112:115], v[92:95], v[144:147]
  ds_read_b64_tr_b16 v[138:139], v11 offset:30656
  v_mfma_f32_16x16x32_bf16 v[148:151], v[116:119], v[88:91], v[148:151]
  buffer_load_dwordx4 v[80:83], v190, s[20:23], s10 offen offset:2048 sc1
  v_mfma_f32_16x16x32_bf16 v[152:155], v[116:119], v[92:95], v[152:155]
  ds_read_b64_tr_b16 v[112:113], v11 offset:35840
  ds_read_b64_tr_b16 v[114:115], v11 offset:37632
  s_waitcnt lgkmcnt(8)
  v_mfma_f32_16x16x32_bf16 v[156:159], v[120:123], v[88:91], v[156:159]
  buffer_load_dwordx4 v[84:87], v190, s[20:23], s11 offen offset:2048 sc1
  v_mfma_f32_16x16x32_bf16 v[160:163], v[120:123], v[92:95], v[160:163]
  ds_read_b64_tr_b16 v[116:117], v11 offset:35872
  ds_read_b64_tr_b16 v[118:119], v11 offset:37664
  v_mfma_f32_16x16x32_bf16 v[164:167], v[124:127], v[88:91], v[164:167]
  ds_read_b64_tr_b16 v[120:121], v11 offset:35904
  v_mfma_f32_16x16x32_bf16 v[168:171], v[124:127], v[92:95], v[168:171]
  ds_read_b64_tr_b16 v[122:123], v11 offset:37696
  s_waitcnt lgkmcnt(8)
  v_mfma_f32_16x16x32_bf16 v[172:175], v[128:131], v[88:91], v[172:175]
  ds_read_b64_tr_b16 v[124:125], v11 offset:35936
  v_mfma_f32_16x16x32_bf16 v[176:179], v[128:131], v[92:95], v[176:179]
  ds_read_b64_tr_b16 v[126:127], v11 offset:37728
  v_mfma_f32_16x16x32_bf16 v[180:183], v[132:135], v[88:91], v[180:183]
  ds_read_b64_tr_b16 v[128:129], v11 offset:35968
  v_mfma_f32_16x16x32_bf16 v[212:215], v[132:135], v[92:95], v[212:215]
  ds_read_b64_tr_b16 v[130:131], v11 offset:37760
  s_waitcnt lgkmcnt(10)
  v_mfma_f32_16x16x32_bf16 v[216:219], v[136:139], v[88:91], v[216:219]
  ds_read_b64_tr_b16 v[132:133], v11 offset:36000
  v_mfma_f32_16x16x32_bf16 v[220:223], v[136:139], v[92:95], v[220:223]
  ds_read_b64_tr_b16 v[134:135], v11 offset:37792
  s_waitcnt lgkmcnt(8)
  s_waitcnt vmcnt(11)
  v_mfma_f32_16x16x32_bf16 v[140:143], v[112:115], v[96:99], v[140:143]
  ds_read_b64_tr_b16 v[136:137], v11 offset:36032
  s_waitcnt vmcnt(10)
  v_mfma_f32_16x16x32_bf16 v[144:147], v[112:115], v[100:103], v[144:147]
  ds_read_b64_tr_b16 v[138:139], v11 offset:37824
  v_mfma_f32_16x16x32_bf16 v[148:151], v[116:119], v[96:99], v[148:151]
  buffer_load_dwordx4 v[88:91], v190, s[20:23], s10 offen offset:3072 sc1
  v_mfma_f32_16x16x32_bf16 v[152:155], v[116:119], v[100:103], v[152:155]
  ds_read_b64_tr_b16 v[112:113], v11 offset:43008
  ds_read_b64_tr_b16 v[114:115], v11 offset:44800
  s_waitcnt lgkmcnt(8)
  v_mfma_f32_16x16x32_bf16 v[156:159], v[120:123], v[96:99], v[156:159]
  buffer_load_dwordx4 v[92:95], v190, s[20:23], s11 offen offset:3072 sc1
  v_mfma_f32_16x16x32_bf16 v[160:163], v[120:123], v[100:103], v[160:163]
  ds_read_b64_tr_b16 v[116:117], v11 offset:43040
  ds_read_b64_tr_b16 v[118:119], v11 offset:44832
  v_mfma_f32_16x16x32_bf16 v[164:167], v[124:127], v[96:99], v[164:167]
  ds_read_b64_tr_b16 v[120:121], v11 offset:43072
  v_mfma_f32_16x16x32_bf16 v[168:171], v[124:127], v[100:103], v[168:171]
  ds_read_b64_tr_b16 v[122:123], v11 offset:44864
  s_waitcnt lgkmcnt(8)
  v_mfma_f32_16x16x32_bf16 v[172:175], v[128:131], v[96:99], v[172:175]
  ds_read_b64_tr_b16 v[124:125], v11 offset:43104
  v_mfma_f32_16x16x32_bf16 v[176:179], v[128:131], v[100:103], v[176:179]
  ds_read_b64_tr_b16 v[126:127], v11 offset:44896
  v_mfma_f32_16x16x32_bf16 v[180:183], v[132:135], v[96:99], v[180:183]
  ds_read_b64_tr_b16 v[128:129], v11 offset:43136
  v_mfma_f32_16x16x32_bf16 v[212:215], v[132:135], v[100:103], v[212:215]
  ds_read_b64_tr_b16 v[130:131], v11 offset:44928
  s_waitcnt lgkmcnt(10)
  v_mfma_f32_16x16x32_bf16 v[216:219], v[136:139], v[96:99], v[216:219]
  ds_read_b64_tr_b16 v[132:133], v11 offset:43168
  v_mfma_f32_16x16x32_bf16 v[220:223], v[136:139], v[100:103], v[220:223]
  ds_read_b64_tr_b16 v[134:135], v11 offset:44960
  s_waitcnt lgkmcnt(8)
  s_waitcnt vmcnt(11)
  v_mfma_f32_16x16x32_bf16 v[140:143], v[112:115], v[104:107], v[140:143]
  ds_read_b64_tr_b16 v[136:137], v11 offset:43200
  s_waitcnt vmcnt(10)
  v_mfma_f32_16x16x32_bf16 v[144:147], v[112:115], v[108:111], v[144:147]
  ds_read_b64_tr_b16 v[138:139], v11 offset:44992
  v_mfma_f32_16x16x32_bf16 v[148:151], v[116:119], v[104:107], v[148:151]
  s_add_u32 s10, s10, 0x1000
  buffer_load_dwordx4 v[96:99], v190, s[20:23], s10 offen offset:0 sc1
  v_mfma_f32_16x16x32_bf16 v[152:155], v[116:119], v[108:111], v[152:155]
  ds_read_b64_tr_b16 v[112:113], v11 offset:50176
  ds_read_b64_tr_b16 v[114:115], v11 offset:51968
  s_waitcnt lgkmcnt(8)
  v_mfma_f32_16x16x32_bf16 v[156:159], v[120:123], v[104:107], v[156:159]
  s_add_u32 s11, s11, 0x1000
  buffer_load_dwordx4 v[100:103], v190, s[20:23], s11 offen offset:0 sc1
  v_mfma_f32_16x16x32_bf16 v[160:163], v[120:123], v[108:111], v[160:163]
  ds_read_b64_tr_b16 v[116:117], v11 offset:50208
  ds_read_b64_tr_b16 v[118:119], v11 offset:52000
  v_mfma_f32_16x16x32_bf16 v[164:167], v[124:127], v[104:107], v[164:167]
  ds_read_b64_tr_b16 v[120:121], v11 offset:50240
  v_mfma_f32_16x16x32_bf16 v[168:171], v[124:127], v[108:111], v[168:171]
  ds_read_b64_tr_b16 v[122:123], v11 offset:52032
  s_waitcnt lgkmcnt(8)
  v_mfma_f32_16x16x32_bf16 v[172:175], v[128:131], v[104:107], v[172:175]
  ds_read_b64_tr_b16 v[124:125], v11 offset:50272
  v_mfma_f32_16x16x32_bf16 v[176:179], v[128:131], v[108:111], v[176:179]
  ds_read_b64_tr_b16 v[126:127], v11 offset:52064
  v_mfma_f32_16x16x32_bf16 v[180:183], v[132:135], v[104:107], v[180:183]
  ds_read_b64_tr_b16 v[128:129], v11 offset:50304
  v_mfma_f32_16x16x32_bf16 v[212:215], v[132:135], v[108:111], v[212:215]
  ds_read_b64_tr_b16 v[130:131], v11 offset:52096
  s_waitcnt lgkmcnt(10)
  v_mfma_f32_16x16x32_bf16 v[216:219], v[136:139], v[104:107], v[216:219]
  ds_read_b64_tr_b16 v[132:133], v11 offset:50336
  v_mfma_f32_16x16x32_bf16 v[220:223], v[136:139], v[108:111], v[220:223]
  ds_read_b64_tr_b16 v[134:135], v11 offset:52128
  s_waitcnt lgkmcnt(8)
  s_waitcnt vmcnt(11)
  v_mfma_f32_16x16x32_bf16 v[140:143], v[112:115], v[6:9], v[140:143]
  ds_read_b64_tr_b16 v[136:137], v11 offset:50368
  s_waitcnt vmcnt(10)
  v_mfma_f32_16x16x32_bf16 v[144:147], v[112:115], v[26:29], v[144:147]
  ds_read_b64_tr_b16 v[138:139], v11 offset:52160
  v_mfma_f32_16x16x32_bf16 v[148:151], v[116:119], v[6:9], v[148:151]
  buffer_load_dwordx4 v[104:107], v190, s[20:23], s10 offen offset:1024 sc1
  v_mfma_f32_16x16x32_bf16 v[152:155], v[116:119], v[26:29], v[152:155]
  ds_read_b64_tr_b16 v[112:113], v23 offset:0
  ds_read_b64_tr_b16 v[114:115], v23 offset:1792
  s_waitcnt lgkmcnt(8)
  v_mfma_f32_16x16x32_bf16 v[156:159], v[120:123], v[6:9], v[156:159]
  buffer_load_dwordx4 v[108:111], v190, s[20:23], s11 offen offset:1024 sc1
  v_mfma_f32_16x16x32_bf16 v[160:163], v[120:123], v[26:29], v[160:163]
  ds_read_b64_tr_b16 v[116:117], v23 offset:32
  ds_read_b64_tr_b16 v[118:119], v23 offset:1824
  v_mfma_f32_16x16x32_bf16 v[164:167], v[124:127], v[6:9], v[164:167]
  ds_read_b64_tr_b16 v[120:121], v23 offset:64
  v_mfma_f32_16x16x32_bf16 v[168:171], v[124:127], v[26:29], v[168:171]
  ds_read_b64_tr_b16 v[122:123], v23 offset:1856
  s_waitcnt lgkmcnt(8)
  v_mfma_f32_16x16x32_bf16 v[172:175], v[128:131], v[6:9], v[172:175]
  ds_read_b64_tr_b16 v[124:125], v23 offset:96
  v_mfma_f32_16x16x32_bf16 v[176:179], v[128:131], v[26:29], v[176:179]
  ds_read_b64_tr_b16 v[126:127], v23 offset:1888
  v_mfma_f32_16x16x32_bf16 v[180:183], v[132:135], v[6:9], v[180:183]
  ds_read_b64_tr_b16 v[128:129], v23 offset:128
  v_mfma_f32_16x16x32_bf16 v[212:215], v[132:135], v[26:29], v[212:215]
  ds_read_b64_tr_b16 v[130:131], v23 offset:1920
  s_waitcnt lgkmcnt(10)
  v_mfma_f32_16x16x32_bf16 v[216:219], v[136:139], v[6:9], v[216:219]
  ds_read_b64_tr_b16 v[132:133], v23 offset:160
  v_mfma_f32_16x16x32_bf16 v[220:223], v[136:139], v[26:29], v[220:223]
  ds_read_b64_tr_b16 v[134:135], v23 offset:1952
  s_barrier
  s_waitcnt lgkmcnt(8)
  s_waitcnt vmcnt(11)
  v_mfma_f32_16x16x32_bf16 v[140:143], v[112:115], v[30:33], v[140:143]
  ds_read_b64_tr_b16 v[136:137], v23 offset:192
  s_waitcnt vmcnt(10)
  v_mfma_f32_16x16x32_bf16 v[144:147], v[112:115], v[34:37], v[144:147]
  ds_read_b64_tr_b16 v[138:139], v23 offset:1984
  v_mfma_f32_16x16x32_bf16 v[148:151], v[116:119], v[30:33], v[148:151]
  buffer_load_dwordx4 v[6:9], v190, s[20:23], s10 offen offset:2048 sc1
  v_mfma_f32_16x16x32_bf16 v[152:155], v[116:119], v[34:37], v[152:155]
  ds_read_b64_tr_b16 v[112:113], v23 offset:7168
  ds_read_b64_tr_b16 v[114:115], v23 offset:8960
  s_waitcnt lgkmcnt(8)
  v_mfma_f32_16x16x32_bf16 v[156:159], v[120:123], v[30:33], v[156:159]
  buffer_load_dwordx4 v[26:29], v190, s[20:23], s11 offen offset:2048 sc1
  v_mfma_f32_16x16x32_bf16 v[160:163], v[120:123], v[34:37], v[160:163]
  ds_read_b64_tr_b16 v[116:117], v23 offset:7200
  ds_read_b64_tr_b16 v[118:119], v23 offset:8992
  v_mfma_f32_16x16x32_bf16 v[164:167], v[124:127], v[30:33], v[164:167]
  ds_read_b64_tr_b16 v[120:121], v23 offset:7232
  v_mfma_f32_16x16x32_bf16 v[168:171], v[124:127], v[34:37], v[168:171]
  ds_read_b64_tr_b16 v[122:123], v23 offset:9024
  s_waitcnt lgkmcnt(8)
  v_mfma_f32_16x16x32_bf16 v[172:175], v[128:131], v[30:33], v[172:175]
  ds_read_b64_tr_b16 v[124:125], v23 offset:7264
  v_mfma_f32_16x16x32_bf16 v[176:179], v[128:131], v[34:37], v[176:179]
  ds_read_b64_tr_b16 v[126:127], v23 offset:9056
  v_mfma_f32_16x16x32_bf16 v[180:183], v[132:135], v[30:33], v[180:183]
  ds_read_b64_tr_b16 v[128:129], v23 offset:7296
  v_mfma_f32_16x16x32_bf16 v[212:215], v[132:135], v[34:37], v[212:215]
  ds_read_b64_tr_b16 v[130:131], v23 offset:9088
  s_waitcnt lgkmcnt(10)
  v_mfma_f32_16x16x32_bf16 v[216:219], v[136:139], v[30:33], v[216:219]
  ds_read_b64_tr_b16 v[132:133], v23 offset:7328
  v_mfma_f32_16x16x32_bf16 v[220:223], v[136:139], v[34:37], v[220:223]
  ds_read_b64_tr_b16 v[134:135], v23 offset:9120
  s_waitcnt lgkmcnt(8)
  s_waitcnt vmcnt(11)
  v_mfma_f32_16x16x32_bf16 v[140:143], v[112:115], v[72:75], v[140:143]
  ds_read_b64_tr_b16 v[136:137], v23 offset:7360
  s_waitcnt vmcnt(10)
  v_mfma_f32_16x16x32_bf16 v[144:147], v[112:115], v[76:79], v[144:147]
  ds_read_b64_tr_b16 v[138:139], v23 offset:9152
  v_mfma_f32_16x16x32_bf16 v[148:151], v[116:119], v[72:75], v[148:151]
  buffer_load_dwordx4 v[30:33], v190, s[20:23], s10 offen offset:3072 sc1
  v_mfma_f32_16x16x32_bf16 v[152:155], v[116:119], v[76:79], v[152:155]
  ds_read_b64_tr_b16 v[112:113], v23 offset:14336
  ds_read_b64_tr_b16 v[114:115], v23 offset:16128
  s_waitcnt lgkmcnt(8)
  v_mfma_f32_16x16x32_bf16 v[156:159], v[120:123], v[72:75], v[156:159]
  buffer_load_dwordx4 v[34:37], v190, s[20:23], s11 offen offset:3072 sc1
  v_mfma_f32_16x16x32_bf16 v[160:163], v[120:123], v[76:79], v[160:163]
  ds_read_b64_tr_b16 v[116:117], v23 offset:14368
  ds_read_b64_tr_b16 v[118:119], v23 offset:16160
  v_mfma_f32_16x16x32_bf16 v[164:167], v[124:127], v[72:75], v[164:167]
  ds_read_b64_tr_b16 v[120:121], v23 offset:14400
  v_mfma_f32_16x16x32_bf16 v[168:171], v[124:127], v[76:79], v[168:171]
  ds_read_b64_tr_b16 v[122:123], v23 offset:16192
  s_waitcnt lgkmcnt(8)
  v_mfma_f32_16x16x32_bf16 v[172:175], v[128:131], v[72:75], v[172:175]
  ds_read_b64_tr_b16 v[124:125], v23 offset:14432
  v_mfma_f32_16x16x32_bf16 v[176:179], v[128:131], v[76:79], v[176:179]
  ds_read_b64_tr_b16 v[126:127], v23 offset:16224
  v_mfma_f32_16x16x32_bf16 v[180:183], v[132:135], v[72:75], v[180:183]
  ds_read_b64_tr_b16 v[128:129], v23 offset:14464
  v_mfma_f32_16x16x32_bf16 v[212:215], v[132:135], v[76:79], v[212:215]
  ds_read_b64_tr_b16 v[130:131], v23 offset:16256
  s_waitcnt lgkmcnt(10)
  v_mfma_f32_16x16x32_bf16 v[216:219], v[136:139], v[72:75], v[216:219]
  ds_read_b64_tr_b16 v[132:133], v23 offset:14496
  v_mfma_f32_16x16x32_bf16 v[220:223], v[136:139], v[76:79], v[220:223]
  ds_read_b64_tr_b16 v[134:135], v23 offset:16288
  s_waitcnt lgkmcnt(8)
  s_waitcnt vmcnt(11)
  v_mfma_f32_16x16x32_bf16 v[140:143], v[112:115], v[80:83], v[140:143]
  ds_read_b64_tr_b16 v[136:137], v23 offset:14528
  s_waitcnt vmcnt(10)
  v_mfma_f32_16x16x32_bf16 v[144:147], v[112:115], v[84:87], v[144:147]
  ds_read_b64_tr_b16 v[138:139], v23 offset:16320
  v_mfma_f32_16x16x32_bf16 v[148:151], v[116:119], v[80:83], v[148:151]
  s_add_u32 s10, s10, 0x1000
  buffer_load_dwordx4 v[72:75], v190, s[20:23], s10 offen offset:0 sc1
  v_mfma_f32_16x16x32_bf16 v[152:155], v[116:119], v[84:87], v[152:155]
  ds_read_b64_tr_b16 v[112:113], v23 offset:21504
  ds_read_b64_tr_b16 v[114:115], v23 offset:23296
  s_waitcnt lgkmcnt(8)
  v_mfma_f32_16x16x32_bf16 v[156:159], v[120:123], v[80:83], v[156:159]
  s_add_u32 s11, s11, 0x1000
  buffer_load_dwordx4 v[76:79], v190, s[20:23], s11 offen offset:0 sc1
  v_mfma_f32_16x16x32_bf16 v[160:163], v[120:123], v[84:87], v[160:163]
  ds_read_b64_tr_b16 v[116:117], v23 offset:21536
  ds_read_b64_tr_b16 v[118:119], v23 offset:23328
  v_mfma_f32_16x16x32_bf16 v[164:167], v[124:127], v[80:83], v[164:167]
  ds_read_b64_tr_b16 v[120:121], v23 offset:21568
  v_mfma_f32_16x16x32_bf16 v[168:171], v[124:127], v[84:87], v[168:171]
  ds_read_b64_tr_b16 v[122:123], v23 offset:23360
  s_waitcnt lgkmcnt(8)
  v_mfma_f32_16x16x32_bf16 v[172:175], v[128:131], v[80:83], v[172:175]
  ds_read_b64_tr_b16 v[124:125], v23 offset:21600
  v_mfma_f32_16x16x32_bf16 v[176:179], v[128:131], v[84:87], v[176:179]
  ds_read_b64_tr_b16 v[126:127], v23 offset:23392
  v_mfma_f32_16x16x32_bf16 v[180:183], v[132:135], v[80:83], v[180:183]
  ds_read_b64_tr_b16 v[128:129], v23 offset:21632
  v_mfma_f32_16x16x32_bf16 v[212:215], v[132:135], v[84:87], v[212:215]
  ds_read_b64_tr_b16 v[130:131], v23 offset:23424
  s_waitcnt lgkmcnt(10)
  v_mfma_f32_16x16x32_bf16 v[216:219], v[136:139], v[80:83], v[216:219]
  ds_read_b64_tr_b16 v[132:133], v23 offset:21664
  v_mfma_f32_16x16x32_bf16 v[220:223], v[136:139], v[84:87], v[220:223]
  ds_read_b64_tr_b16 v[134:135], v23 offset:23456
  s_waitcnt lgkmcnt(8)
  s_waitcnt vmcnt(11)
  v_mfma_f32_16x16x32_bf16 v[140:143], v[112:115], v[88:91], v[140:143]
  ds_read_b64_tr_b16 v[136:137], v23 offset:21696
  s_waitcnt vmcnt(10)
  v_mfma_f32_16x16x32_bf16 v[144:147], v[112:115], v[92:95], v[144:147]
  ds_read_b64_tr_b16 v[138:139], v23 offset:23488
  v_mfma_f32_16x16x32_bf16 v[148:151], v[116:119], v[88:91], v[148:151]
  buffer_load_dwordx4 v[80:83], v190, s[20:23], s10 offen offset:1024 sc1
  v_mfma_f32_16x16x32_bf16 v[152:155], v[116:119], v[92:95], v[152:155]
  ds_read_b64_tr_b16 v[112:113], v23 offset:28672
  ds_read_b64_tr_b16 v[114:115], v23 offset:30464
  s_waitcnt lgkmcnt(8)
  v_mfma_f32_16x16x32_bf16 v[156:159], v[120:123], v[88:91], v[156:159]
  buffer_load_dwordx4 v[84:87], v190, s[20:23], s11 offen offset:1024 sc1
  v_mfma_f32_16x16x32_bf16 v[160:163], v[120:123], v[92:95], v[160:163]
  ds_read_b64_tr_b16 v[116:117], v23 offset:28704
  ds_read_b64_tr_b16 v[118:119], v23 offset:30496
  v_mfma_f32_16x16x32_bf16 v[164:167], v[124:127], v[88:91], v[164:167]
  ds_read_b64_tr_b16 v[120:121], v23 offset:28736
  v_mfma_f32_16x16x32_bf16 v[168:171], v[124:127], v[92:95], v[168:171]
  ds_read_b64_tr_b16 v[122:123], v23 offset:30528
  s_waitcnt lgkmcnt(8)
  v_mfma_f32_16x16x32_bf16 v[172:175], v[128:131], v[88:91], v[172:175]
  ds_read_b64_tr_b16 v[124:125], v23 offset:28768
  v_mfma_f32_16x16x32_bf16 v[176:179], v[128:131], v[92:95], v[176:179]
  ds_read_b64_tr_b16 v[126:127], v23 offset:30560
  v_mfma_f32_16x16x32_bf16 v[180:183], v[132:135], v[88:91], v[180:183]
  ds_read_b64_tr_b16 v[128:129], v23 offset:28800
  v_mfma_f32_16x16x32_bf16 v[212:215], v[132:135], v[92:95], v[212:215]
  ds_read_b64_tr_b16 v[130:131], v23 offset:30592
  s_waitcnt lgkmcnt(10)
  v_mfma_f32_16x16x32_bf16 v[216:219], v[136:139], v[88:91], v[216:219]
  ds_read_b64_tr_b16 v[132:133], v23 offset:28832
  v_mfma_f32_16x16x32_bf16 v[220:223], v[136:139], v[92:95], v[220:223]
  ds_read_b64_tr_b16 v[134:135], v23 offset:30624
  s_barrier
  s_waitcnt lgkmcnt(8)
  s_waitcnt vmcnt(11)
  v_mfma_f32_16x16x32_bf16 v[140:143], v[112:115], v[96:99], v[140:143]
  ds_read_b64_tr_b16 v[136:137], v23 offset:28864
  s_waitcnt vmcnt(10)
  v_mfma_f32_16x16x32_bf16 v[144:147], v[112:115], v[100:103], v[144:147]
  ds_read_b64_tr_b16 v[138:139], v23 offset:30656
  v_mfma_f32_16x16x32_bf16 v[148:151], v[116:119], v[96:99], v[148:151]
  buffer_load_dwordx4 v[88:91], v190, s[20:23], s10 offen offset:2048 sc1
  v_mfma_f32_16x16x32_bf16 v[152:155], v[116:119], v[100:103], v[152:155]
  ds_read_b64_tr_b16 v[112:113], v23 offset:35840
  ds_read_b64_tr_b16 v[114:115], v23 offset:37632
  s_waitcnt lgkmcnt(8)
  v_mfma_f32_16x16x32_bf16 v[156:159], v[120:123], v[96:99], v[156:159]
  buffer_load_dwordx4 v[92:95], v190, s[20:23], s11 offen offset:2048 sc1
  v_mfma_f32_16x16x32_bf16 v[160:163], v[120:123], v[100:103], v[160:163]
  ds_read_b64_tr_b16 v[116:117], v23 offset:35872
  ds_read_b64_tr_b16 v[118:119], v23 offset:37664
  v_mfma_f32_16x16x32_bf16 v[164:167], v[124:127], v[96:99], v[164:167]
  ds_read_b64_tr_b16 v[120:121], v23 offset:35904
  v_mfma_f32_16x16x32_bf16 v[168:171], v[124:127], v[100:103], v[168:171]
  ds_read_b64_tr_b16 v[122:123], v23 offset:37696
  s_waitcnt lgkmcnt(8)
  v_mfma_f32_16x16x32_bf16 v[172:175], v[128:131], v[96:99], v[172:175]
  ds_read_b64_tr_b16 v[124:125], v23 offset:35936
  v_mfma_f32_16x16x32_bf16 v[176:179], v[128:131], v[100:103], v[176:179]
  ds_read_b64_tr_b16 v[126:127], v23 offset:37728
  v_mfma_f32_16x16x32_bf16 v[180:183], v[132:135], v[96:99], v[180:183]
  ds_read_b64_tr_b16 v[128:129], v23 offset:35968
  v_mfma_f32_16x16x32_bf16 v[212:215], v[132:135], v[100:103], v[212:215]
  ds_read_b64_tr_b16 v[130:131], v23 offset:37760
  s_waitcnt lgkmcnt(10)
  v_mfma_f32_16x16x32_bf16 v[216:219], v[136:139], v[96:99], v[216:219]
  ds_read_b64_tr_b16 v[132:133], v23 offset:36000
  v_mfma_f32_16x16x32_bf16 v[220:223], v[136:139], v[100:103], v[220:223]
  ds_read_b64_tr_b16 v[134:135], v23 offset:37792
  s_waitcnt lgkmcnt(8)
  s_waitcnt vmcnt(11)
  v_mfma_f32_16x16x32_bf16 v[140:143], v[112:115], v[104:107], v[140:143]
  ds_read_b64_tr_b16 v[136:137], v23 offset:36032
  s_waitcnt vmcnt(10)
  v_mfma_f32_16x16x32_bf16 v[144:147], v[112:115], v[108:111], v[144:147]
  ds_read_b64_tr_b16 v[138:139], v23 offset:37824
  v_mfma_f32_16x16x32_bf16 v[148:151], v[116:119], v[104:107], v[148:151]
  buffer_load_dwordx4 v[96:99], v190, s[20:23], s10 offen offset:3072 sc1
  v_mfma_f32_16x16x32_bf16 v[152:155], v[116:119], v[108:111], v[152:155]
  ds_read_b64_tr_b16 v[112:113], v23 offset:43008
  ds_read_b64_tr_b16 v[114:115], v23 offset:44800
  s_waitcnt lgkmcnt(8)
  v_mfma_f32_16x16x32_bf16 v[156:159], v[120:123], v[104:107], v[156:159]
  buffer_load_dwordx4 v[100:103], v190, s[20:23], s11 offen offset:3072 sc1
  v_mfma_f32_16x16x32_bf16 v[160:163], v[120:123], v[108:111], v[160:163]
  ds_read_b64_tr_b16 v[116:117], v23 offset:43040
  ds_read_b64_tr_b16 v[118:119], v23 offset:44832
  v_mfma_f32_16x16x32_bf16 v[164:167], v[124:127], v[104:107], v[164:167]
  ds_read_b64_tr_b16 v[120:121], v23 offset:43072
  v_mfma_f32_16x16x32_bf16 v[168:171], v[124:127], v[108:111], v[168:171]
  ds_read_b64_tr_b16 v[122:123], v23 offset:44864
  s_waitcnt lgkmcnt(8)
  v_mfma_f32_16x16x32_bf16 v[172:175], v[128:131], v[104:107], v[172:175]
  ds_read_b64_tr_b16 v[124:125], v23 offset:43104
  v_mfma_f32_16x16x32_bf16 v[176:179], v[128:131], v[108:111], v[176:179]
  ds_read_b64_tr_b16 v[126:127], v23 offset:44896
  v_mfma_f32_16x16x32_bf16 v[180:183], v[132:135], v[104:107], v[180:183]
  ds_read_b64_tr_b16 v[128:129], v23 offset:43136
  v_mfma_f32_16x16x32_bf16 v[212:215], v[132:135], v[108:111], v[212:215]
  ds_read_b64_tr_b16 v[130:131], v23 offset:44928
  s_waitcnt lgkmcnt(10)
  v_mfma_f32_16x16x32_bf16 v[216:219], v[136:139], v[104:107], v[216:219]
  ds_read_b64_tr_b16 v[132:133], v23 offset:43168
  v_mfma_f32_16x16x32_bf16 v[220:223], v[136:139], v[108:111], v[220:223]
  ds_read_b64_tr_b16 v[134:135], v23 offset:44960
  s_waitcnt lgkmcnt(8)
  s_waitcnt vmcnt(11)
  v_mfma_f32_16x16x32_bf16 v[140:143], v[112:115], v[6:9], v[140:143]
  ds_read_b64_tr_b16 v[136:137], v23 offset:43200
  s_waitcnt vmcnt(10)
  v_mfma_f32_16x16x32_bf16 v[144:147], v[112:115], v[26:29], v[144:147]
  ds_read_b64_tr_b16 v[138:139], v23 offset:44992
  v_mfma_f32_16x16x32_bf16 v[148:151], v[116:119], v[6:9], v[148:151]
  ds_read_b64_tr_b16 v[112:113], v23 offset:50176
  v_mfma_f32_16x16x32_bf16 v[152:155], v[116:119], v[26:29], v[152:155]
  ds_read_b64_tr_b16 v[114:115], v23 offset:51968
  s_waitcnt lgkmcnt(8)
  v_mfma_f32_16x16x32_bf16 v[156:159], v[120:123], v[6:9], v[156:159]
  ds_read_b64_tr_b16 v[116:117], v23 offset:50208
  v_mfma_f32_16x16x32_bf16 v[160:163], v[120:123], v[26:29], v[160:163]
  ds_read_b64_tr_b16 v[118:119], v23 offset:52000
  v_mfma_f32_16x16x32_bf16 v[164:167], v[124:127], v[6:9], v[164:167]
  ds_read_b64_tr_b16 v[120:121], v23 offset:50240
  v_mfma_f32_16x16x32_bf16 v[168:171], v[124:127], v[26:29], v[168:171]
  ds_read_b64_tr_b16 v[122:123], v23 offset:52032
  s_waitcnt lgkmcnt(8)
  v_mfma_f32_16x16x32_bf16 v[172:175], v[128:131], v[6:9], v[172:175]
  ds_read_b64_tr_b16 v[124:125], v23 offset:50272
  v_mfma_f32_16x16x32_bf16 v[176:179], v[128:131], v[26:29], v[176:179]
  ds_read_b64_tr_b16 v[126:127], v23 offset:52064
  v_mfma_f32_16x16x32_bf16 v[180:183], v[132:135], v[6:9], v[180:183]
  ds_read_b64_tr_b16 v[128:129], v23 offset:50304
  v_mfma_f32_16x16x32_bf16 v[212:215], v[132:135], v[26:29], v[212:215]
  ds_read_b64_tr_b16 v[130:131], v23 offset:52096
  s_waitcnt lgkmcnt(10)
  v_mfma_f32_16x16x32_bf16 v[216:219], v[136:139], v[6:9], v[216:219]
  ds_read_b64_tr_b16 v[132:133], v23 offset:50336
  v_mfma_f32_16x16x32_bf16 v[220:223], v[136:139], v[26:29], v[220:223]
  ds_read_b64_tr_b16 v[134:135], v23 offset:52128
  s_waitcnt lgkmcnt(8)
  s_waitcnt vmcnt(9)
  v_mfma_f32_16x16x32_bf16 v[140:143], v[112:115], v[30:33], v[140:143]
  ds_read_b64_tr_b16 v[136:137], v23 offset:50368
  s_waitcnt vmcnt(8)
  v_mfma_f32_16x16x32_bf16 v[144:147], v[112:115], v[34:37], v[144:147]
  ds_read_b64_tr_b16 v[138:139], v23 offset:52160
  v_mfma_f32_16x16x32_bf16 v[148:151], v[116:119], v[30:33], v[148:151]
  ds_read_b64_tr_b16 v[112:113], v25 offset:0
  v_mfma_f32_16x16x32_bf16 v[152:155], v[116:119], v[34:37], v[152:155]
  ds_read_b64_tr_b16 v[114:115], v25 offset:1792
  s_waitcnt lgkmcnt(8)
  v_mfma_f32_16x16x32_bf16 v[156:159], v[120:123], v[30:33], v[156:159]
  ds_read_b64_tr_b16 v[116:117], v25 offset:32
  v_mfma_f32_16x16x32_bf16 v[160:163], v[120:123], v[34:37], v[160:163]
  ds_read_b64_tr_b16 v[118:119], v25 offset:1824
  v_mfma_f32_16x16x32_bf16 v[164:167], v[124:127], v[30:33], v[164:167]
  ds_read_b64_tr_b16 v[120:121], v25 offset:64
  v_mfma_f32_16x16x32_bf16 v[168:171], v[124:127], v[34:37], v[168:171]
  ds_read_b64_tr_b16 v[122:123], v25 offset:1856
  s_waitcnt lgkmcnt(8)
  v_mfma_f32_16x16x32_bf16 v[172:175], v[128:131], v[30:33], v[172:175]
  ds_read_b64_tr_b16 v[124:125], v25 offset:96
  v_mfma_f32_16x16x32_bf16 v[176:179], v[128:131], v[34:37], v[176:179]
  ds_read_b64_tr_b16 v[126:127], v25 offset:1888
  v_mfma_f32_16x16x32_bf16 v[180:183], v[132:135], v[30:33], v[180:183]
  ds_read_b64_tr_b16 v[128:129], v25 offset:128
  v_mfma_f32_16x16x32_bf16 v[212:215], v[132:135], v[34:37], v[212:215]
  ds_read_b64_tr_b16 v[130:131], v25 offset:1920
  s_waitcnt lgkmcnt(10)
  v_mfma_f32_16x16x32_bf16 v[216:219], v[136:139], v[30:33], v[216:219]
  ds_read_b64_tr_b16 v[132:133], v25 offset:160
  v_mfma_f32_16x16x32_bf16 v[220:223], v[136:139], v[34:37], v[220:223]
  ds_read_b64_tr_b16 v[134:135], v25 offset:1952
  s_barrier
  s_waitcnt lgkmcnt(8)
  s_waitcnt vmcnt(7)
  v_mfma_f32_16x16x32_bf16 v[140:143], v[112:115], v[72:75], v[140:143]
  ds_read_b64_tr_b16 v[136:137], v25 offset:192
  s_waitcnt vmcnt(6)
  v_mfma_f32_16x16x32_bf16 v[144:147], v[112:115], v[76:79], v[144:147]
  ds_read_b64_tr_b16 v[138:139], v25 offset:1984
  v_mfma_f32_16x16x32_bf16 v[148:151], v[116:119], v[72:75], v[148:151]
  ds_read_b64_tr_b16 v[112:113], v25 offset:7168
  v_mfma_f32_16x16x32_bf16 v[152:155], v[116:119], v[76:79], v[152:155]
  ds_read_b64_tr_b16 v[114:115], v25 offset:8960
  s_waitcnt lgkmcnt(8)
  v_mfma_f32_16x16x32_bf16 v[156:159], v[120:123], v[72:75], v[156:159]
  ds_read_b64_tr_b16 v[116:117], v25 offset:7200
  v_mfma_f32_16x16x32_bf16 v[160:163], v[120:123], v[76:79], v[160:163]
  ds_read_b64_tr_b16 v[118:119], v25 offset:8992
  v_mfma_f32_16x16x32_bf16 v[164:167], v[124:127], v[72:75], v[164:167]
  ds_read_b64_tr_b16 v[120:121], v25 offset:7232
  v_mfma_f32_16x16x32_bf16 v[168:171], v[124:127], v[76:79], v[168:171]
  ds_read_b64_tr_b16 v[122:123], v25 offset:9024
  s_waitcnt lgkmcnt(8)
  v_mfma_f32_16x16x32_bf16 v[172:175], v[128:131], v[72:75], v[172:175]
  ds_read_b64_tr_b16 v[124:125], v25 offset:7264
  v_mfma_f32_16x16x32_bf16 v[176:179], v[128:131], v[76:79], v[176:179]
  ds_read_b64_tr_b16 v[126:127], v25 offset:9056
  v_mfma_f32_16x16x32_bf16 v[180:183], v[132:135], v[72:75], v[180:183]
  ds_read_b64_tr_b16 v[128:129], v25 offset:7296
  v_mfma_f32_16x16x32_bf16 v[212:215], v[132:135], v[76:79], v[212:215]
  ds_read_b64_tr_b16 v[130:131], v25 offset:9088
  s_waitcnt lgkmcnt(10)
  v_mfma_f32_16x16x32_bf16 v[216:219], v[136:139], v[72:75], v[216:219]
  ds_read_b64_tr_b16 v[132:133], v25 offset:7328
  v_mfma_f32_16x16x32_bf16 v[220:223], v[136:139], v[76:79], v[220:223]
  ds_read_b64_tr_b16 v[134:135], v25 offset:9120
  s_waitcnt lgkmcnt(8)
  s_waitcnt vmcnt(5)
  v_mfma_f32_16x16x32_bf16 v[140:143], v[112:115], v[80:83], v[140:143]
  ds_read_b64_tr_b16 v[136:137], v25 offset:7360
  s_waitcnt vmcnt(4)
  v_mfma_f32_16x16x32_bf16 v[144:147], v[112:115], v[84:87], v[144:147]
  ds_read_b64_tr_b16 v[138:139], v25 offset:9152
  v_mfma_f32_16x16x32_bf16 v[148:151], v[116:119], v[80:83], v[148:151]
  ds_read_b64_tr_b16 v[112:113], v25 offset:14336
  v_mfma_f32_16x16x32_bf16 v[152:155], v[116:119], v[84:87], v[152:155]
  ds_read_b64_tr_b16 v[114:115], v25 offset:16128
  s_waitcnt lgkmcnt(8)
  v_mfma_f32_16x16x32_bf16 v[156:159], v[120:123], v[80:83], v[156:159]
  ds_read_b64_tr_b16 v[116:117], v25 offset:14368
  v_mfma_f32_16x16x32_bf16 v[160:163], v[120:123], v[84:87], v[160:163]
  ds_read_b64_tr_b16 v[118:119], v25 offset:16160
  v_mfma_f32_16x16x32_bf16 v[164:167], v[124:127], v[80:83], v[164:167]
  ds_read_b64_tr_b16 v[120:121], v25 offset:14400
  v_mfma_f32_16x16x32_bf16 v[168:171], v[124:127], v[84:87], v[168:171]
  ds_read_b64_tr_b16 v[122:123], v25 offset:16192
  s_waitcnt lgkmcnt(8)
  v_mfma_f32_16x16x32_bf16 v[172:175], v[128:131], v[80:83], v[172:175]
  ds_read_b64_tr_b16 v[124:125], v25 offset:14432
  v_mfma_f32_16x16x32_bf16 v[176:179], v[128:131], v[84:87], v[176:179]
  ds_read_b64_tr_b16 v[126:127], v25 offset:16224
  v_mfma_f32_16x16x32_bf16 v[180:183], v[132:135], v[80:83], v[180:183]
  ds_read_b64_tr_b16 v[128:129], v25 offset:14464
  v_mfma_f32_16x16x32_bf16 v[212:215], v[132:135], v[84:87], v[212:215]
  ds_read_b64_tr_b16 v[130:131], v25 offset:16256
  s_waitcnt lgkmcnt(10)
  v_mfma_f32_16x16x32_bf16 v[216:219], v[136:139], v[80:83], v[216:219]
  ds_read_b64_tr_b16 v[132:133], v25 offset:14496
  v_mfma_f32_16x16x32_bf16 v[220:223], v[136:139], v[84:87], v[220:223]
  ds_read_b64_tr_b16 v[134:135], v25 offset:16288
  s_waitcnt lgkmcnt(8)
  s_waitcnt vmcnt(3)
  v_mfma_f32_16x16x32_bf16 v[140:143], v[112:115], v[88:91], v[140:143]
  ds_read_b64_tr_b16 v[136:137], v25 offset:14528
  s_waitcnt vmcnt(2)
  v_mfma_f32_16x16x32_bf16 v[144:147], v[112:115], v[92:95], v[144:147]
  ds_read_b64_tr_b16 v[138:139], v25 offset:16320
  v_mfma_f32_16x16x32_bf16 v[148:151], v[116:119], v[88:91], v[148:151]
  ds_read_b64_tr_b16 v[112:113], v25 offset:21504
  v_mfma_f32_16x16x32_bf16 v[152:155], v[116:119], v[92:95], v[152:155]
  ds_read_b64_tr_b16 v[114:115], v25 offset:23296
  s_waitcnt lgkmcnt(8)
  v_mfma_f32_16x16x32_bf16 v[156:159], v[120:123], v[88:91], v[156:159]
  ds_read_b64_tr_b16 v[116:117], v25 offset:21536
  v_mfma_f32_16x16x32_bf16 v[160:163], v[120:123], v[92:95], v[160:163]
  ds_read_b64_tr_b16 v[118:119], v25 offset:23328
  v_mfma_f32_16x16x32_bf16 v[164:167], v[124:127], v[88:91], v[164:167]
  ds_read_b64_tr_b16 v[120:121], v25 offset:21568
  v_mfma_f32_16x16x32_bf16 v[168:171], v[124:127], v[92:95], v[168:171]
  ds_read_b64_tr_b16 v[122:123], v25 offset:23360
  s_waitcnt lgkmcnt(8)
  v_mfma_f32_16x16x32_bf16 v[172:175], v[128:131], v[88:91], v[172:175]
  ds_read_b64_tr_b16 v[124:125], v25 offset:21600
  v_mfma_f32_16x16x32_bf16 v[176:179], v[128:131], v[92:95], v[176:179]
  ds_read_b64_tr_b16 v[126:127], v25 offset:23392
  v_mfma_f32_16x16x32_bf16 v[180:183], v[132:135], v[88:91], v[180:183]
  ds_read_b64_tr_b16 v[128:129], v25 offset:21632
  v_mfma_f32_16x16x32_bf16 v[212:215], v[132:135], v[92:95], v[212:215]
  ds_read_b64_tr_b16 v[130:131], v25 offset:23424
  s_waitcnt lgkmcnt(10)
  v_mfma_f32_16x16x32_bf16 v[216:219], v[136:139], v[88:91], v[216:219]
  ds_read_b64_tr_b16 v[132:133], v25 offset:21664
  v_mfma_f32_16x16x32_bf16 v[220:223], v[136:139], v[92:95], v[220:223]
  ds_read_b64_tr_b16 v[134:135], v25 offset:23456
  s_waitcnt lgkmcnt(8)
  s_waitcnt vmcnt(1)
  v_mfma_f32_16x16x32_bf16 v[140:143], v[112:115], v[96:99], v[140:143]
  ds_read_b64_tr_b16 v[136:137], v25 offset:21696
  s_waitcnt vmcnt(0)
  v_mfma_f32_16x16x32_bf16 v[144:147], v[112:115], v[100:103], v[144:147]
  ds_read_b64_tr_b16 v[138:139], v25 offset:23488
  v_mfma_f32_16x16x32_bf16 v[148:151], v[116:119], v[96:99], v[148:151]
  v_mfma_f32_16x16x32_bf16 v[152:155], v[116:119], v[100:103], v[152:155]
  s_waitcnt lgkmcnt(6)
  v_mfma_f32_16x16x32_bf16 v[156:159], v[120:123], v[96:99], v[156:159]
  v_mfma_f32_16x16x32_bf16 v[160:163], v[120:123], v[100:103], v[160:163]
  v_mfma_f32_16x16x32_bf16 v[164:167], v[124:127], v[96:99], v[164:167]
  v_mfma_f32_16x16x32_bf16 v[168:171], v[124:127], v[100:103], v[168:171]
  s_waitcnt lgkmcnt(2)
  v_mfma_f32_16x16x32_bf16 v[172:175], v[128:131], v[96:99], v[172:175]
  v_mfma_f32_16x16x32_bf16 v[176:179], v[128:131], v[100:103], v[176:179]
  v_mfma_f32_16x16x32_bf16 v[180:183], v[132:135], v[96:99], v[180:183]
  v_mfma_f32_16x16x32_bf16 v[212:215], v[132:135], v[100:103], v[212:215]
  s_waitcnt lgkmcnt(0)
  v_mfma_f32_16x16x32_bf16 v[216:219], v[136:139], v[96:99], v[216:219]
  v_mfma_f32_16x16x32_bf16 v[220:223], v[136:139], v[100:103], v[220:223]
  s_barrier
  v_lshlrev_b32 v39, 4, v3
  v_add_u32 v39, 0x277c0, v39
  ds_read_b128 v[6:9], v39 offset:0
  ds_read_b128 v[26:29], v39 offset:64
  ds_read_b128 v[30:33], v39 offset:128
  ds_read_b128 v[34:37], v39 offset:192
  ds_read_b128 v[72:75], v39 offset:256
  ds_read_b128 v[76:79], v39 offset:320
  ds_read_b128 v[80:83], v39 offset:384
  v_pk_add_f32 v[186:187], v[186:187], v[224:225]
  v_pk_add_f32 v[226:227], v[226:227], v[228:229]
  s_nop 0
  v_permlane16_swap_b32 v186, v187
  v_permlane16_swap_b32 v226, v227
  v_add_f32 v186, v186, v187
  v_add_f32 v226, v226, v227
  s_nop 1
  v_permlane32_swap_b32 v186, v226
  v_add_f32 v186, v186, v226
  v_mov_b32 v187, v186
  s_nop 1
  v_permlane32_swap_b32 v186, v187
  v_mov_b32 v226, v186
  v_mov_b32 v227, v187
  s_nop 0
  v_permlane16_swap_b32 v186, v226
  v_permlane16_swap_b32 v187, v227
  v_mul_f32 v84, 0xbacccccd, v186
  v_mul_f32 v39, 0x3acccccd, v226
  v_fma_f32 v39, -v84, v84, v39
  v_max_f32 v39, 0, v39
  v_add_f32 v39, 0x3727c5ac, v39
  v_rsq_f32 v88, v39
  v_mul_f32 v86, 0xbacccccd, v187
  v_mul_f32 v39, 0x3acccccd, v227
  v_fma_f32 v39, -v86, v86, v39
  v_max_f32 v39, 0, v39
  v_add_f32 v39, 0x3727c5ac, v39
  v_rsq_f32 v90, v39
  v_and_b32 v39, 1, v3
  v_mul_u32_u24 v11, 0xd800, v39
  v_lshl_add_u32 v11, v2, 4, v11
  v_lshrrev_b32 v39, 1, v3
  v_lshl_add_u32 v11, v39, 8, v11
  s_add_u32 s66, s9, 0
  s_mul_i32 s66, s66, 0xd800
  s_lshl_b32 s10, s62, 9
  s_add_u32 s10, s10, s66
  s_add_u32 s10, s10, 0x92e000
  s_add_u32 s66, s9, 1
  s_mul_i32 s66, s66, 0xd800
  s_lshl_b32 s11, s62, 9
  s_add_u32 s11, s11, s66
  s_add_u32 s11, s11, 0x92e000
  s_waitcnt lgkmcnt(6)
  v_pk_fma_f32 v[140:141], v[6:7], v[84:85], v[140:141] op_sel_hi:[1,0,1]
  v_pk_fma_f32 v[142:143], v[8:9], v[84:85], v[142:143] op_sel_hi:[1,0,1]
  v_pk_fma_f32 v[144:145], v[6:7], v[86:87], v[144:145] op_sel_hi:[1,0,1]
  v_pk_fma_f32 v[146:147], v[8:9], v[86:87], v[146:147] op_sel_hi:[1,0,1]
  s_waitcnt lgkmcnt(5)
  v_pk_fma_f32 v[148:149], v[26:27], v[84:85], v[148:149] op_sel_hi:[1,0,1]
  v_pk_fma_f32 v[150:151], v[28:29], v[84:85], v[150:151] op_sel_hi:[1,0,1]
  v_pk_fma_f32 v[152:153], v[26:27], v[86:87], v[152:153] op_sel_hi:[1,0,1]
  v_pk_fma_f32 v[154:155], v[28:29], v[86:87], v[154:155] op_sel_hi:[1,0,1]
  v_pk_mul_f32 v[140:141], v[140:141], v[88:89] op_sel_hi:[1,0]
  v_pk_mul_f32 v[142:143], v[142:143], v[88:89] op_sel_hi:[1,0]
  v_pk_mul_f32 v[148:149], v[148:149], v[88:89] op_sel_hi:[1,0]
  v_pk_mul_f32 v[150:151], v[150:151], v[88:89] op_sel_hi:[1,0]
  v_pk_mul_f32 v[100:101], v[140:141], v[140:141]
  v_pk_mul_f32 v[102:103], v[142:143], v[142:143]
  v_pk_mul_f32 v[104:105], v[148:149], v[148:149]
  v_pk_mul_f32 v[106:107], v[150:151], v[150:151]
  v_pk_fma_f32 v[100:101], v[100:101], s[60:61], v[4:5] op_sel_hi:[1,0,0]
  v_pk_fma_f32 v[102:103], v[102:103], s[60:61], v[4:5] op_sel_hi:[1,0,0]
  v_pk_fma_f32 v[104:105], v[104:105], s[60:61], v[4:5] op_sel_hi:[1,0,0]
  v_pk_fma_f32 v[106:107], v[106:107], s[60:61], v[4:5] op_sel_hi:[1,0,0]
  v_pk_mul_f32 v[100:101], v[100:101], v[140:141]
  v_pk_mul_f32 v[102:103], v[102:103], v[142:143]
  v_pk_mul_f32 v[104:105], v[104:105], v[148:149]
  v_pk_mul_f32 v[106:107], v[106:107], v[150:151]
  v_exp_f32 v100, v100
  v_exp_f32 v101, v101
  v_exp_f32 v102, v102
  v_exp_f32 v103, v103
  v_exp_f32 v104, v104
  v_exp_f32 v105, v105
  v_exp_f32 v106, v106
  v_exp_f32 v107, v107
  v_pk_add_f32 v[100:101], v[100:101], v[4:5] op_sel:[0,1] op_sel_hi:[1,1]
  v_pk_add_f32 v[102:103], v[102:103], v[4:5] op_sel:[0,1] op_sel_hi:[1,1]
  v_pk_add_f32 v[104:105], v[104:105], v[4:5] op_sel:[0,1] op_sel_hi:[1,1]
  v_pk_add_f32 v[106:107], v[106:107], v[4:5] op_sel:[0,1] op_sel_hi:[1,1]
  v_rcp_f32 v100, v100
  v_rcp_f32 v101, v101
  v_rcp_f32 v102, v102
  v_rcp_f32 v103, v103
  v_rcp_f32 v104, v104
  v_rcp_f32 v105, v105
  v_rcp_f32 v106, v106
  v_rcp_f32 v107, v107
  v_pk_mul_f32 v[100:101], v[100:101], v[140:141]
  v_pk_mul_f32 v[102:103], v[102:103], v[142:143]
  v_pk_mul_f32 v[104:105], v[104:105], v[148:149]
  v_pk_mul_f32 v[106:107], v[106:107], v[150:151]
  v_cvt_pk_bf16_f32 v92, v100, v101
  v_cvt_pk_bf16_f32 v93, v102, v103
  v_cvt_pk_bf16_f32 v94, v104, v105
  v_cvt_pk_bf16_f32 v95, v106, v107
  s_nop 0
  v_permlane16_swap_b32 v92, v94
  v_permlane16_swap_b32 v93, v95
  buffer_store_dwordx4 v[92:95], v189, s[20:23], s10 offen offset:0 sc1
  v_pk_mul_f32 v[144:145], v[144:145], v[90:91] op_sel_hi:[1,0]
  v_pk_mul_f32 v[146:147], v[146:147], v[90:91] op_sel_hi:[1,0]
  v_pk_mul_f32 v[152:153], v[152:153], v[90:91] op_sel_hi:[1,0]
  v_pk_mul_f32 v[154:155], v[154:155], v[90:91] op_sel_hi:[1,0]
  v_pk_mul_f32 v[100:101], v[144:145], v[144:145]
  v_pk_mul_f32 v[102:103], v[146:147], v[146:147]
  v_pk_mul_f32 v[104:105], v[152:153], v[152:153]
  v_pk_mul_f32 v[106:107], v[154:155], v[154:155]
  v_pk_fma_f32 v[100:101], v[100:101], s[60:61], v[4:5] op_sel_hi:[1,0,0]
  v_pk_fma_f32 v[102:103], v[102:103], s[60:61], v[4:5] op_sel_hi:[1,0,0]
  v_pk_fma_f32 v[104:105], v[104:105], s[60:61], v[4:5] op_sel_hi:[1,0,0]
  v_pk_fma_f32 v[106:107], v[106:107], s[60:61], v[4:5] op_sel_hi:[1,0,0]
  v_pk_mul_f32 v[100:101], v[100:101], v[144:145]
  v_pk_mul_f32 v[102:103], v[102:103], v[146:147]
  v_pk_mul_f32 v[104:105], v[104:105], v[152:153]
  v_pk_mul_f32 v[106:107], v[106:107], v[154:155]
  v_exp_f32 v100, v100
  v_exp_f32 v101, v101
  v_exp_f32 v102, v102
  v_exp_f32 v103, v103
  v_exp_f32 v104, v104
  v_exp_f32 v105, v105
  v_exp_f32 v106, v106
  v_exp_f32 v107, v107
  v_pk_add_f32 v[100:101], v[100:101], v[4:5] op_sel:[0,1] op_sel_hi:[1,1]
  v_pk_add_f32 v[102:103], v[102:103], v[4:5] op_sel:[0,1] op_sel_hi:[1,1]
  v_pk_add_f32 v[104:105], v[104:105], v[4:5] op_sel:[0,1] op_sel_hi:[1,1]
  v_pk_add_f32 v[106:107], v[106:107], v[4:5] op_sel:[0,1] op_sel_hi:[1,1]
  v_rcp_f32 v100, v100
  v_rcp_f32 v101, v101
  v_rcp_f32 v102, v102
  v_rcp_f32 v103, v103
  v_rcp_f32 v104, v104
  v_rcp_f32 v105, v105
  v_rcp_f32 v106, v106
  v_rcp_f32 v107, v107
  v_pk_mul_f32 v[100:101], v[100:101], v[144:145]
  v_pk_mul_f32 v[102:103], v[102:103], v[146:147]
  v_pk_mul_f32 v[104:105], v[104:105], v[152:153]
  v_pk_mul_f32 v[106:107], v[106:107], v[154:155]
  v_cvt_pk_bf16_f32 v96, v100, v101
  v_cvt_pk_bf16_f32 v97, v102, v103
  v_cvt_pk_bf16_f32 v98, v104, v105
  v_cvt_pk_bf16_f32 v99, v106, v107
  s_nop 0
  v_permlane16_swap_b32 v96, v98
  v_permlane16_swap_b32 v97, v99
  buffer_store_dwordx4 v[96:99], v189, s[20:23], s11 offen offset:0 sc1
  s_waitcnt lgkmcnt(4)
  v_pk_fma_f32 v[156:157], v[30:31], v[84:85], v[156:157] op_sel_hi:[1,0,1]
  v_pk_fma_f32 v[158:159], v[32:33], v[84:85], v[158:159] op_sel_hi:[1,0,1]
  v_pk_fma_f32 v[160:161], v[30:31], v[86:87], v[160:161] op_sel_hi:[1,0,1]
  v_pk_fma_f32 v[162:163], v[32:33], v[86:87], v[162:163] op_sel_hi:[1,0,1]
  s_waitcnt lgkmcnt(3)
  v_pk_fma_f32 v[164:165], v[34:35], v[84:85], v[164:165] op_sel_hi:[1,0,1]
  v_pk_fma_f32 v[166:167], v[36:37], v[84:85], v[166:167] op_sel_hi:[1,0,1]
  v_pk_fma_f32 v[168:169], v[34:35], v[86:87], v[168:169] op_sel_hi:[1,0,1]
  v_pk_fma_f32 v[170:171], v[36:37], v[86:87], v[170:171] op_sel_hi:[1,0,1]
  v_pk_mul_f32 v[156:157], v[156:157], v[88:89] op_sel_hi:[1,0]
  v_pk_mul_f32 v[158:159], v[158:159], v[88:89] op_sel_hi:[1,0]
  v_pk_mul_f32 v[164:165], v[164:165], v[88:89] op_sel_hi:[1,0]
  v_pk_mul_f32 v[166:167], v[166:167], v[88:89] op_sel_hi:[1,0]
  v_pk_mul_f32 v[100:101], v[156:157], v[156:157]
  v_pk_mul_f32 v[102:103], v[158:159], v[158:159]
  v_pk_mul_f32 v[104:105], v[164:165], v[164:165]
  v_pk_mul_f32 v[106:107], v[166:167], v[166:167]
  v_pk_fma_f32 v[100:101], v[100:101], s[60:61], v[4:5] op_sel_hi:[1,0,0]
  v_pk_fma_f32 v[102:103], v[102:103], s[60:61], v[4:5] op_sel_hi:[1,0,0]
  v_pk_fma_f32 v[104:105], v[104:105], s[60:61], v[4:5] op_sel_hi:[1,0,0]
  v_pk_fma_f32 v[106:107], v[106:107], s[60:61], v[4:5] op_sel_hi:[1,0,0]
  v_pk_mul_f32 v[100:101], v[100:101], v[156:157]
  v_pk_mul_f32 v[102:103], v[102:103], v[158:159]
  v_pk_mul_f32 v[104:105], v[104:105], v[164:165]
  v_pk_mul_f32 v[106:107], v[106:107], v[166:167]
  v_exp_f32 v100, v100
  v_exp_f32 v101, v101
  v_exp_f32 v102, v102
  v_exp_f32 v103, v103
  v_exp_f32 v104, v104
  v_exp_f32 v105, v105
  v_exp_f32 v106, v106
  v_exp_f32 v107, v107
  v_pk_add_f32 v[100:101], v[100:101], v[4:5] op_sel:[0,1] op_sel_hi:[1,1]
  v_pk_add_f32 v[102:103], v[102:103], v[4:5] op_sel:[0,1] op_sel_hi:[1,1]
  v_pk_add_f32 v[104:105], v[104:105], v[4:5] op_sel:[0,1] op_sel_hi:[1,1]
  v_pk_add_f32 v[106:107], v[106:107], v[4:5] op_sel:[0,1] op_sel_hi:[1,1]
  v_rcp_f32 v100, v100
  v_rcp_f32 v101, v101
  v_rcp_f32 v102, v102
  v_rcp_f32 v103, v103
  v_rcp_f32 v104, v104
  v_rcp_f32 v105, v105
  v_rcp_f32 v106, v106
  v_rcp_f32 v107, v107
  v_pk_mul_f32 v[100:101], v[100:101], v[156:157]
  v_pk_mul_f32 v[102:103], v[102:103], v[158:159]
  v_pk_mul_f32 v[104:105], v[104:105], v[164:165]
  v_pk_mul_f32 v[106:107], v[106:107], v[166:167]
  v_cvt_pk_bf16_f32 v92, v100, v101
  v_cvt_pk_bf16_f32 v93, v102, v103
  v_cvt_pk_bf16_f32 v94, v104, v105
  v_cvt_pk_bf16_f32 v95, v106, v107
  s_nop 0
  v_permlane16_swap_b32 v92, v94
  v_permlane16_swap_b32 v93, v95
  buffer_store_dwordx4 v[92:95], v189, s[20:23], s10 offen offset:1024 sc1
  v_pk_mul_f32 v[160:161], v[160:161], v[90:91] op_sel_hi:[1,0]
  v_pk_mul_f32 v[162:163], v[162:163], v[90:91] op_sel_hi:[1,0]
  v_pk_mul_f32 v[168:169], v[168:169], v[90:91] op_sel_hi:[1,0]
  v_pk_mul_f32 v[170:171], v[170:171], v[90:91] op_sel_hi:[1,0]
  v_pk_mul_f32 v[100:101], v[160:161], v[160:161]
  v_pk_mul_f32 v[102:103], v[162:163], v[162:163]
  v_pk_mul_f32 v[104:105], v[168:169], v[168:169]
  v_pk_mul_f32 v[106:107], v[170:171], v[170:171]
  v_pk_fma_f32 v[100:101], v[100:101], s[60:61], v[4:5] op_sel_hi:[1,0,0]
  v_pk_fma_f32 v[102:103], v[102:103], s[60:61], v[4:5] op_sel_hi:[1,0,0]
  v_pk_fma_f32 v[104:105], v[104:105], s[60:61], v[4:5] op_sel_hi:[1,0,0]
  v_pk_fma_f32 v[106:107], v[106:107], s[60:61], v[4:5] op_sel_hi:[1,0,0]
  v_pk_mul_f32 v[100:101], v[100:101], v[160:161]
  v_pk_mul_f32 v[102:103], v[102:103], v[162:163]
  v_pk_mul_f32 v[104:105], v[104:105], v[168:169]
  v_pk_mul_f32 v[106:107], v[106:107], v[170:171]
  v_exp_f32 v100, v100
  v_exp_f32 v101, v101
  v_exp_f32 v102, v102
  v_exp_f32 v103, v103
  v_exp_f32 v104, v104
  v_exp_f32 v105, v105
  v_exp_f32 v106, v106
  v_exp_f32 v107, v107
  v_pk_add_f32 v[100:101], v[100:101], v[4:5] op_sel:[0,1] op_sel_hi:[1,1]
  v_pk_add_f32 v[102:103], v[102:103], v[4:5] op_sel:[0,1] op_sel_hi:[1,1]
  v_pk_add_f32 v[104:105], v[104:105], v[4:5] op_sel:[0,1] op_sel_hi:[1,1]
  v_pk_add_f32 v[106:107], v[106:107], v[4:5] op_sel:[0,1] op_sel_hi:[1,1]
  v_rcp_f32 v100, v100
  v_rcp_f32 v101, v101
  v_rcp_f32 v102, v102
  v_rcp_f32 v103, v103
  v_rcp_f32 v104, v104
  v_rcp_f32 v105, v105
  v_rcp_f32 v106, v106
  v_rcp_f32 v107, v107
  v_pk_mul_f32 v[100:101], v[100:101], v[160:161]
  v_pk_mul_f32 v[102:103], v[102:103], v[162:163]
  v_pk_mul_f32 v[104:105], v[104:105], v[168:169]
  v_pk_mul_f32 v[106:107], v[106:107], v[170:171]
  v_cvt_pk_bf16_f32 v96, v100, v101
  v_cvt_pk_bf16_f32 v97, v102, v103
  v_cvt_pk_bf16_f32 v98, v104, v105
  v_cvt_pk_bf16_f32 v99, v106, v107
  s_nop 0
  v_permlane16_swap_b32 v96, v98
  v_permlane16_swap_b32 v97, v99
  buffer_store_dwordx4 v[96:99], v189, s[20:23], s11 offen offset:1024 sc1
  s_waitcnt lgkmcnt(2)
  v_pk_fma_f32 v[172:173], v[72:73], v[84:85], v[172:173] op_sel_hi:[1,0,1]
  v_pk_fma_f32 v[174:175], v[74:75], v[84:85], v[174:175] op_sel_hi:[1,0,1]
  v_pk_fma_f32 v[176:177], v[72:73], v[86:87], v[176:177] op_sel_hi:[1,0,1]
  v_pk_fma_f32 v[178:179], v[74:75], v[86:87], v[178:179] op_sel_hi:[1,0,1]
  s_waitcnt lgkmcnt(1)
  v_pk_fma_f32 v[180:181], v[76:77], v[84:85], v[180:181] op_sel_hi:[1,0,1]
  v_pk_fma_f32 v[182:183], v[78:79], v[84:85], v[182:183] op_sel_hi:[1,0,1]
  v_pk_fma_f32 v[212:213], v[76:77], v[86:87], v[212:213] op_sel_hi:[1,0,1]
  v_pk_fma_f32 v[214:215], v[78:79], v[86:87], v[214:215] op_sel_hi:[1,0,1]
  v_pk_mul_f32 v[172:173], v[172:173], v[88:89] op_sel_hi:[1,0]
  v_pk_mul_f32 v[174:175], v[174:175], v[88:89] op_sel_hi:[1,0]
  v_pk_mul_f32 v[180:181], v[180:181], v[88:89] op_sel_hi:[1,0]
  v_pk_mul_f32 v[182:183], v[182:183], v[88:89] op_sel_hi:[1,0]
  v_pk_mul_f32 v[100:101], v[172:173], v[172:173]
  v_pk_mul_f32 v[102:103], v[174:175], v[174:175]
  v_pk_mul_f32 v[104:105], v[180:181], v[180:181]
  v_pk_mul_f32 v[106:107], v[182:183], v[182:183]
  v_pk_fma_f32 v[100:101], v[100:101], s[60:61], v[4:5] op_sel_hi:[1,0,0]
  v_pk_fma_f32 v[102:103], v[102:103], s[60:61], v[4:5] op_sel_hi:[1,0,0]
  v_pk_fma_f32 v[104:105], v[104:105], s[60:61], v[4:5] op_sel_hi:[1,0,0]
  v_pk_fma_f32 v[106:107], v[106:107], s[60:61], v[4:5] op_sel_hi:[1,0,0]
  v_pk_mul_f32 v[100:101], v[100:101], v[172:173]
  v_pk_mul_f32 v[102:103], v[102:103], v[174:175]
  v_pk_mul_f32 v[104:105], v[104:105], v[180:181]
  v_pk_mul_f32 v[106:107], v[106:107], v[182:183]
  v_exp_f32 v100, v100
  v_exp_f32 v101, v101
  v_exp_f32 v102, v102
  v_exp_f32 v103, v103
  v_exp_f32 v104, v104
  v_exp_f32 v105, v105
  v_exp_f32 v106, v106
  v_exp_f32 v107, v107
  v_pk_add_f32 v[100:101], v[100:101], v[4:5] op_sel:[0,1] op_sel_hi:[1,1]
  v_pk_add_f32 v[102:103], v[102:103], v[4:5] op_sel:[0,1] op_sel_hi:[1,1]
  v_pk_add_f32 v[104:105], v[104:105], v[4:5] op_sel:[0,1] op_sel_hi:[1,1]
  v_pk_add_f32 v[106:107], v[106:107], v[4:5] op_sel:[0,1] op_sel_hi:[1,1]
  v_rcp_f32 v100, v100
  v_rcp_f32 v101, v101
  v_rcp_f32 v102, v102
  v_rcp_f32 v103, v103
  v_rcp_f32 v104, v104
  v_rcp_f32 v105, v105
  v_rcp_f32 v106, v106
  v_rcp_f32 v107, v107
  v_pk_mul_f32 v[100:101], v[100:101], v[172:173]
  v_pk_mul_f32 v[102:103], v[102:103], v[174:175]
  v_pk_mul_f32 v[104:105], v[104:105], v[180:181]
  v_pk_mul_f32 v[106:107], v[106:107], v[182:183]
  v_cvt_pk_bf16_f32 v92, v100, v101
  v_cvt_pk_bf16_f32 v93, v102, v103
  v_cvt_pk_bf16_f32 v94, v104, v105
  v_cvt_pk_bf16_f32 v95, v106, v107
  s_nop 0
  v_permlane16_swap_b32 v92, v94
  v_permlane16_swap_b32 v93, v95
  buffer_store_dwordx4 v[92:95], v189, s[20:23], s10 offen offset:2048 sc1
  v_pk_mul_f32 v[176:177], v[176:177], v[90:91] op_sel_hi:[1,0]
  v_pk_mul_f32 v[178:179], v[178:179], v[90:91] op_sel_hi:[1,0]
  v_pk_mul_f32 v[212:213], v[212:213], v[90:91] op_sel_hi:[1,0]
  v_pk_mul_f32 v[214:215], v[214:215], v[90:91] op_sel_hi:[1,0]
  v_pk_mul_f32 v[100:101], v[176:177], v[176:177]
  v_pk_mul_f32 v[102:103], v[178:179], v[178:179]
  v_pk_mul_f32 v[104:105], v[212:213], v[212:213]
  v_pk_mul_f32 v[106:107], v[214:215], v[214:215]
  v_pk_fma_f32 v[100:101], v[100:101], s[60:61], v[4:5] op_sel_hi:[1,0,0]
  v_pk_fma_f32 v[102:103], v[102:103], s[60:61], v[4:5] op_sel_hi:[1,0,0]
  v_pk_fma_f32 v[104:105], v[104:105], s[60:61], v[4:5] op_sel_hi:[1,0,0]
  v_pk_fma_f32 v[106:107], v[106:107], s[60:61], v[4:5] op_sel_hi:[1,0,0]
  v_pk_mul_f32 v[100:101], v[100:101], v[176:177]
  v_pk_mul_f32 v[102:103], v[102:103], v[178:179]
  v_pk_mul_f32 v[104:105], v[104:105], v[212:213]
  v_pk_mul_f32 v[106:107], v[106:107], v[214:215]
  v_exp_f32 v100, v100
  v_exp_f32 v101, v101
  v_exp_f32 v102, v102
  v_exp_f32 v103, v103
  v_exp_f32 v104, v104
  v_exp_f32 v105, v105
  v_exp_f32 v106, v106
  v_exp_f32 v107, v107
  v_pk_add_f32 v[100:101], v[100:101], v[4:5] op_sel:[0,1] op_sel_hi:[1,1]
  v_pk_add_f32 v[102:103], v[102:103], v[4:5] op_sel:[0,1] op_sel_hi:[1,1]
  v_pk_add_f32 v[104:105], v[104:105], v[4:5] op_sel:[0,1] op_sel_hi:[1,1]
  v_pk_add_f32 v[106:107], v[106:107], v[4:5] op_sel:[0,1] op_sel_hi:[1,1]
  v_rcp_f32 v100, v100
  v_rcp_f32 v101, v101
  v_rcp_f32 v102, v102
  v_rcp_f32 v103, v103
  v_rcp_f32 v104, v104
  v_rcp_f32 v105, v105
  v_rcp_f32 v106, v106
  v_rcp_f32 v107, v107
  v_pk_mul_f32 v[100:101], v[100:101], v[176:177]
  v_pk_mul_f32 v[102:103], v[102:103], v[178:179]
  v_pk_mul_f32 v[104:105], v[104:105], v[212:213]
  v_pk_mul_f32 v[106:107], v[106:107], v[214:215]
  v_cvt_pk_bf16_f32 v96, v100, v101
  v_cvt_pk_bf16_f32 v97, v102, v103
  v_cvt_pk_bf16_f32 v98, v104, v105
  v_cvt_pk_bf16_f32 v99, v106, v107
  s_nop 0
  v_permlane16_swap_b32 v96, v98
  v_permlane16_swap_b32 v97, v99
  buffer_store_dwordx4 v[96:99], v189, s[20:23], s11 offen offset:2048 sc1
  s_waitcnt lgkmcnt(0)
  v_pk_fma_f32 v[216:217], v[80:81], v[84:85], v[216:217] op_sel_hi:[1,0,1]
  v_pk_fma_f32 v[218:219], v[82:83], v[84:85], v[218:219] op_sel_hi:[1,0,1]
  v_pk_fma_f32 v[220:221], v[80:81], v[86:87], v[220:221] op_sel_hi:[1,0,1]
  v_pk_fma_f32 v[222:223], v[82:83], v[86:87], v[222:223] op_sel_hi:[1,0,1]
  v_pk_mul_f32 v[216:217], v[216:217], v[88:89] op_sel_hi:[1,0]
  v_pk_mul_f32 v[218:219], v[218:219], v[88:89] op_sel_hi:[1,0]
  v_pk_mul_f32 v[220:221], v[220:221], v[90:91] op_sel_hi:[1,0]
  v_pk_mul_f32 v[222:223], v[222:223], v[90:91] op_sel_hi:[1,0]
  v_pk_mul_f32 v[100:101], v[216:217], v[216:217]
  v_pk_mul_f32 v[102:103], v[218:219], v[218:219]
  v_pk_mul_f32 v[104:105], v[220:221], v[220:221]
  v_pk_mul_f32 v[106:107], v[222:223], v[222:223]
  v_pk_fma_f32 v[100:101], v[100:101], s[60:61], v[4:5] op_sel_hi:[1,0,0]
  v_pk_fma_f32 v[102:103], v[102:103], s[60:61], v[4:5] op_sel_hi:[1,0,0]
  v_pk_fma_f32 v[104:105], v[104:105], s[60:61], v[4:5] op_sel_hi:[1,0,0]
  v_pk_fma_f32 v[106:107], v[106:107], s[60:61], v[4:5] op_sel_hi:[1,0,0]
  v_pk_mul_f32 v[100:101], v[100:101], v[216:217]
  v_pk_mul_f32 v[102:103], v[102:103], v[218:219]
  v_pk_mul_f32 v[104:105], v[104:105], v[220:221]
  v_pk_mul_f32 v[106:107], v[106:107], v[222:223]
  v_exp_f32 v100, v100
  v_exp_f32 v101, v101
  v_exp_f32 v102, v102
  v_exp_f32 v103, v103
  v_exp_f32 v104, v104
  v_exp_f32 v105, v105
  v_exp_f32 v106, v106
  v_exp_f32 v107, v107
  v_pk_add_f32 v[100:101], v[100:101], v[4:5] op_sel:[0,1] op_sel_hi:[1,1]
  v_pk_add_f32 v[102:103], v[102:103], v[4:5] op_sel:[0,1] op_sel_hi:[1,1]
  v_pk_add_f32 v[104:105], v[104:105], v[4:5] op_sel:[0,1] op_sel_hi:[1,1]
  v_pk_add_f32 v[106:107], v[106:107], v[4:5] op_sel:[0,1] op_sel_hi:[1,1]
  v_rcp_f32 v100, v100
  v_rcp_f32 v101, v101
  v_rcp_f32 v102, v102
  v_rcp_f32 v103, v103
  v_rcp_f32 v104, v104
  v_rcp_f32 v105, v105
  v_rcp_f32 v106, v106
  v_rcp_f32 v107, v107
  v_pk_mul_f32 v[100:101], v[100:101], v[216:217]
  v_pk_mul_f32 v[102:103], v[102:103], v[218:219]
  v_pk_mul_f32 v[104:105], v[104:105], v[220:221]
  v_pk_mul_f32 v[106:107], v[106:107], v[222:223]
  v_cvt_pk_bf16_f32 v92, v100, v101
  v_cvt_pk_bf16_f32 v93, v102, v103
  v_cvt_pk_bf16_f32 v94, v104, v105
  v_cvt_pk_bf16_f32 v95, v106, v107
  s_nop 0
  v_permlane16_swap_b32 v92, v94
  v_permlane16_swap_b32 v93, v95
  buffer_store_dwordx4 v[92:95], v11, s[20:23], s10 offen offset:3072 sc1
  s_nop 1
  s_waitcnt vmcnt(0)
  s_barrier
  s_nop 7
  s_cmp_lg_u32 s53, 0
  s_cbranch_scc1 L_ob_46
  v_lshlrev_b32 v8, 6, v2
  v_lshl_add_u32 v8, v3, 4, v8
  v_add_u32 v8, 0x23000, v8
  v_mul_u32_u24 v9, 0x550, v3
  v_lshl_add_u32 v9, v2, 4, v9
  v_add_u32 v9, 0x23540, v9
  v_mov_b32 v23, v8
  v_mul_u32_u24 v6, 20, v3
  v_sub_u32 v6, v2, v6
  v_add_u32 v6, 0, v6
  v_cmp_gt_u32 vcc, 20, v6
  v_mov_b32 v11, 0x24a80
  s_nop 0
  v_cndmask_b32 v25, v11, v9, vcc
  v_cmp_gt_u32 vcc, 4, v2
  v_mov_b32 v11, 0x24680
  s_nop 0
  v_cndmask_b32 v26, v11, v8, vcc
  v_cmp_le_u32 vcc, 4, v2
  v_mov_b32 v11, 0x244f0
  s_nop 0
  v_cndmask_b32 v27, v11, v8, vcc
  v_mul_u32_u24 v6, 20, v3
  v_sub_u32 v6, v2, v6
  v_add_u32 v6, 16, v6
  v_cmp_gt_u32 vcc, 20, v6
  v_mov_b32 v11, 0x24980
  s_nop 0
  v_cndmask_b32 v28, v11, v9, vcc
  v_cmp_gt_u32 vcc, 8, v2
  v_mov_b32 v11, 0x240f0
  s_nop 0
  v_cndmask_b32 v29, v11, v8, vcc
  v_cmp_le_u32 vcc, 8, v2
  v_mov_b32 v11, 0x23f60
  s_nop 0
  v_cndmask_b32 v30, v11, v8, vcc
  v_mul_u32_u24 v6, 20, v3
  v_sub_u32 v6, v2, v6
  v_add_u32 v6, 32, v6
  v_cmp_gt_u32 vcc, 20, v6
  v_mov_b32 v11, 0x24880
  s_nop 0
  v_cndmask_b32 v31, v11, v9, vcc
  v_cmp_gt_u32 vcc, 12, v2
  v_mov_b32 v11, 0x23b60
  s_nop 0
  v_cndmask_b32 v32, v11, v8, vcc
  v_cmp_le_u32 vcc, 12, v2
  v_mov_b32 v11, 0x239d0
  s_nop 0
  v_cndmask_b32 v33, v11, v8, vcc
  v_mul_u32_u24 v6, 20, v3
  v_sub_u32 v6, v2, v6
  v_add_u32 v6, 48, v6
  v_cmp_gt_u32 vcc, 20, v6
  v_mov_b32 v11, 0x24780
  s_nop 0
  v_cndmask_b32 v34, v11, v9, vcc
  v_mov_b32 v35, v8
  v_mul_u32_u24 v6, 20, v3
  v_sub_u32 v6, v2, v6
  v_add_u32 v6, 64, v6
  v_cmp_gt_u32 vcc, 20, v6
  v_mov_b32 v11, 0x24680
  s_nop 0
  v_cndmask_b32 v36, v11, v9, vcc
  v_and_b32 v7, 3, v2
  v_lshlrev_b32 v37, 4, v3
  v_add_u32 v37, 0x23500, v37
  v_cmp_eq_u32 vcc, 0, v7
  v_mov_b32 v11, 0x24a80
  s_nop 0
  v_cndmask_b32 v37, v11, v37, vcc
  v_lshlrev_b32 v38, 4, v3
  v_add_u32 v38, 0x23500, v38
  v_cmp_eq_u32 vcc, 1, v7
  v_mov_b32 v11, 0x243f0
  s_nop 0
  v_cndmask_b32 v38, v11, v38, vcc
  v_lshlrev_b32 v39, 4, v3
  v_add_u32 v39, 0x23500, v39
  v_cmp_eq_u32 vcc, 2, v7
  v_mov_b32 v11, 0x23d60
  s_nop 0
  v_cndmask_b32 v39, v11, v39, vcc
  v_lshlrev_b32 v72, 4, v3
  v_add_u32 v72, 0x23500, v72
  v_cmp_eq_u32 vcc, 3, v7
  v_mov_b32 v11, 0x236d0
  s_nop 0
  v_cndmask_b32 v72, v11, v72, vcc
  v_mul_u32_u24 v73, 0x690, v7
  v_add_u32 v73, 0x23680, v73
  v_cmp_eq_u32 vcc, v7, v3
  v_mov_b32 v11, 0x24a80
  s_nop 0
  v_cndmask_b32 v73, v11, v73, vcc
  ds_read_b128 v[74:77], v23 offset:0
  ds_read_b128 v[78:81], v26 offset:1024
  ds_read_b128 v[82:85], v27 offset:1424
  ds_read_b128 v[86:89], v29 offset:2448
  ds_read_b128 v[90:93], v30 offset:2848
  ds_read_b128 v[94:97], v32 offset:3872
  ds_read_b128 v[98:101], v33 offset:4272
  ds_read_b128 v[102:105], v35 offset:5296
  ds_read_b128 v[106:109], v37 offset:0
  ds_read_b128 v[110:113], v38 offset:1680
  ds_read_b128 v[114:117], v39 offset:3360
  ds_read_b128 v[118:121], v72 offset:5040
  ds_read_b128 v[122:125], v25 offset:0
  ds_read_b128 v[126:129], v28 offset:256
  ds_read_b128 v[26:29], v31 offset:512
  ds_read_b128 v[30:33], v34 offset:768
  ds_read_b128 v[130:133], v36 offset:1024
  ds_read_b128 v[34:37], v73 offset:0
  v_and_b32 v6, 1, v3
  v_mul_u32_u24 v8, 0x5000, v6
  v_lshl_add_u32 v8, v2, 4, v8
  v_lshrrev_b32 v6, 1, v3
  v_lshl_add_u32 v8, v6, 8, v8
  v_add_u32 v8, 0x800, v8
  s_mul_i32 s10, s9, 0x5000
  s_mul_i32 s66, s52, 0xa00
  s_add_u32 s66, s66, s10
  s_add_u32 s66, s66, 0x6ae000
  s_add_u32 s67, s66, 0x5000
  v_cmp_gt_u32 s[68:69], 1, v3
  v_cmp_gt_u32 s[70:71], 2, v3
  v_cmp_gt_u32 s[72:73], 3, v3
  s_waitcnt lgkmcnt(0)
  v_mfma_f32_16x16x32_bf16 v[158:161], v[34:37], v[208:211], 0
  v_mfma_f32_16x16x32_bf16 v[138:141], v[122:125], v[208:211], 0
  v_mfma_f32_16x16x32_bf16 v[142:145], v[126:129], v[208:211], 0
  v_mfma_f32_16x16x32_bf16 v[146:149], v[26:29], v[208:211], 0
  v_mfma_f32_16x16x32_bf16 v[150:153], v[30:33], v[208:211], 0
  v_mfma_f32_16x16x32_bf16 v[154:157], v[130:133], v[208:211], 0
  v_mfma_f32_16x16x32_bf16 v[158:161], v[106:109], v[192:195], v[158:161]
  v_mfma_f32_16x16x32_bf16 v[158:161], v[110:113], v[196:199], v[158:161]
  v_mfma_f32_16x16x32_bf16 v[158:161], v[114:117], v[200:203], v[158:161]
  v_mfma_f32_16x16x32_bf16 v[158:161], v[118:121], v[204:207], v[158:161]
  v_mfma_f32_16x16x32_bf16 v[138:141], v[74:77], v[192:195], v[138:141]
  v_mfma_f32_16x16x32_bf16 v[142:145], v[78:81], v[192:195], v[142:145]
  v_mfma_f32_16x16x32_bf16 v[142:145], v[82:85], v[196:199], v[142:145]
  v_mfma_f32_16x16x32_bf16 v[146:149], v[86:89], v[196:199], v[146:149]
  v_mfma_f32_16x16x32_bf16 v[146:149], v[90:93], v[200:203], v[146:149]
  v_mfma_f32_16x16x32_bf16 v[150:153], v[94:97], v[200:203], v[150:153]
  v_mfma_f32_16x16x32_bf16 v[150:153], v[98:101], v[204:207], v[150:153]
  v_mfma_f32_16x16x32_bf16 v[154:157], v[102:105], v[204:207], v[154:157]
  v_mfma_f32_16x16x32_bf16 v[212:215], v[34:37], v[68:71], 0
  v_mfma_f32_16x16x32_bf16 v[162:165], v[122:125], v[68:71], 0
  v_mfma_f32_16x16x32_bf16 v[166:169], v[126:129], v[68:71], 0
  v_mfma_f32_16x16x32_bf16 v[170:173], v[26:29], v[68:71], 0
  v_mfma_f32_16x16x32_bf16 v[174:177], v[30:33], v[68:71], 0
  v_mfma_f32_16x16x32_bf16 v[178:181], v[130:133], v[68:71], 0
  v_mfma_f32_16x16x32_bf16 v[212:215], v[106:109], v[52:55], v[212:215]
  v_mfma_f32_16x16x32_bf16 v[212:215], v[110:113], v[56:59], v[212:215]
  v_mfma_f32_16x16x32_bf16 v[212:215], v[114:117], v[60:63], v[212:215]
  v_mfma_f32_16x16x32_bf16 v[212:215], v[118:121], v[64:67], v[212:215]
  v_mfma_f32_16x16x32_bf16 v[162:165], v[74:77], v[52:55], v[162:165]
  v_mfma_f32_16x16x32_bf16 v[166:169], v[78:81], v[52:55], v[166:169]
  v_mfma_f32_16x16x32_bf16 v[166:169], v[82:85], v[56:59], v[166:169]
  v_mfma_f32_16x16x32_bf16 v[170:173], v[86:89], v[56:59], v[170:173]
  v_mfma_f32_16x16x32_bf16 v[170:173], v[90:93], v[60:63], v[170:173]
  v_mfma_f32_16x16x32_bf16 v[174:177], v[94:97], v[60:63], v[174:177]
  v_mfma_f32_16x16x32_bf16 v[174:177], v[98:101], v[64:67], v[174:177]
  v_mfma_f32_16x16x32_bf16 v[178:181], v[102:105], v[64:67], v[178:181]
  v_add_f32 v158, 0x358637bd, v158
  v_add_f32 v159, 0x358637bd, v159
  v_add_f32 v160, 0x358637bd, v160
  v_add_f32 v161, 0x358637bd, v161
  v_rcp_f32 v158, v158
  v_rcp_f32 v159, v159
  v_rcp_f32 v160, v160
  v_rcp_f32 v161, v161
  v_add_f32 v212, 0x358637bd, v212
  v_add_f32 v213, 0x358637bd, v213
  v_add_f32 v214, 0x358637bd, v214
  v_add_f32 v215, 0x358637bd, v215
  v_rcp_f32 v212, v212
  v_rcp_f32 v213, v213
  v_rcp_f32 v214, v214
  v_rcp_f32 v215, v215
  v_mov_b32 v38, v158
  v_cndmask_b32 v72, v159, v158, s[68:69]
  v_cndmask_b32 v182, v160, v159, s[70:71]
  v_cndmask_b32 v186, v161, v160, s[72:73]
  v_mov_b32 v216, v161
  v_pk_mul_f32 v[138:139], v[138:139], v[38:39] op_sel_hi:[1,0]
  v_pk_mul_f32 v[140:141], v[140:141], v[38:39] op_sel_hi:[1,0]
  v_pk_mul_f32 v[142:143], v[142:143], v[72:73] op_sel_hi:[1,0]
  v_pk_mul_f32 v[144:145], v[144:145], v[72:73] op_sel_hi:[1,0]
  v_pk_mul_f32 v[146:147], v[146:147], v[182:183] op_sel_hi:[1,0]
  v_pk_mul_f32 v[148:149], v[148:149], v[182:183] op_sel_hi:[1,0]
  v_pk_mul_f32 v[150:151], v[150:151], v[186:187] op_sel_hi:[1,0]
  v_pk_mul_f32 v[152:153], v[152:153], v[186:187] op_sel_hi:[1,0]
  v_pk_mul_f32 v[154:155], v[154:155], v[216:217] op_sel_hi:[1,0]
  v_pk_mul_f32 v[156:157], v[156:157], v[216:217] op_sel_hi:[1,0]
  v_cvt_pk_bf16_f32 v218, v138, v139
  v_cvt_pk_bf16_f32 v219, v140, v141
  v_cvt_pk_bf16_f32 v220, v142, v143
  v_cvt_pk_bf16_f32 v221, v144, v145
  v_cvt_pk_bf16_f32 v222, v146, v147
  v_cvt_pk_bf16_f32 v223, v148, v149
  v_cvt_pk_bf16_f32 v224, v150, v151
  v_cvt_pk_bf16_f32 v225, v152, v153
  v_cvt_pk_bf16_f32 v134, v154, v155
  v_cvt_pk_bf16_f32 v135, v156, v157
  v_permlane16_swap_b32 v218, v220
  v_permlane16_swap_b32 v219, v221
  buffer_store_dwordx4 v[218:221], v189, s[20:23], s66 offen offset:0 sc1
  v_permlane16_swap_b32 v222, v224
  v_permlane16_swap_b32 v223, v225
  buffer_store_dwordx4 v[222:225], v189, s[20:23], s66 offen offset:1024 sc1
  s_nop 1
  v_mov_b32 v38, v212
  v_cndmask_b32 v72, v213, v212, s[68:69]
  v_cndmask_b32 v138, v214, v213, s[70:71]
  v_cndmask_b32 v140, v215, v214, s[72:73]
  v_mov_b32 v142, v215
  v_pk_mul_f32 v[162:163], v[162:163], v[38:39] op_sel_hi:[1,0]
  v_pk_mul_f32 v[164:165], v[164:165], v[38:39] op_sel_hi:[1,0]
  v_pk_mul_f32 v[166:167], v[166:167], v[72:73] op_sel_hi:[1,0]
  v_pk_mul_f32 v[168:169], v[168:169], v[72:73] op_sel_hi:[1,0]
  v_pk_mul_f32 v[170:171], v[170:171], v[138:139] op_sel_hi:[1,0]
  v_pk_mul_f32 v[172:173], v[172:173], v[138:139] op_sel_hi:[1,0]
  v_pk_mul_f32 v[174:175], v[174:175], v[140:141] op_sel_hi:[1,0]
  v_pk_mul_f32 v[176:177], v[176:177], v[140:141] op_sel_hi:[1,0]
  v_pk_mul_f32 v[178:179], v[178:179], v[142:143] op_sel_hi:[1,0]
  v_pk_mul_f32 v[180:181], v[180:181], v[142:143] op_sel_hi:[1,0]
  v_cvt_pk_bf16_f32 v144, v162, v163
  v_cvt_pk_bf16_f32 v145, v164, v165
  v_cvt_pk_bf16_f32 v146, v166, v167
  v_cvt_pk_bf16_f32 v147, v168, v169
  v_cvt_pk_bf16_f32 v148, v170, v171
  v_cvt_pk_bf16_f32 v149, v172, v173
  v_cvt_pk_bf16_f32 v150, v174, v175
  v_cvt_pk_bf16_f32 v151, v176, v177
  v_cvt_pk_bf16_f32 v136, v178, v179
  v_cvt_pk_bf16_f32 v137, v180, v181
  v_permlane16_swap_b32 v144, v146
  v_permlane16_swap_b32 v145, v147
  buffer_store_dwordx4 v[144:147], v189, s[20:23], s67 offen offset:0 sc1
  v_permlane16_swap_b32 v148, v150
  v_permlane16_swap_b32 v149, v151
  buffer_store_dwordx4 v[148:151], v189, s[20:23], s67 offen offset:1024 sc1
  s_nop 1
  v_permlane16_swap_b32 v134, v136
  v_permlane16_swap_b32 v135, v137
  buffer_store_dwordx4 v[134:137], v8, s[20:23], s66 offen sc1
  s_nop 1
  s_waitcnt lgkmcnt(0)
  s_nop 7
  s_branch L_oe_47
L_ob_46:
  s_waitcnt lgkmcnt(0)
  s_nop 7
L_oe_47:
  s_mul_i32 s10, s64, 0xa000
  v_subrev_u32 v22, s10, v22
  v_add_u32 v6, 0xf000, v22
  v_add_u32 v7, 0x1e000, v22
  s_add_u32 s10, s64, 0
  s_and_b32 s10, s10, 1
  s_add_u32 s10, s10, s65
  s_mul_i32 s67, s10, 0xd800
  s_mul_i32 s69, s64, 0x6c00
  s_add_u32 s67, s67, s69
  s_add_u32 s67, s67, 0x92e000
  s_mul_i32 s11, s10, 0x5000
  s_mul_i32 s69, s64, 0x2800
  s_add_u32 s11, s11, s69
  s_add_u32 s11, s11, 0x6ae000
  s_add_u32 s10, s64, 1
  s_and_b32 s10, s10, 1
  s_add_u32 s10, s10, s65
  s_mul_i32 s68, s10, 0xd800
  s_mul_i32 s69, s64, 0x6c00
  s_add_u32 s68, s68, s69
  s_add_u32 s68, s68, 0x92e000
  s_mul_i32 s66, s10, 0x5000
  s_mul_i32 s69, s64, 0x2800
  s_add_u32 s66, s66, s69
  s_add_u32 s66, s66, 0x6ae000
  s_barrier
  buffer_load_dwordx4 v[26:29], v190, s[20:23], s67 offen offset:0 sc1
  buffer_load_dwordx4 v[30:33], v190, s[20:23], s68 offen offset:0 sc1
  buffer_load_dwordx4 v[34:37], v190, s[20:23], s67 offen offset:1024 sc1
  buffer_load_dwordx4 v[52:55], v190, s[20:23], s68 offen offset:1024 sc1
  buffer_load_dwordx4 v[56:59], v190, s[20:23], s67 offen offset:2048 sc1
  buffer_load_dwordx4 v[60:63], v190, s[20:23], s68 offen offset:2048 sc1
  buffer_load_dwordx4 v[64:67], v190, s[20:23], s67 offen offset:3072 sc1
  buffer_load_dwordx4 v[68:71], v190, s[20:23], s68 offen offset:3072 sc1
  s_add_u32 s67, s67, 0x1000
  buffer_load_dwordx4 v[72:75], v190, s[20:23], s67 offen offset:0 sc1
  s_add_u32 s68, s68, 0x1000
  buffer_load_dwordx4 v[76:79], v190, s[20:23], s68 offen offset:0 sc1
  buffer_load_dwordx4 v[80:83], v190, s[20:23], s67 offen offset:1024 sc1
  buffer_load_dwordx4 v[84:87], v190, s[20:23], s68 offen offset:1024 sc1
  buffer_load_dwordx4 v[88:91], v190, s[20:23], s67 offen offset:2048 sc1
  buffer_load_dwordx4 v[92:95], v190, s[20:23], s68 offen offset:2048 sc1
  buffer_load_dwordx4 v[96:99], v190, s[20:23], s67 offen offset:3072 sc1
  buffer_load_dwordx4 v[100:103], v190, s[20:23], s68 offen offset:3072 sc1
  s_add_u32 s67, s67, 0x1000
  buffer_load_dwordx4 v[104:107], v190, s[20:23], s67 offen offset:0 sc1
  s_add_u32 s68, s68, 0x1000
  buffer_load_dwordx4 v[108:111], v190, s[20:23], s68 offen offset:0 sc1
  buffer_load_dwordx4 v[112:115], v190, s[20:23], s67 offen offset:1024 sc1
  buffer_load_dwordx4 v[116:119], v190, s[20:23], s68 offen offset:1024 sc1
  buffer_load_dwordx4 v[120:123], v190, s[20:23], s67 offen offset:2048 sc1
  buffer_load_dwordx4 v[124:127], v190, s[20:23], s68 offen offset:2048 sc1
  ds_read_b64_tr_b16 v[136:137], v22 offset:0
  ds_read_b64_tr_b16 v[138:139], v22 offset:1280
  ds_read_b64_tr_b16 v[140:141], v22 offset:32
  ds_read_b64_tr_b16 v[142:143], v22 offset:1312
  ds_read_b64_tr_b16 v[144:145], v22 offset:64
  ds_read_b64_tr_b16 v[146:147], v22 offset:1344
  ds_read_b64_tr_b16 v[148:149], v22 offset:96
  ds_read_b64_tr_b16 v[150:151], v22 offset:1376
  ds_read_b64_tr_b16 v[152:153], v22 offset:128
  ds_read_b64_tr_b16 v[154:155], v22 offset:1408
  s_waitcnt lgkmcnt(6)
  s_waitcnt vmcnt(21)
  v_mfma_f32_16x16x32_bf16 v[176:179], v[136:139], v[26:29], 0
  ds_read_b64_tr_b16 v[156:157], v22 offset:5120
  s_waitcnt vmcnt(20)
  v_mfma_f32_16x16x32_bf16 v[180:183], v[136:139], v[30:33], 0
  ds_read_b64_tr_b16 v[158:159], v22 offset:6400
  v_mfma_f32_16x16x32_bf16 v[192:195], v[140:143], v[26:29], 0
  ds_read_b64_tr_b16 v[160:161], v22 offset:5152
  buffer_load_dwordx4 v[128:131], v190, s[20:23], s67 offen offset:3072 sc1
  v_mfma_f32_16x16x32_bf16 v[196:199], v[140:143], v[30:33], 0
  ds_read_b64_tr_b16 v[162:163], v22 offset:6432
  s_waitcnt lgkmcnt(6)
  v_mfma_f32_16x16x32_bf16 v[200:203], v[144:147], v[26:29], 0
  ds_read_b64_tr_b16 v[164:165], v22 offset:5184
  v_mfma_f32_16x16x32_bf16 v[204:207], v[144:147], v[30:33], 0
  ds_read_b64_tr_b16 v[166:167], v22 offset:6464
  buffer_load_dwordx4 v[132:135], v190, s[20:23], s68 offen offset:3072 sc1
  v_mfma_f32_16x16x32_bf16 v[208:211], v[148:151], v[26:29], 0
  ds_read_b64_tr_b16 v[168:169], v22 offset:5216
  v_mfma_f32_16x16x32_bf16 v[212:215], v[148:151], v[30:33], 0
  ds_read_b64_tr_b16 v[170:171], v22 offset:6496
  s_waitcnt lgkmcnt(8)
  v_mfma_f32_16x16x32_bf16 v[216:219], v[152:155], v[26:29], 0
  ds_read_b64_tr_b16 v[172:173], v22 offset:5248
  v_mfma_f32_16x16x32_bf16 v[220:223], v[152:155], v[30:33], 0
  ds_read_b64_tr_b16 v[174:175], v22 offset:6528
  s_barrier
  s_waitcnt lgkmcnt(6)
  s_waitcnt vmcnt(21)
  v_mfma_f32_16x16x32_bf16 v[176:179], v[156:159], v[34:37], v[176:179]
  ds_read_b64_tr_b16 v[136:137], v22 offset:20480
  s_waitcnt vmcnt(20)
  v_mfma_f32_16x16x32_bf16 v[180:183], v[156:159], v[52:55], v[180:183]
  ds_read_b64_tr_b16 v[138:139], v22 offset:21760
  s_add_u32 s67, s67, 0x1000
  v_mfma_f32_16x16x32_bf16 v[192:195], v[160:163], v[34:37], v[192:195]
  ds_read_b64_tr_b16 v[140:141], v22 offset:20512
  v_mfma_f32_16x16x32_bf16 v[196:199], v[160:163], v[52:55], v[196:199]
  ds_read_b64_tr_b16 v[142:143], v22 offset:21792
  buffer_load_dwordx4 v[26:29], v190, s[20:23], s67 offen offset:0 sc1
  s_waitcnt lgkmcnt(6)
  v_mfma_f32_16x16x32_bf16 v[200:203], v[164:167], v[34:37], v[200:203]
  ds_read_b64_tr_b16 v[144:145], v22 offset:20544
  v_mfma_f32_16x16x32_bf16 v[204:207], v[164:167], v[52:55], v[204:207]
  ds_read_b64_tr_b16 v[146:147], v22 offset:21824
  s_add_u32 s68, s68, 0x1000
  v_mfma_f32_16x16x32_bf16 v[208:211], v[168:171], v[34:37], v[208:211]
  ds_read_b64_tr_b16 v[148:149], v22 offset:20576
  v_mfma_f32_16x16x32_bf16 v[212:215], v[168:171], v[52:55], v[212:215]
  ds_read_b64_tr_b16 v[150:151], v22 offset:21856
  buffer_load_dwordx4 v[30:33], v190, s[20:23], s68 offen offset:0 sc1
  s_waitcnt lgkmcnt(8)
  v_mfma_f32_16x16x32_bf16 v[216:219], v[172:175], v[34:37], v[216:219]
  ds_read_b64_tr_b16 v[152:153], v22 offset:20608
  v_mfma_f32_16x16x32_bf16 v[220:223], v[172:175], v[52:55], v[220:223]
  ds_read_b64_tr_b16 v[154:155], v22 offset:21888
  s_waitcnt lgkmcnt(6)
  s_waitcnt vmcnt(21)
  v_mfma_f32_16x16x32_bf16 v[176:179], v[136:139], v[56:59], v[176:179]
  ds_read_b64_tr_b16 v[156:157], v22 offset:25600
  s_waitcnt vmcnt(20)
  v_mfma_f32_16x16x32_bf16 v[180:183], v[136:139], v[60:63], v[180:183]
  ds_read_b64_tr_b16 v[158:159], v22 offset:26880
  v_mfma_f32_16x16x32_bf16 v[192:195], v[140:143], v[56:59], v[192:195]
  ds_read_b64_tr_b16 v[160:161], v22 offset:25632
  buffer_load_dwordx4 v[34:37], v190, s[20:23], s67 offen offset:1024 sc1
  v_mfma_f32_16x16x32_bf16 v[196:199], v[140:143], v[60:63], v[196:199]
  ds_read_b64_tr_b16 v[162:163], v22 offset:26912
  s_waitcnt lgkmcnt(6)
  v_mfma_f32_16x16x32_bf16 v[200:203], v[144:147], v[56:59], v[200:203]
  ds_read_b64_tr_b16 v[164:165], v22 offset:25664
  v_mfma_f32_16x16x32_bf16 v[204:207], v[144:147], v[60:63], v[204:207]
  ds_read_b64_tr_b16 v[166:167], v22 offset:26944
  buffer_load_dwordx4 v[52:55], v190, s[20:23], s68 offen offset:1024 sc1
  v_mfma_f32_16x16x32_bf16 v[208:211], v[148:151], v[56:59], v[208:211]
  ds_read_b64_tr_b16 v[168:169], v22 offset:25696
  v_mfma_f32_16x16x32_bf16 v[212:215], v[148:151], v[60:63], v[212:215]
  ds_read_b64_tr_b16 v[170:171], v22 offset:26976
  s_waitcnt lgkmcnt(8)
  v_mfma_f32_16x16x32_bf16 v[216:219], v[152:155], v[56:59], v[216:219]
  ds_read_b64_tr_b16 v[172:173], v22 offset:25728
  v_mfma_f32_16x16x32_bf16 v[220:223], v[152:155], v[60:63], v[220:223]
  ds_read_b64_tr_b16 v[174:175], v22 offset:27008
  s_barrier
  s_waitcnt lgkmcnt(6)
  s_waitcnt vmcnt(21)
  v_mfma_f32_16x16x32_bf16 v[176:179], v[156:159], v[64:67], v[176:179]
  ds_read_b64_tr_b16 v[136:137], v22 offset:40960
  s_waitcnt vmcnt(20)
  v_mfma_f32_16x16x32_bf16 v[180:183], v[156:159], v[68:71], v[180:183]
  ds_read_b64_tr_b16 v[138:139], v22 offset:42240
  v_mfma_f32_16x16x32_bf16 v[192:195], v[160:163], v[64:67], v[192:195]
  ds_read_b64_tr_b16 v[140:141], v22 offset:40992
  buffer_load_dwordx4 v[56:59], v190, s[20:23], s67 offen offset:2048 sc1
  v_mfma_f32_16x16x32_bf16 v[196:199], v[160:163], v[68:71], v[196:199]
  ds_read_b64_tr_b16 v[142:143], v22 offset:42272
  s_waitcnt lgkmcnt(6)
  v_mfma_f32_16x16x32_bf16 v[200:203], v[164:167], v[64:67], v[200:203]
  ds_read_b64_tr_b16 v[144:145], v22 offset:41024
  v_mfma_f32_16x16x32_bf16 v[204:207], v[164:167], v[68:71], v[204:207]
  ds_read_b64_tr_b16 v[146:147], v22 offset:42304
  buffer_load_dwordx4 v[60:63], v190, s[20:23], s68 offen offset:2048 sc1
  v_mfma_f32_16x16x32_bf16 v[208:211], v[168:171], v[64:67], v[208:211]
  ds_read_b64_tr_b16 v[148:149], v22 offset:41056
  v_mfma_f32_16x16x32_bf16 v[212:215], v[168:171], v[68:71], v[212:215]
  ds_read_b64_tr_b16 v[150:151], v22 offset:42336
  s_waitcnt lgkmcnt(8)
  v_mfma_f32_16x16x32_bf16 v[216:219], v[172:175], v[64:67], v[216:219]
  ds_read_b64_tr_b16 v[152:153], v22 offset:41088
  v_mfma_f32_16x16x32_bf16 v[220:223], v[172:175], v[68:71], v[220:223]
  ds_read_b64_tr_b16 v[154:155], v22 offset:42368
  s_waitcnt lgkmcnt(6)
  s_waitcnt vmcnt(21)
  v_mfma_f32_16x16x32_bf16 v[176:179], v[136:139], v[72:75], v[176:179]
  ds_read_b64_tr_b16 v[156:157], v22 offset:46080
  s_waitcnt vmcnt(20)
  v_mfma_f32_16x16x32_bf16 v[180:183], v[136:139], v[76:79], v[180:183]
  ds_read_b64_tr_b16 v[158:159], v22 offset:47360
  v_mfma_f32_16x16x32_bf16 v[192:195], v[140:143], v[72:75], v[192:195]
  ds_read_b64_tr_b16 v[160:161], v22 offset:46112
  buffer_load_dwordx4 v[64:67], v190, s[20:23], s67 offen offset:3072 sc1
  v_mfma_f32_16x16x32_bf16 v[196:199], v[140:143], v[76:79], v[196:199]
  ds_read_b64_tr_b16 v[162:163], v22 offset:47392
  s_waitcnt lgkmcnt(6)
  v_mfma_f32_16x16x32_bf16 v[200:203], v[144:147], v[72:75], v[200:203]
  ds_read_b64_tr_b16 v[164:165], v22 offset:46144
  v_mfma_f32_16x16x32_bf16 v[204:207], v[144:147], v[76:79], v[204:207]
  ds_read_b64_tr_b16 v[166:167], v22 offset:47424
  buffer_load_dwordx4 v[68:71], v190, s[20:23], s68 offen offset:3072 sc1
  v_mfma_f32_16x16x32_bf16 v[208:211], v[148:151], v[72:75], v[208:211]
  ds_read_b64_tr_b16 v[168:169], v22 offset:46176
  v_mfma_f32_16x16x32_bf16 v[212:215], v[148:151], v[76:79], v[212:215]
  ds_read_b64_tr_b16 v[170:171], v22 offset:47456
  s_waitcnt lgkmcnt(8)
  v_mfma_f32_16x16x32_bf16 v[216:219], v[152:155], v[72:75], v[216:219]
  ds_read_b64_tr_b16 v[172:173], v22 offset:46208
  v_mfma_f32_16x16x32_bf16 v[220:223], v[152:155], v[76:79], v[220:223]
  ds_read_b64_tr_b16 v[174:175], v22 offset:47488
  s_barrier
  s_waitcnt lgkmcnt(6)
  s_waitcnt vmcnt(21)
  v_mfma_f32_16x16x32_bf16 v[176:179], v[156:159], v[80:83], v[176:179]
  ds_read_b64_tr_b16 v[136:137], v6 offset:0
  s_waitcnt vmcnt(20)
  v_mfma_f32_16x16x32_bf16 v[180:183], v[156:159], v[84:87], v[180:183]
  ds_read_b64_tr_b16 v[138:139], v6 offset:1280
  s_add_u32 s67, s67, 0x1000
  v_mfma_f32_16x16x32_bf16 v[192:195], v[160:163], v[80:83], v[192:195]
  ds_read_b64_tr_b16 v[140:141], v6 offset:32
  v_mfma_f32_16x16x32_bf16 v[196:199], v[160:163], v[84:87], v[196:199]
  ds_read_b64_tr_b16 v[142:143], v6 offset:1312
  buffer_load_dwordx4 v[72:75], v190, s[20:23], s67 offen offset:0 sc1
  s_waitcnt lgkmcnt(6)
  v_mfma_f32_16x16x32_bf16 v[200:203], v[164:167], v[80:83], v[200:203]
  ds_read_b64_tr_b16 v[144:145], v6 offset:64
  v_mfma_f32_16x16x32_bf16 v[204:207], v[164:167], v[84:87], v[204:207]
  ds_read_b64_tr_b16 v[146:147], v6 offset:1344
  s_add_u32 s68, s68, 0x1000
  v_mfma_f32_16x16x32_bf16 v[208:211], v[168:171], v[80:83], v[208:211]
  ds_read_b64_tr_b16 v[148:149], v6 offset:96
  v_mfma_f32_16x16x32_bf16 v[212:215], v[168:171], v[84:87], v[212:215]
  ds_read_b64_tr_b16 v[150:151], v6 offset:1376
  buffer_load_dwordx4 v[76:79], v190, s[20:23], s68 offen offset:0 sc1
  s_waitcnt lgkmcnt(8)
  v_mfma_f32_16x16x32_bf16 v[216:219], v[172:175], v[80:83], v[216:219]
  ds_read_b64_tr_b16 v[152:153], v6 offset:128
  v_mfma_f32_16x16x32_bf16 v[220:223], v[172:175], v[84:87], v[220:223]
  ds_read_b64_tr_b16 v[154:155], v6 offset:1408
  s_waitcnt lgkmcnt(6)
  s_waitcnt vmcnt(21)
  v_mfma_f32_16x16x32_bf16 v[176:179], v[136:139], v[88:91], v[176:179]
  ds_read_b64_tr_b16 v[156:157], v6 offset:5120
  s_waitcnt vmcnt(20)
  v_mfma_f32_16x16x32_bf16 v[180:183], v[136:139], v[92:95], v[180:183]
  ds_read_b64_tr_b16 v[158:159], v6 offset:6400
  v_mfma_f32_16x16x32_bf16 v[192:195], v[140:143], v[88:91], v[192:195]
  ds_read_b64_tr_b16 v[160:161], v6 offset:5152
  buffer_load_dwordx4 v[80:83], v190, s[20:23], s67 offen offset:1024 sc1
  v_mfma_f32_16x16x32_bf16 v[196:199], v[140:143], v[92:95], v[196:199]
  ds_read_b64_tr_b16 v[162:163], v6 offset:6432
  s_waitcnt lgkmcnt(6)
  v_mfma_f32_16x16x32_bf16 v[200:203], v[144:147], v[88:91], v[200:203]
  ds_read_b64_tr_b16 v[164:165], v6 offset:5184
  v_mfma_f32_16x16x32_bf16 v[204:207], v[144:147], v[92:95], v[204:207]
  ds_read_b64_tr_b16 v[166:167], v6 offset:6464
  buffer_load_dwordx4 v[84:87], v190, s[20:23], s68 offen offset:1024 sc1
  v_mfma_f32_16x16x32_bf16 v[208:211], v[148:151], v[88:91], v[208:211]
  ds_read_b64_tr_b16 v[168:169], v6 offset:5216
  v_mfma_f32_16x16x32_bf16 v[212:215], v[148:151], v[92:95], v[212:215]
  ds_read_b64_tr_b16 v[170:171], v6 offset:6496
  s_waitcnt lgkmcnt(8)
  v_mfma_f32_16x16x32_bf16 v[216:219], v[152:155], v[88:91], v[216:219]
  ds_read_b64_tr_b16 v[172:173], v6 offset:5248
  v_mfma_f32_16x16x32_bf16 v[220:223], v[152:155], v[92:95], v[220:223]
  ds_read_b64_tr_b16 v[174:175], v6 offset:6528
  s_barrier
  s_waitcnt lgkmcnt(6)
  s_waitcnt vmcnt(21)
  v_mfma_f32_16x16x32_bf16 v[176:179], v[156:159], v[96:99], v[176:179]
  ds_read_b64_tr_b16 v[136:137], v6 offset:20480
  s_waitcnt vmcnt(20)
  v_mfma_f32_16x16x32_bf16 v[180:183], v[156:159], v[100:103], v[180:183]
  ds_read_b64_tr_b16 v[138:139], v6 offset:21760
  v_mfma_f32_16x16x32_bf16 v[192:195], v[160:163], v[96:99], v[192:195]
  ds_read_b64_tr_b16 v[140:141], v6 offset:20512
  buffer_load_dwordx4 v[88:91], v190, s[20:23], s67 offen offset:2048 sc1
  v_mfma_f32_16x16x32_bf16 v[196:199], v[160:163], v[100:103], v[196:199]
  ds_read_b64_tr_b16 v[142:143], v6 offset:21792
  s_waitcnt lgkmcnt(6)
  v_mfma_f32_16x16x32_bf16 v[200:203], v[164:167], v[96:99], v[200:203]
  ds_read_b64_tr_b16 v[144:145], v6 offset:20544
  v_mfma_f32_16x16x32_bf16 v[204:207], v[164:167], v[100:103], v[204:207]
  ds_read_b64_tr_b16 v[146:147], v6 offset:21824
  buffer_load_dwordx4 v[92:95], v190, s[20:23], s68 offen offset:2048 sc1
  v_mfma_f32_16x16x32_bf16 v[208:211], v[168:171], v[96:99], v[208:211]
  ds_read_b64_tr_b16 v[148:149], v6 offset:20576
  v_mfma_f32_16x16x32_bf16 v[212:215], v[168:171], v[100:103], v[212:215]
  ds_read_b64_tr_b16 v[150:151], v6 offset:21856
  s_waitcnt lgkmcnt(8)
  v_mfma_f32_16x16x32_bf16 v[216:219], v[172:175], v[96:99], v[216:219]
  ds_read_b64_tr_b16 v[152:153], v6 offset:20608
  v_mfma_f32_16x16x32_bf16 v[220:223], v[172:175], v[100:103], v[220:223]
  ds_read_b64_tr_b16 v[154:155], v6 offset:21888
  s_waitcnt lgkmcnt(6)
  s_waitcnt vmcnt(21)
  v_mfma_f32_16x16x32_bf16 v[176:179], v[136:139], v[104:107], v[176:179]
  ds_read_b64_tr_b16 v[156:157], v6 offset:25600
  s_waitcnt vmcnt(20)
  v_mfma_f32_16x16x32_bf16 v[180:183], v[136:139], v[108:111], v[180:183]
  ds_read_b64_tr_b16 v[158:159], v6 offset:26880
  v_mfma_f32_16x16x32_bf16 v[192:195], v[140:143], v[104:107], v[192:195]
  ds_read_b64_tr_b16 v[160:161], v6 offset:25632
  buffer_load_dwordx4 v[96:99], v190, s[20:23], s67 offen offset:3072 sc1
  v_mfma_f32_16x16x32_bf16 v[196:199], v[140:143], v[108:111], v[196:199]
  ds_read_b64_tr_b16 v[162:163], v6 offset:26912
  s_waitcnt lgkmcnt(6)
  v_mfma_f32_16x16x32_bf16 v[200:203], v[144:147], v[104:107], v[200:203]
  ds_read_b64_tr_b16 v[164:165], v6 offset:25664
  v_mfma_f32_16x16x32_bf16 v[204:207], v[144:147], v[108:111], v[204:207]
  ds_read_b64_tr_b16 v[166:167], v6 offset:26944
  buffer_load_dwordx4 v[100:103], v190, s[20:23], s68 offen offset:3072 sc1
  v_mfma_f32_16x16x32_bf16 v[208:211], v[148:151], v[104:107], v[208:211]
  ds_read_b64_tr_b16 v[168:169], v6 offset:25696
  v_mfma_f32_16x16x32_bf16 v[212:215], v[148:151], v[108:111], v[212:215]
  ds_read_b64_tr_b16 v[170:171], v6 offset:26976
  s_waitcnt lgkmcnt(8)
  v_mfma_f32_16x16x32_bf16 v[216:219], v[152:155], v[104:107], v[216:219]
  ds_read_b64_tr_b16 v[172:173], v6 offset:25728
  v_mfma_f32_16x16x32_bf16 v[220:223], v[152:155], v[108:111], v[220:223]
  ds_read_b64_tr_b16 v[174:175], v6 offset:27008
  s_barrier
  s_waitcnt lgkmcnt(6)
  s_waitcnt vmcnt(21)
  v_mfma_f32_16x16x32_bf16 v[176:179], v[156:159], v[112:115], v[176:179]
  ds_read_b64_tr_b16 v[136:137], v6 offset:40960
  s_waitcnt vmcnt(20)
  v_mfma_f32_16x16x32_bf16 v[180:183], v[156:159], v[116:119], v[180:183]
  ds_read_b64_tr_b16 v[138:139], v6 offset:42240
  s_add_u32 s67, s67, 0x1000
  v_mfma_f32_16x16x32_bf16 v[192:195], v[160:163], v[112:115], v[192:195]
  ds_read_b64_tr_b16 v[140:141], v6 offset:40992
  v_mfma_f32_16x16x32_bf16 v[196:199], v[160:163], v[116:119], v[196:199]
  ds_read_b64_tr_b16 v[142:143], v6 offset:42272
  buffer_load_dwordx4 v[104:107], v190, s[20:23], s67 offen offset:0 sc1
  s_waitcnt lgkmcnt(6)
  v_mfma_f32_16x16x32_bf16 v[200:203], v[164:167], v[112:115], v[200:203]
  ds_read_b64_tr_b16 v[144:145], v6 offset:41024
  v_mfma_f32_16x16x32_bf16 v[204:207], v[164:167], v[116:119], v[204:207]
  ds_read_b64_tr_b16 v[146:147], v6 offset:42304
  s_add_u32 s68, s68, 0x1000
  v_mfma_f32_16x16x32_bf16 v[208:211], v[168:171], v[112:115], v[208:211]
  ds_read_b64_tr_b16 v[148:149], v6 offset:41056
  v_mfma_f32_16x16x32_bf16 v[212:215], v[168:171], v[116:119], v[212:215]
  ds_read_b64_tr_b16 v[150:151], v6 offset:42336
  buffer_load_dwordx4 v[108:111], v190, s[20:23], s68 offen offset:0 sc1
  s_waitcnt lgkmcnt(8)
  v_mfma_f32_16x16x32_bf16 v[216:219], v[172:175], v[112:115], v[216:219]
  ds_read_b64_tr_b16 v[152:153], v6 offset:41088
  v_mfma_f32_16x16x32_bf16 v[220:223], v[172:175], v[116:119], v[220:223]
  ds_read_b64_tr_b16 v[154:155], v6 offset:42368
  s_waitcnt lgkmcnt(6)
  s_waitcnt vmcnt(21)
  v_mfma_f32_16x16x32_bf16 v[176:179], v[136:139], v[120:123], v[176:179]
  ds_read_b64_tr_b16 v[156:157], v6 offset:46080
  s_waitcnt vmcnt(20)
  v_mfma_f32_16x16x32_bf16 v[180:183], v[136:139], v[124:127], v[180:183]
  ds_read_b64_tr_b16 v[158:159], v6 offset:47360
  v_mfma_f32_16x16x32_bf16 v[192:195], v[140:143], v[120:123], v[192:195]
  ds_read_b64_tr_b16 v[160:161], v6 offset:46112
  buffer_load_dwordx4 v[112:115], v190, s[20:23], s67 offen offset:1024 sc1
  v_mfma_f32_16x16x32_bf16 v[196:199], v[140:143], v[124:127], v[196:199]
  ds_read_b64_tr_b16 v[162:163], v6 offset:47392
  s_waitcnt lgkmcnt(6)
  v_mfma_f32_16x16x32_bf16 v[200:203], v[144:147], v[120:123], v[200:203]
  ds_read_b64_tr_b16 v[164:165], v6 offset:46144
  v_mfma_f32_16x16x32_bf16 v[204:207], v[144:147], v[124:127], v[204:207]
  ds_read_b64_tr_b16 v[166:167], v6 offset:47424
  buffer_load_dwordx4 v[116:119], v190, s[20:23], s68 offen offset:1024 sc1
  v_mfma_f32_16x16x32_bf16 v[208:211], v[148:151], v[120:123], v[208:211]
  ds_read_b64_tr_b16 v[168:169], v6 offset:46176
  v_mfma_f32_16x16x32_bf16 v[212:215], v[148:151], v[124:127], v[212:215]
  ds_read_b64_tr_b16 v[170:171], v6 offset:47456
  s_waitcnt lgkmcnt(8)
  v_mfma_f32_16x16x32_bf16 v[216:219], v[152:155], v[120:123], v[216:219]
  ds_read_b64_tr_b16 v[172:173], v6 offset:46208
  v_mfma_f32_16x16x32_bf16 v[220:223], v[152:155], v[124:127], v[220:223]
  ds_read_b64_tr_b16 v[174:175], v6 offset:47488
  s_barrier
  s_waitcnt lgkmcnt(6)
  s_waitcnt vmcnt(21)
  v_mfma_f32_16x16x32_bf16 v[176:179], v[156:159], v[128:131], v[176:179]
  ds_read_b64_tr_b16 v[136:137], v7 offset:0
  s_waitcnt vmcnt(20)
  v_mfma_f32_16x16x32_bf16 v[180:183], v[156:159], v[132:135], v[180:183]
  ds_read_b64_tr_b16 v[138:139], v7 offset:1280
  v_mfma_f32_16x16x32_bf16 v[192:195], v[160:163], v[128:131], v[192:195]
  ds_read_b64_tr_b16 v[140:141], v7 offset:32
  buffer_load_dwordx4 v[120:123], v190, s[20:23], s67 offen offset:2048 sc1
  v_mfma_f32_16x16x32_bf16 v[196:199], v[160:163], v[132:135], v[196:199]
  ds_read_b64_tr_b16 v[142:143], v7 offset:1312
  s_waitcnt lgkmcnt(6)
  v_mfma_f32_16x16x32_bf16 v[200:203], v[164:167], v[128:131], v[200:203]
  ds_read_b64_tr_b16 v[144:145], v7 offset:64
  v_mfma_f32_16x16x32_bf16 v[204:207], v[164:167], v[132:135], v[204:207]
  ds_read_b64_tr_b16 v[146:147], v7 offset:1344
  buffer_load_dwordx4 v[124:127], v190, s[20:23], s68 offen offset:2048 sc1
  v_mfma_f32_16x16x32_bf16 v[208:211], v[168:171], v[128:131], v[208:211]
  ds_read_b64_tr_b16 v[148:149], v7 offset:96
  v_mfma_f32_16x16x32_bf16 v[212:215], v[168:171], v[132:135], v[212:215]
  ds_read_b64_tr_b16 v[150:151], v7 offset:1376
  s_waitcnt lgkmcnt(8)
  v_mfma_f32_16x16x32_bf16 v[216:219], v[172:175], v[128:131], v[216:219]
  ds_read_b64_tr_b16 v[152:153], v7 offset:128
  v_mfma_f32_16x16x32_bf16 v[220:223], v[172:175], v[132:135], v[220:223]
  ds_read_b64_tr_b16 v[154:155], v7 offset:1408
  s_waitcnt lgkmcnt(6)
  s_waitcnt vmcnt(21)
  v_mfma_f32_16x16x32_bf16 v[176:179], v[136:139], v[26:29], v[176:179]
  ds_read_b64_tr_b16 v[156:157], v7 offset:5120
  s_waitcnt vmcnt(20)
  v_mfma_f32_16x16x32_bf16 v[180:183], v[136:139], v[30:33], v[180:183]
  ds_read_b64_tr_b16 v[158:159], v7 offset:6400
  v_mfma_f32_16x16x32_bf16 v[192:195], v[140:143], v[26:29], v[192:195]
  ds_read_b64_tr_b16 v[160:161], v7 offset:5152
  buffer_load_dwordx4 v[128:131], v190, s[20:23], s67 offen offset:3072 sc1
  v_mfma_f32_16x16x32_bf16 v[196:199], v[140:143], v[30:33], v[196:199]
  ds_read_b64_tr_b16 v[162:163], v7 offset:6432
  s_waitcnt lgkmcnt(6)
  v_mfma_f32_16x16x32_bf16 v[200:203], v[144:147], v[26:29], v[200:203]
  ds_read_b64_tr_b16 v[164:165], v7 offset:5184
  v_mfma_f32_16x16x32_bf16 v[204:207], v[144:147], v[30:33], v[204:207]
  ds_read_b64_tr_b16 v[166:167], v7 offset:6464
  buffer_load_dwordx4 v[132:135], v190, s[20:23], s68 offen offset:3072 sc1
  v_mfma_f32_16x16x32_bf16 v[208:211], v[148:151], v[26:29], v[208:211]
  ds_read_b64_tr_b16 v[168:169], v7 offset:5216
  v_mfma_f32_16x16x32_bf16 v[212:215], v[148:151], v[30:33], v[212:215]
  ds_read_b64_tr_b16 v[170:171], v7 offset:6496
  s_waitcnt lgkmcnt(8)
  v_mfma_f32_16x16x32_bf16 v[216:219], v[152:155], v[26:29], v[216:219]
  ds_read_b64_tr_b16 v[172:173], v7 offset:5248
  v_mfma_f32_16x16x32_bf16 v[220:223], v[152:155], v[30:33], v[220:223]
  ds_read_b64_tr_b16 v[174:175], v7 offset:6528
  s_barrier
  s_waitcnt lgkmcnt(6)
  s_waitcnt vmcnt(21)
  v_mfma_f32_16x16x32_bf16 v[176:179], v[156:159], v[34:37], v[176:179]
  ds_read_b64_tr_b16 v[136:137], v22 offset:0
  s_waitcnt vmcnt(20)
  v_mfma_f32_16x16x32_bf16 v[180:183], v[156:159], v[52:55], v[180:183]
  ds_read_b64_tr_b16 v[138:139], v22 offset:1280
  s_add_u32 s67, s67, 0x1000
  v_mfma_f32_16x16x32_bf16 v[192:195], v[160:163], v[34:37], v[192:195]
  ds_read_b64_tr_b16 v[140:141], v22 offset:32
  v_mfma_f32_16x16x32_bf16 v[196:199], v[160:163], v[52:55], v[196:199]
  ds_read_b64_tr_b16 v[142:143], v22 offset:1312
  buffer_load_dwordx4 v[26:29], v190, s[20:23], s67 offen offset:0 sc1
  s_waitcnt lgkmcnt(6)
  v_mfma_f32_16x16x32_bf16 v[200:203], v[164:167], v[34:37], v[200:203]
  ds_read_b64_tr_b16 v[144:145], v22 offset:64
  v_mfma_f32_16x16x32_bf16 v[204:207], v[164:167], v[52:55], v[204:207]
  ds_read_b64_tr_b16 v[146:147], v22 offset:1344
  s_add_u32 s68, s68, 0x1000
  v_mfma_f32_16x16x32_bf16 v[208:211], v[168:171], v[34:37], v[208:211]
  ds_read_b64_tr_b16 v[148:149], v22 offset:96
  v_mfma_f32_16x16x32_bf16 v[212:215], v[168:171], v[52:55], v[212:215]
  ds_read_b64_tr_b16 v[150:151], v22 offset:1376
  buffer_load_dwordx4 v[30:33], v190, s[20:23], s68 offen offset:0 sc1
  s_waitcnt lgkmcnt(8)
  v_mfma_f32_16x16x32_bf16 v[216:219], v[172:175], v[34:37], v[216:219]
  ds_read_b64_tr_b16 v[152:153], v22 offset:128
  v_mfma_f32_16x16x32_bf16 v[220:223], v[172:175], v[52:55], v[220:223]
  ds_read_b64_tr_b16 v[154:155], v22 offset:1408
  s_waitcnt lgkmcnt(6)
  s_waitcnt vmcnt(21)
  v_mfma_f32_16x16x32_bf16 v[176:179], v[136:139], v[56:59], v[176:179]
  ds_read_b64_tr_b16 v[156:157], v22 offset:5120
  s_waitcnt vmcnt(20)
  v_mfma_f32_16x16x32_bf16 v[180:183], v[136:139], v[60:63], v[180:183]
  ds_read_b64_tr_b16 v[158:159], v22 offset:6400
  v_mfma_f32_16x16x32_bf16 v[192:195], v[140:143], v[56:59], v[192:195]
  ds_read_b64_tr_b16 v[160:161], v22 offset:5152
  buffer_load_dwordx4 v[34:37], v190, s[20:23], s67 offen offset:1024 sc1
  v_mfma_f32_16x16x32_bf16 v[196:199], v[140:143], v[60:63], v[196:199]
  ds_read_b64_tr_b16 v[162:163], v22 offset:6432
  s_waitcnt lgkmcnt(6)
  v_mfma_f32_16x16x32_bf16 v[200:203], v[144:147], v[56:59], v[200:203]
  ds_read_b64_tr_b16 v[164:165], v22 offset:5184
  v_mfma_f32_16x16x32_bf16 v[204:207], v[144:147], v[60:63], v[204:207]
  ds_read_b64_tr_b16 v[166:167], v22 offset:6464
  buffer_load_dwordx4 v[52:55], v190, s[20:23], s68 offen offset:1024 sc1
  v_mfma_f32_16x16x32_bf16 v[208:211], v[148:151], v[56:59], v[208:211]
  ds_read_b64_tr_b16 v[168:169], v22 offset:5216
  v_mfma_f32_16x16x32_bf16 v[212:215], v[148:151], v[60:63], v[212:215]
  ds_read_b64_tr_b16 v[170:171], v22 offset:6496
  s_waitcnt lgkmcnt(8)
  v_mfma_f32_16x16x32_bf16 v[216:219], v[152:155], v[56:59], v[216:219]
  ds_read_b64_tr_b16 v[172:173], v22 offset:5248
  v_mfma_f32_16x16x32_bf16 v[220:223], v[152:155], v[60:63], v[220:223]
  ds_read_b64_tr_b16 v[174:175], v22 offset:6528
  s_barrier
  s_waitcnt lgkmcnt(6)
  s_waitcnt vmcnt(21)
  v_mfma_f32_16x16x32_bf16 v[176:179], v[156:159], v[64:67], v[176:179]
  ds_read_b64_tr_b16 v[136:137], v22 offset:20480
  s_waitcnt vmcnt(20)
  v_mfma_f32_16x16x32_bf16 v[180:183], v[156:159], v[68:71], v[180:183]
  ds_read_b64_tr_b16 v[138:139], v22 offset:21760
  v_mfma_f32_16x16x32_bf16 v[192:195], v[160:163], v[64:67], v[192:195]
  ds_read_b64_tr_b16 v[140:141], v22 offset:20512
  buffer_load_dwordx4 v[56:59], v190, s[20:23], s67 offen offset:2048 sc1
  v_mfma_f32_16x16x32_bf16 v[196:199], v[160:163], v[68:71], v[196:199]
  ds_read_b64_tr_b16 v[142:143], v22 offset:21792
  s_waitcnt lgkmcnt(6)
  v_mfma_f32_16x16x32_bf16 v[200:203], v[164:167], v[64:67], v[200:203]
  ds_read_b64_tr_b16 v[144:145], v22 offset:20544
  v_mfma_f32_16x16x32_bf16 v[204:207], v[164:167], v[68:71], v[204:207]
  ds_read_b64_tr_b16 v[146:147], v22 offset:21824
  buffer_load_dwordx4 v[60:63], v190, s[20:23], s68 offen offset:2048 sc1
  v_mfma_f32_16x16x32_bf16 v[208:211], v[168:171], v[64:67], v[208:211]
  ds_read_b64_tr_b16 v[148:149], v22 offset:20576
  v_mfma_f32_16x16x32_bf16 v[212:215], v[168:171], v[68:71], v[212:215]
  ds_read_b64_tr_b16 v[150:151], v22 offset:21856
  s_waitcnt lgkmcnt(8)
  v_mfma_f32_16x16x32_bf16 v[216:219], v[172:175], v[64:67], v[216:219]
  ds_read_b64_tr_b16 v[152:153], v22 offset:20608
  v_mfma_f32_16x16x32_bf16 v[220:223], v[172:175], v[68:71], v[220:223]
  ds_read_b64_tr_b16 v[154:155], v22 offset:21888
  s_waitcnt lgkmcnt(6)
  s_waitcnt vmcnt(21)
  v_mfma_f32_16x16x32_bf16 v[176:179], v[136:139], v[72:75], v[176:179]
  ds_read_b64_tr_b16 v[156:157], v22 offset:25600
  s_waitcnt vmcnt(20)
  v_mfma_f32_16x16x32_bf16 v[180:183], v[136:139], v[76:79], v[180:183]
  ds_read_b64_tr_b16 v[158:159], v22 offset:26880
  v_mfma_f32_16x16x32_bf16 v[192:195], v[140:143], v[72:75], v[192:195]
  ds_read_b64_tr_b16 v[160:161], v22 offset:25632
  buffer_load_dwordx4 v[64:67], v190, s[20:23], s11 offen offset:0 sc1
  v_mfma_f32_16x16x32_bf16 v[196:199], v[140:143], v[76:79], v[196:199]
  ds_read_b64_tr_b16 v[162:163], v22 offset:26912
  s_waitcnt lgkmcnt(6)
  v_mfma_f32_16x16x32_bf16 v[200:203], v[144:147], v[72:75], v[200:203]
  ds_read_b64_tr_b16 v[164:165], v22 offset:25664
  v_mfma_f32_16x16x32_bf16 v[204:207], v[144:147], v[76:79], v[204:207]
  ds_read_b64_tr_b16 v[166:167], v22 offset:26944
  buffer_load_dwordx4 v[68:71], v190, s[20:23], s66 offen offset:0 sc1
  v_mfma_f32_16x16x32_bf16 v[208:211], v[148:151], v[72:75], v[208:211]
  ds_read_b64_tr_b16 v[168:169], v22 offset:25696
  v_mfma_f32_16x16x32_bf16 v[212:215], v[148:151], v[76:79], v[212:215]
  ds_read_b64_tr_b16 v[170:171], v22 offset:26976
  s_waitcnt lgkmcnt(8)
  v_mfma_f32_16x16x32_bf16 v[216:219], v[152:155], v[72:75], v[216:219]
  ds_read_b64_tr_b16 v[172:173], v22 offset:25728
  v_mfma_f32_16x16x32_bf16 v[220:223], v[152:155], v[76:79], v[220:223]
  ds_read_b64_tr_b16 v[174:175], v22 offset:27008
  s_barrier
  s_waitcnt lgkmcnt(6)
  s_waitcnt vmcnt(21)
  v_mfma_f32_16x16x32_bf16 v[176:179], v[156:159], v[80:83], v[176:179]
  ds_read_b64_tr_b16 v[136:137], v22 offset:40960
  s_waitcnt vmcnt(20)
  v_mfma_f32_16x16x32_bf16 v[180:183], v[156:159], v[84:87], v[180:183]
  ds_read_b64_tr_b16 v[138:139], v22 offset:42240
  v_mfma_f32_16x16x32_bf16 v[192:195], v[160:163], v[80:83], v[192:195]
  ds_read_b64_tr_b16 v[140:141], v22 offset:40992
  buffer_load_dwordx4 v[72:75], v190, s[20:23], s11 offen offset:1024 sc1
  v_mfma_f32_16x16x32_bf16 v[196:199], v[160:163], v[84:87], v[196:199]
  ds_read_b64_tr_b16 v[142:143], v22 offset:42272
  s_waitcnt lgkmcnt(6)
  v_mfma_f32_16x16x32_bf16 v[200:203], v[164:167], v[80:83], v[200:203]
  ds_read_b64_tr_b16 v[144:145], v22 offset:41024
  v_mfma_f32_16x16x32_bf16 v[204:207], v[164:167], v[84:87], v[204:207]
  ds_read_b64_tr_b16 v[146:147], v22 offset:42304
  buffer_load_dwordx4 v[76:79], v190, s[20:23], s66 offen offset:1024 sc1
  v_mfma_f32_16x16x32_bf16 v[208:211], v[168:171], v[80:83], v[208:211]
  ds_read_b64_tr_b16 v[148:149], v22 offset:41056
  v_mfma_f32_16x16x32_bf16 v[212:215], v[168:171], v[84:87], v[212:215]
  ds_read_b64_tr_b16 v[150:151], v22 offset:42336
  s_waitcnt lgkmcnt(8)
  v_mfma_f32_16x16x32_bf16 v[216:219], v[172:175], v[80:83], v[216:219]
  ds_read_b64_tr_b16 v[152:153], v22 offset:41088
  v_mfma_f32_16x16x32_bf16 v[220:223], v[172:175], v[84:87], v[220:223]
  ds_read_b64_tr_b16 v[154:155], v22 offset:42368
  s_waitcnt lgkmcnt(6)
  s_waitcnt vmcnt(21)
  v_mfma_f32_16x16x32_bf16 v[176:179], v[136:139], v[88:91], v[176:179]
  ds_read_b64_tr_b16 v[156:157], v22 offset:46080
  s_waitcnt vmcnt(20)
  v_mfma_f32_16x16x32_bf16 v[180:183], v[136:139], v[92:95], v[180:183]
  ds_read_b64_tr_b16 v[158:159], v22 offset:47360
  v_mfma_f32_16x16x32_bf16 v[192:195], v[140:143], v[88:91], v[192:195]
  ds_read_b64_tr_b16 v[160:161], v22 offset:46112
  buffer_load_dwordx4 v[80:83], v190, s[20:23], s11 offen offset:2048 sc1
  v_mfma_f32_16x16x32_bf16 v[196:199], v[140:143], v[92:95], v[196:199]
  ds_read_b64_tr_b16 v[162:163], v22 offset:47392
  s_waitcnt lgkmcnt(6)
  v_mfma_f32_16x16x32_bf16 v[200:203], v[144:147], v[88:91], v[200:203]
  ds_read_b64_tr_b16 v[164:165], v22 offset:46144
  v_mfma_f32_16x16x32_bf16 v[204:207], v[144:147], v[92:95], v[204:207]
  ds_read_b64_tr_b16 v[166:167], v22 offset:47424
  buffer_load_dwordx4 v[84:87], v190, s[20:23], s66 offen offset:2048 sc1
  v_mfma_f32_16x16x32_bf16 v[208:211], v[148:151], v[88:91], v[208:211]
  ds_read_b64_tr_b16 v[168:169], v22 offset:46176
  v_mfma_f32_16x16x32_bf16 v[212:215], v[148:151], v[92:95], v[212:215]
  ds_read_b64_tr_b16 v[170:171], v22 offset:47456
  s_waitcnt lgkmcnt(8)
  v_mfma_f32_16x16x32_bf16 v[216:219], v[152:155], v[88:91], v[216:219]
  ds_read_b64_tr_b16 v[172:173], v22 offset:46208
  v_mfma_f32_16x16x32_bf16 v[220:223], v[152:155], v[92:95], v[220:223]
  ds_read_b64_tr_b16 v[174:175], v22 offset:47488
  s_barrier
  s_waitcnt lgkmcnt(6)
  s_waitcnt vmcnt(21)
  v_mfma_f32_16x16x32_bf16 v[176:179], v[156:159], v[96:99], v[176:179]
  ds_read_b64_tr_b16 v[136:137], v6 offset:0
  s_waitcnt vmcnt(20)
  v_mfma_f32_16x16x32_bf16 v[180:183], v[156:159], v[100:103], v[180:183]
  ds_read_b64_tr_b16 v[138:139], v6 offset:1280
  v_mfma_f32_16x16x32_bf16 v[192:195], v[160:163], v[96:99], v[192:195]
  ds_read_b64_tr_b16 v[140:141], v6 offset:32
  buffer_load_dwordx4 v[88:91], v190, s[20:23], s11 offen offset:3072 sc1
  v_mfma_f32_16x16x32_bf16 v[196:199], v[160:163], v[100:103], v[196:199]
  ds_read_b64_tr_b16 v[142:143], v6 offset:1312
  s_waitcnt lgkmcnt(6)
  v_mfma_f32_16x16x32_bf16 v[200:203], v[164:167], v[96:99], v[200:203]
  ds_read_b64_tr_b16 v[144:145], v6 offset:64
  v_mfma_f32_16x16x32_bf16 v[204:207], v[164:167], v[100:103], v[204:207]
  ds_read_b64_tr_b16 v[146:147], v6 offset:1344
  buffer_load_dwordx4 v[92:95], v190, s[20:23], s66 offen offset:3072 sc1
  v_mfma_f32_16x16x32_bf16 v[208:211], v[168:171], v[96:99], v[208:211]
  ds_read_b64_tr_b16 v[148:149], v6 offset:96
  v_mfma_f32_16x16x32_bf16 v[212:215], v[168:171], v[100:103], v[212:215]
  ds_read_b64_tr_b16 v[150:151], v6 offset:1376
  s_waitcnt lgkmcnt(8)
  v_mfma_f32_16x16x32_bf16 v[216:219], v[172:175], v[96:99], v[216:219]
  ds_read_b64_tr_b16 v[152:153], v6 offset:128
  v_mfma_f32_16x16x32_bf16 v[220:223], v[172:175], v[100:103], v[220:223]
  ds_read_b64_tr_b16 v[154:155], v6 offset:1408
  s_waitcnt lgkmcnt(6)
  s_waitcnt vmcnt(21)
  v_mfma_f32_16x16x32_bf16 v[176:179], v[136:139], v[104:107], v[176:179]
  ds_read_b64_tr_b16 v[156:157], v6 offset:5120
  s_waitcnt vmcnt(20)
  v_mfma_f32_16x16x32_bf16 v[180:183], v[136:139], v[108:111], v[180:183]
  ds_read_b64_tr_b16 v[158:159], v6 offset:6400
  s_add_u32 s11, s11, 0x1000
  v_mfma_f32_16x16x32_bf16 v[192:195], v[140:143], v[104:107], v[192:195]
  ds_read_b64_tr_b16 v[160:161], v6 offset:5152
  v_mfma_f32_16x16x32_bf16 v[196:199], v[140:143], v[108:111], v[196:199]
  ds_read_b64_tr_b16 v[162:163], v6 offset:6432
  buffer_load_dwordx4 v[96:99], v190, s[20:23], s11 offen offset:0 sc1
  s_waitcnt lgkmcnt(6)
  v_mfma_f32_16x16x32_bf16 v[200:203], v[144:147], v[104:107], v[200:203]
  ds_read_b64_tr_b16 v[164:165], v6 offset:5184
  v_mfma_f32_16x16x32_bf16 v[204:207], v[144:147], v[108:111], v[204:207]
  ds_read_b64_tr_b16 v[166:167], v6 offset:6464
  s_add_u32 s66, s66, 0x1000
  v_mfma_f32_16x16x32_bf16 v[208:211], v[148:151], v[104:107], v[208:211]
  ds_read_b64_tr_b16 v[168:169], v6 offset:5216
  v_mfma_f32_16x16x32_bf16 v[212:215], v[148:151], v[108:111], v[212:215]
  ds_read_b64_tr_b16 v[170:171], v6 offset:6496
  buffer_load_dwordx4 v[100:103], v190, s[20:23], s66 offen offset:0 sc1
  s_waitcnt lgkmcnt(8)
  v_mfma_f32_16x16x32_bf16 v[216:219], v[152:155], v[104:107], v[216:219]
  ds_read_b64_tr_b16 v[172:173], v6 offset:5248
  v_mfma_f32_16x16x32_bf16 v[220:223], v[152:155], v[108:111], v[220:223]
  ds_read_b64_tr_b16 v[174:175], v6 offset:6528
  s_barrier
  s_waitcnt lgkmcnt(6)
  s_waitcnt vmcnt(21)
  v_mfma_f32_16x16x32_bf16 v[176:179], v[156:159], v[112:115], v[176:179]
  ds_read_b64_tr_b16 v[136:137], v6 offset:20480
  s_waitcnt vmcnt(20)
  v_mfma_f32_16x16x32_bf16 v[180:183], v[156:159], v[116:119], v[180:183]
  ds_read_b64_tr_b16 v[138:139], v6 offset:21760
  v_mfma_f32_16x16x32_bf16 v[192:195], v[160:163], v[112:115], v[192:195]
  ds_read_b64_tr_b16 v[140:141], v6 offset:20512
  buffer_load_dwordx4 v[104:107], v190, s[20:23], s11 offen offset:1024 sc1
  v_mfma_f32_16x16x32_bf16 v[196:199], v[160:163], v[116:119], v[196:199]
  ds_read_b64_tr_b16 v[142:143], v6 offset:21792
  s_waitcnt lgkmcnt(6)
  v_mfma_f32_16x16x32_bf16 v[200:203], v[164:167], v[112:115], v[200:203]
  ds_read_b64_tr_b16 v[144:145], v6 offset:20544
  v_mfma_f32_16x16x32_bf16 v[204:207], v[164:167], v[116:119], v[204:207]
  ds_read_b64_tr_b16 v[146:147], v6 offset:21824
  buffer_load_dwordx4 v[108:111], v190, s[20:23], s66 offen offset:1024 sc1
  v_mfma_f32_16x16x32_bf16 v[208:211], v[168:171], v[112:115], v[208:211]
  ds_read_b64_tr_b16 v[148:149], v6 offset:20576
  v_mfma_f32_16x16x32_bf16 v[212:215], v[168:171], v[116:119], v[212:215]
  ds_read_b64_tr_b16 v[150:151], v6 offset:21856
  s_waitcnt lgkmcnt(8)
  v_mfma_f32_16x16x32_bf16 v[216:219], v[172:175], v[112:115], v[216:219]
  ds_read_b64_tr_b16 v[152:153], v6 offset:20608
  v_mfma_f32_16x16x32_bf16 v[220:223], v[172:175], v[116:119], v[220:223]
  ds_read_b64_tr_b16 v[154:155], v6 offset:21888
  s_waitcnt lgkmcnt(6)
  s_waitcnt vmcnt(21)
  v_mfma_f32_16x16x32_bf16 v[176:179], v[136:139], v[120:123], v[176:179]
  ds_read_b64_tr_b16 v[156:157], v6 offset:25600
  s_waitcnt vmcnt(20)
  v_mfma_f32_16x16x32_bf16 v[180:183], v[136:139], v[124:127], v[180:183]
  ds_read_b64_tr_b16 v[158:159], v6 offset:26880
  v_mfma_f32_16x16x32_bf16 v[192:195], v[140:143], v[120:123], v[192:195]
  ds_read_b64_tr_b16 v[160:161], v6 offset:25632
  buffer_load_dwordx4 v[112:115], v190, s[20:23], s11 offen offset:2048 sc1
  v_mfma_f32_16x16x32_bf16 v[196:199], v[140:143], v[124:127], v[196:199]
  ds_read_b64_tr_b16 v[162:163], v6 offset:26912
  s_waitcnt lgkmcnt(6)
  v_mfma_f32_16x16x32_bf16 v[200:203], v[144:147], v[120:123], v[200:203]
  ds_read_b64_tr_b16 v[164:165], v6 offset:25664
  v_mfma_f32_16x16x32_bf16 v[204:207], v[144:147], v[124:127], v[204:207]
  ds_read_b64_tr_b16 v[166:167], v6 offset:26944
  buffer_load_dwordx4 v[116:119], v190, s[20:23], s66 offen offset:2048 sc1
  v_mfma_f32_16x16x32_bf16 v[208:211], v[148:151], v[120:123], v[208:211]
  ds_read_b64_tr_b16 v[168:169], v6 offset:25696
  v_mfma_f32_16x16x32_bf16 v[212:215], v[148:151], v[124:127], v[212:215]
  ds_read_b64_tr_b16 v[170:171], v6 offset:26976
  s_waitcnt lgkmcnt(8)
  v_mfma_f32_16x16x32_bf16 v[216:219], v[152:155], v[120:123], v[216:219]
  ds_read_b64_tr_b16 v[172:173], v6 offset:25728
  v_mfma_f32_16x16x32_bf16 v[220:223], v[152:155], v[124:127], v[220:223]
  ds_read_b64_tr_b16 v[174:175], v6 offset:27008
  s_barrier
  s_waitcnt lgkmcnt(6)
  s_waitcnt vmcnt(21)
  v_mfma_f32_16x16x32_bf16 v[176:179], v[156:159], v[128:131], v[176:179]
  ds_read_b64_tr_b16 v[136:137], v6 offset:40960
  s_waitcnt vmcnt(20)
  v_mfma_f32_16x16x32_bf16 v[180:183], v[156:159], v[132:135], v[180:183]
  ds_read_b64_tr_b16 v[138:139], v6 offset:42240
  v_mfma_f32_16x16x32_bf16 v[192:195], v[160:163], v[128:131], v[192:195]
  ds_read_b64_tr_b16 v[140:141], v6 offset:40992
  buffer_load_dwordx4 v[120:123], v190, s[20:23], s11 offen offset:3072 sc1
  v_mfma_f32_16x16x32_bf16 v[196:199], v[160:163], v[132:135], v[196:199]
  ds_read_b64_tr_b16 v[142:143], v6 offset:42272
  s_waitcnt lgkmcnt(6)
  v_mfma_f32_16x16x32_bf16 v[200:203], v[164:167], v[128:131], v[200:203]
  ds_read_b64_tr_b16 v[144:145], v6 offset:41024
  v_mfma_f32_16x16x32_bf16 v[204:207], v[164:167], v[132:135], v[204:207]
  ds_read_b64_tr_b16 v[146:147], v6 offset:42304
  buffer_load_dwordx4 v[124:127], v190, s[20:23], s66 offen offset:3072 sc1
  v_mfma_f32_16x16x32_bf16 v[208:211], v[168:171], v[128:131], v[208:211]
  ds_read_b64_tr_b16 v[148:149], v6 offset:41056
  v_mfma_f32_16x16x32_bf16 v[212:215], v[168:171], v[132:135], v[212:215]
  ds_read_b64_tr_b16 v[150:151], v6 offset:42336
  s_waitcnt lgkmcnt(8)
  v_mfma_f32_16x16x32_bf16 v[216:219], v[172:175], v[128:131], v[216:219]
  ds_read_b64_tr_b16 v[152:153], v6 offset:41088
  v_mfma_f32_16x16x32_bf16 v[220:223], v[172:175], v[132:135], v[220:223]
  ds_read_b64_tr_b16 v[154:155], v6 offset:42368
  s_waitcnt lgkmcnt(6)
  s_waitcnt vmcnt(21)
  v_mfma_f32_16x16x32_bf16 v[176:179], v[136:139], v[26:29], v[176:179]
  ds_read_b64_tr_b16 v[156:157], v6 offset:46080
  s_waitcnt vmcnt(20)
  v_mfma_f32_16x16x32_bf16 v[180:183], v[136:139], v[30:33], v[180:183]
  ds_read_b64_tr_b16 v[158:159], v6 offset:47360
  s_add_u32 s11, s11, 0x1000
  v_mfma_f32_16x16x32_bf16 v[192:195], v[140:143], v[26:29], v[192:195]
  ds_read_b64_tr_b16 v[160:161], v6 offset:46112
  v_mfma_f32_16x16x32_bf16 v[196:199], v[140:143], v[30:33], v[196:199]
  ds_read_b64_tr_b16 v[162:163], v6 offset:47392
  buffer_load_dwordx4 v[128:131], v190, s[20:23], s11 offen offset:0 sc1
  s_waitcnt lgkmcnt(6)
  v_mfma_f32_16x16x32_bf16 v[200:203], v[144:147], v[26:29], v[200:203]
  ds_read_b64_tr_b16 v[164:165], v6 offset:46144
  v_mfma_f32_16x16x32_bf16 v[204:207], v[144:147], v[30:33], v[204:207]
  ds_read_b64_tr_b16 v[166:167], v6 offset:47424
  s_add_u32 s66, s66, 0x1000
  v_mfma_f32_16x16x32_bf16 v[208:211], v[148:151], v[26:29], v[208:211]
  ds_read_b64_tr_b16 v[168:169], v6 offset:46176
  v_mfma_f32_16x16x32_bf16 v[212:215], v[148:151], v[30:33], v[212:215]
  ds_read_b64_tr_b16 v[170:171], v6 offset:47456
  buffer_load_dwordx4 v[132:135], v190, s[20:23], s66 offen offset:0 sc1
  s_waitcnt lgkmcnt(8)
  v_mfma_f32_16x16x32_bf16 v[216:219], v[152:155], v[26:29], v[216:219]
  ds_read_b64_tr_b16 v[172:173], v6 offset:46208
  v_mfma_f32_16x16x32_bf16 v[220:223], v[152:155], v[30:33], v[220:223]
  ds_read_b64_tr_b16 v[174:175], v6 offset:47488
  s_barrier
  s_waitcnt lgkmcnt(6)
  s_waitcnt vmcnt(21)
  v_mfma_f32_16x16x32_bf16 v[176:179], v[156:159], v[34:37], v[176:179]
  ds_read_b64_tr_b16 v[136:137], v7 offset:0
  s_waitcnt vmcnt(20)
  v_mfma_f32_16x16x32_bf16 v[180:183], v[156:159], v[52:55], v[180:183]
  ds_read_b64_tr_b16 v[138:139], v7 offset:1280
  v_mfma_f32_16x16x32_bf16 v[192:195], v[160:163], v[34:37], v[192:195]
  ds_read_b64_tr_b16 v[140:141], v7 offset:32
  buffer_load_dwordx4 v[26:29], v190, s[20:23], s11 offen offset:1024 sc1
  v_mfma_f32_16x16x32_bf16 v[196:199], v[160:163], v[52:55], v[196:199]
  ds_read_b64_tr_b16 v[142:143], v7 offset:1312
  s_waitcnt lgkmcnt(6)
  v_mfma_f32_16x16x32_bf16 v[200:203], v[164:167], v[34:37], v[200:203]
  ds_read_b64_tr_b16 v[144:145], v7 offset:64
  v_mfma_f32_16x16x32_bf16 v[204:207], v[164:167], v[52:55], v[204:207]
  ds_read_b64_tr_b16 v[146:147], v7 offset:1344
  buffer_load_dwordx4 v[30:33], v190, s[20:23], s66 offen offset:1024 sc1
  v_mfma_f32_16x16x32_bf16 v[208:211], v[168:171], v[34:37], v[208:211]
  ds_read_b64_tr_b16 v[148:149], v7 offset:96
  v_mfma_f32_16x16x32_bf16 v[212:215], v[168:171], v[52:55], v[212:215]
  ds_read_b64_tr_b16 v[150:151], v7 offset:1376
  s_waitcnt lgkmcnt(8)
  v_mfma_f32_16x16x32_bf16 v[216:219], v[172:175], v[34:37], v[216:219]
  ds_read_b64_tr_b16 v[152:153], v7 offset:128
  v_mfma_f32_16x16x32_bf16 v[220:223], v[172:175], v[52:55], v[220:223]
  ds_read_b64_tr_b16 v[154:155], v7 offset:1408
  s_waitcnt lgkmcnt(6)
  s_waitcnt vmcnt(21)
  v_mfma_f32_16x16x32_bf16 v[176:179], v[136:139], v[56:59], v[176:179]
  ds_read_b64_tr_b16 v[156:157], v7 offset:5120
  s_waitcnt vmcnt(20)
  v_mfma_f32_16x16x32_bf16 v[180:183], v[136:139], v[60:63], v[180:183]
  ds_read_b64_tr_b16 v[158:159], v7 offset:6400
  v_mfma_f32_16x16x32_bf16 v[192:195], v[140:143], v[56:59], v[192:195]
  ds_read_b64_tr_b16 v[160:161], v7 offset:5152
  v_mfma_f32_16x16x32_bf16 v[196:199], v[140:143], v[60:63], v[196:199]
  ds_read_b64_tr_b16 v[162:163], v7 offset:6432
  s_waitcnt lgkmcnt(6)
  v_mfma_f32_16x16x32_bf16 v[200:203], v[144:147], v[56:59], v[200:203]
  ds_read_b64_tr_b16 v[164:165], v7 offset:5184
  v_mfma_f32_16x16x32_bf16 v[204:207], v[144:147], v[60:63], v[204:207]
  ds_read_b64_tr_b16 v[166:167], v7 offset:6464
  v_mfma_f32_16x16x32_bf16 v[208:211], v[148:151], v[56:59], v[208:211]
  ds_read_b64_tr_b16 v[168:169], v7 offset:5216
  v_mfma_f32_16x16x32_bf16 v[212:215], v[148:151], v[60:63], v[212:215]
  ds_read_b64_tr_b16 v[170:171], v7 offset:6496
  s_waitcnt lgkmcnt(8)
  v_mfma_f32_16x16x32_bf16 v[216:219], v[152:155], v[56:59], v[216:219]
  ds_read_b64_tr_b16 v[172:173], v7 offset:5248
  v_mfma_f32_16x16x32_bf16 v[220:223], v[152:155], v[60:63], v[220:223]
  ds_read_b64_tr_b16 v[174:175], v7 offset:6528
  s_barrier
  s_waitcnt lgkmcnt(6)
  s_waitcnt vmcnt(19)
  v_mfma_f32_16x16x32_bf16 v[176:179], v[156:159], v[64:67], v[176:179]
  ds_read_b64_tr_b16 v[136:137], v22 offset:0
  s_waitcnt vmcnt(18)
  v_mfma_f32_16x16x32_bf16 v[180:183], v[156:159], v[68:71], v[180:183]
  ds_read_b64_tr_b16 v[138:139], v22 offset:1280
  v_mfma_f32_16x16x32_bf16 v[192:195], v[160:163], v[64:67], v[192:195]
  ds_read_b64_tr_b16 v[140:141], v22 offset:32
  v_mfma_f32_16x16x32_bf16 v[196:199], v[160:163], v[68:71], v[196:199]
  ds_read_b64_tr_b16 v[142:143], v22 offset:1312
  s_waitcnt lgkmcnt(6)
  v_mfma_f32_16x16x32_bf16 v[200:203], v[164:167], v[64:67], v[200:203]
  ds_read_b64_tr_b16 v[144:145], v22 offset:64
  v_mfma_f32_16x16x32_bf16 v[204:207], v[164:167], v[68:71], v[204:207]
  ds_read_b64_tr_b16 v[146:147], v22 offset:1344
  v_mfma_f32_16x16x32_bf16 v[208:211], v[168:171], v[64:67], v[208:211]
  ds_read_b64_tr_b16 v[148:149], v22 offset:96
  v_mfma_f32_16x16x32_bf16 v[212:215], v[168:171], v[68:71], v[212:215]
  ds_read_b64_tr_b16 v[150:151], v22 offset:1376
  s_waitcnt lgkmcnt(8)
  v_mfma_f32_16x16x32_bf16 v[216:219], v[172:175], v[64:67], v[216:219]
  ds_read_b64_tr_b16 v[152:153], v22 offset:128
  v_mfma_f32_16x16x32_bf16 v[220:223], v[172:175], v[68:71], v[220:223]
  ds_read_b64_tr_b16 v[154:155], v22 offset:1408
  s_waitcnt lgkmcnt(6)
  s_waitcnt vmcnt(17)
  v_mfma_f32_16x16x32_bf16 v[176:179], v[136:139], v[72:75], v[176:179]
  ds_read_b64_tr_b16 v[156:157], v22 offset:5120
  s_waitcnt vmcnt(16)
  v_mfma_f32_16x16x32_bf16 v[180:183], v[136:139], v[76:79], v[180:183]
  ds_read_b64_tr_b16 v[158:159], v22 offset:6400
  v_mfma_f32_16x16x32_bf16 v[192:195], v[140:143], v[72:75], v[192:195]
  ds_read_b64_tr_b16 v[160:161], v22 offset:5152
  v_mfma_f32_16x16x32_bf16 v[196:199], v[140:143], v[76:79], v[196:199]
  ds_read_b64_tr_b16 v[162:163], v22 offset:6432
  s_waitcnt lgkmcnt(6)
  v_mfma_f32_16x16x32_bf16 v[200:203], v[144:147], v[72:75], v[200:203]
  ds_read_b64_tr_b16 v[164:165], v22 offset:5184
  v_mfma_f32_16x16x32_bf16 v[204:207], v[144:147], v[76:79], v[204:207]
  ds_read_b64_tr_b16 v[166:167], v22 offset:6464
  v_mfma_f32_16x16x32_bf16 v[208:211], v[148:151], v[72:75], v[208:211]
  ds_read_b64_tr_b16 v[168:169], v22 offset:5216
  v_mfma_f32_16x16x32_bf16 v[212:215], v[148:151], v[76:79], v[212:215]
  ds_read_b64_tr_b16 v[170:171], v22 offset:6496
  s_waitcnt lgkmcnt(8)
  v_mfma_f32_16x16x32_bf16 v[216:219], v[152:155], v[72:75], v[216:219]
  ds_read_b64_tr_b16 v[172:173], v22 offset:5248
  v_mfma_f32_16x16x32_bf16 v[220:223], v[152:155], v[76:79], v[220:223]
  ds_read_b64_tr_b16 v[174:175], v22 offset:6528
  s_barrier
  s_waitcnt lgkmcnt(6)
  s_waitcnt vmcnt(15)
  v_mfma_f32_16x16x32_bf16 v[176:179], v[156:159], v[80:83], v[176:179]
  ds_read_b64_tr_b16 v[136:137], v22 offset:20480
  s_waitcnt vmcnt(14)
  v_mfma_f32_16x16x32_bf16 v[180:183], v[156:159], v[84:87], v[180:183]
  ds_read_b64_tr_b16 v[138:139], v22 offset:21760
  v_mfma_f32_16x16x32_bf16 v[192:195], v[160:163], v[80:83], v[192:195]
  ds_read_b64_tr_b16 v[140:141], v22 offset:20512
  v_mfma_f32_16x16x32_bf16 v[196:199], v[160:163], v[84:87], v[196:199]
  ds_read_b64_tr_b16 v[142:143], v22 offset:21792
  s_waitcnt lgkmcnt(6)
  v_mfma_f32_16x16x32_bf16 v[200:203], v[164:167], v[80:83], v[200:203]
  ds_read_b64_tr_b16 v[144:145], v22 offset:20544
  v_mfma_f32_16x16x32_bf16 v[204:207], v[164:167], v[84:87], v[204:207]
  ds_read_b64_tr_b16 v[146:147], v22 offset:21824
  v_mfma_f32_16x16x32_bf16 v[208:211], v[168:171], v[80:83], v[208:211]
  ds_read_b64_tr_b16 v[148:149], v22 offset:20576
  v_mfma_f32_16x16x32_bf16 v[212:215], v[168:171], v[84:87], v[212:215]
  ds_read_b64_tr_b16 v[150:151], v22 offset:21856
  s_waitcnt lgkmcnt(8)
  v_mfma_f32_16x16x32_bf16 v[216:219], v[172:175], v[80:83], v[216:219]
  ds_read_b64_tr_b16 v[152:153], v22 offset:20608
  v_mfma_f32_16x16x32_bf16 v[220:223], v[172:175], v[84:87], v[220:223]
  ds_read_b64_tr_b16 v[154:155], v22 offset:21888
  s_waitcnt lgkmcnt(6)
  s_waitcnt vmcnt(13)
  v_mfma_f32_16x16x32_bf16 v[176:179], v[136:139], v[88:91], v[176:179]
  ds_read_b64_tr_b16 v[156:157], v22 offset:25600
  s_waitcnt vmcnt(12)
  v_mfma_f32_16x16x32_bf16 v[180:183], v[136:139], v[92:95], v[180:183]
  ds_read_b64_tr_b16 v[158:159], v22 offset:26880
  v_mfma_f32_16x16x32_bf16 v[192:195], v[140:143], v[88:91], v[192:195]
  ds_read_b64_tr_b16 v[160:161], v22 offset:25632
  v_mfma_f32_16x16x32_bf16 v[196:199], v[140:143], v[92:95], v[196:199]
  ds_read_b64_tr_b16 v[162:163], v22 offset:26912
  s_waitcnt lgkmcnt(6)
  v_mfma_f32_16x16x32_bf16 v[200:203], v[144:147], v[88:91], v[200:203]
  ds_read_b64_tr_b16 v[164:165], v22 offset:25664
  v_mfma_f32_16x16x32_bf16 v[204:207], v[144:147], v[92:95], v[204:207]
  ds_read_b64_tr_b16 v[166:167], v22 offset:26944
  v_mfma_f32_16x16x32_bf16 v[208:211], v[148:151], v[88:91], v[208:211]
  ds_read_b64_tr_b16 v[168:169], v22 offset:25696
  v_mfma_f32_16x16x32_bf16 v[212:215], v[148:151], v[92:95], v[212:215]
  ds_read_b64_tr_b16 v[170:171], v22 offset:26976
  s_waitcnt lgkmcnt(8)
  v_mfma_f32_16x16x32_bf16 v[216:219], v[152:155], v[88:91], v[216:219]
  ds_read_b64_tr_b16 v[172:173], v22 offset:25728
  v_mfma_f32_16x16x32_bf16 v[220:223], v[152:155], v[92:95], v[220:223]
  ds_read_b64_tr_b16 v[174:175], v22 offset:27008
  s_barrier
  s_waitcnt lgkmcnt(6)
  s_waitcnt vmcnt(11)
  v_mfma_f32_16x16x32_bf16 v[176:179], v[156:159], v[96:99], v[176:179]
  ds_read_b64_tr_b16 v[136:137], v22 offset:40960
  s_waitcnt vmcnt(10)
  v_mfma_f32_16x16x32_bf16 v[180:183], v[156:159], v[100:103], v[180:183]
  ds_read_b64_tr_b16 v[138:139], v22 offset:42240
  v_mfma_f32_16x16x32_bf16 v[192:195], v[160:163], v[96:99], v[192:195]
  ds_read_b64_tr_b16 v[140:141], v22 offset:40992
  v_mfma_f32_16x16x32_bf16 v[196:199], v[160:163], v[100:103], v[196:199]
  ds_read_b64_tr_b16 v[142:143], v22 offset:42272
  s_waitcnt lgkmcnt(6)
  v_mfma_f32_16x16x32_bf16 v[200:203], v[164:167], v[96:99], v[200:203]
  ds_read_b64_tr_b16 v[144:145], v22 offset:41024
  v_mfma_f32_16x16x32_bf16 v[204:207], v[164:167], v[100:103], v[204:207]
  ds_read_b64_tr_b16 v[146:147], v22 offset:42304
  v_mfma_f32_16x16x32_bf16 v[208:211], v[168:171], v[96:99], v[208:211]
  ds_read_b64_tr_b16 v[148:149], v22 offset:41056
  v_mfma_f32_16x16x32_bf16 v[212:215], v[168:171], v[100:103], v[212:215]
  ds_read_b64_tr_b16 v[150:151], v22 offset:42336
  s_waitcnt lgkmcnt(8)
  v_mfma_f32_16x16x32_bf16 v[216:219], v[172:175], v[96:99], v[216:219]
  ds_read_b64_tr_b16 v[152:153], v22 offset:41088
  v_mfma_f32_16x16x32_bf16 v[220:223], v[172:175], v[100:103], v[220:223]
  ds_read_b64_tr_b16 v[154:155], v22 offset:42368
  s_waitcnt lgkmcnt(6)
  s_waitcnt vmcnt(9)
  v_mfma_f32_16x16x32_bf16 v[176:179], v[136:139], v[104:107], v[176:179]
  ds_read_b64_tr_b16 v[156:157], v22 offset:46080
  s_waitcnt vmcnt(8)
  v_mfma_f32_16x16x32_bf16 v[180:183], v[136:139], v[108:111], v[180:183]
  ds_read_b64_tr_b16 v[158:159], v22 offset:47360
  v_mfma_f32_16x16x32_bf16 v[192:195], v[140:143], v[104:107], v[192:195]
  ds_read_b64_tr_b16 v[160:161], v22 offset:46112
  v_mfma_f32_16x16x32_bf16 v[196:199], v[140:143], v[108:111], v[196:199]
  ds_read_b64_tr_b16 v[162:163], v22 offset:47392
  s_waitcnt lgkmcnt(6)
  v_mfma_f32_16x16x32_bf16 v[200:203], v[144:147], v[104:107], v[200:203]
  ds_read_b64_tr_b16 v[164:165], v22 offset:46144
  v_mfma_f32_16x16x32_bf16 v[204:207], v[144:147], v[108:111], v[204:207]
  ds_read_b64_tr_b16 v[166:167], v22 offset:47424
  v_mfma_f32_16x16x32_bf16 v[208:211], v[148:151], v[104:107], v[208:211]
  ds_read_b64_tr_b16 v[168:169], v22 offset:46176
  v_mfma_f32_16x16x32_bf16 v[212:215], v[148:151], v[108:111], v[212:215]
  ds_read_b64_tr_b16 v[170:171], v22 offset:47456
  s_waitcnt lgkmcnt(8)
  v_mfma_f32_16x16x32_bf16 v[216:219], v[152:155], v[104:107], v[216:219]
  ds_read_b64_tr_b16 v[172:173], v22 offset:46208
  v_mfma_f32_16x16x32_bf16 v[220:223], v[152:155], v[108:111], v[220:223]
  ds_read_b64_tr_b16 v[174:175], v22 offset:47488
  s_barrier
  s_waitcnt lgkmcnt(6)
  s_waitcnt vmcnt(7)
  v_mfma_f32_16x16x32_bf16 v[176:179], v[156:159], v[112:115], v[176:179]
  ds_read_b64_tr_b16 v[136:137], v6 offset:0
  s_waitcnt vmcnt(6)
  v_mfma_f32_16x16x32_bf16 v[180:183], v[156:159], v[116:119], v[180:183]
  ds_read_b64_tr_b16 v[138:139], v6 offset:1280
  v_mfma_f32_16x16x32_bf16 v[192:195], v[160:163], v[112:115], v[192:195]
  ds_read_b64_tr_b16 v[140:141], v6 offset:32
  v_mfma_f32_16x16x32_bf16 v[196:199], v[160:163], v[116:119], v[196:199]
  ds_read_b64_tr_b16 v[142:143], v6 offset:1312
  s_waitcnt lgkmcnt(6)
  v_mfma_f32_16x16x32_bf16 v[200:203], v[164:167], v[112:115], v[200:203]
  ds_read_b64_tr_b16 v[144:145], v6 offset:64
  v_mfma_f32_16x16x32_bf16 v[204:207], v[164:167], v[116:119], v[204:207]
  ds_read_b64_tr_b16 v[146:147], v6 offset:1344
  v_mfma_f32_16x16x32_bf16 v[208:211], v[168:171], v[112:115], v[208:211]
  ds_read_b64_tr_b16 v[148:149], v6 offset:96
  v_mfma_f32_16x16x32_bf16 v[212:215], v[168:171], v[116:119], v[212:215]
  ds_read_b64_tr_b16 v[150:151], v6 offset:1376
  s_waitcnt lgkmcnt(8)
  v_mfma_f32_16x16x32_bf16 v[216:219], v[172:175], v[112:115], v[216:219]
  ds_read_b64_tr_b16 v[152:153], v6 offset:128
  v_mfma_f32_16x16x32_bf16 v[220:223], v[172:175], v[116:119], v[220:223]
  ds_read_b64_tr_b16 v[154:155], v6 offset:1408
  s_waitcnt lgkmcnt(6)
  s_waitcnt vmcnt(5)
  v_mfma_f32_16x16x32_bf16 v[176:179], v[136:139], v[120:123], v[176:179]
  ds_read_b64_tr_b16 v[156:157], v6 offset:5120
  s_waitcnt vmcnt(4)
  v_mfma_f32_16x16x32_bf16 v[180:183], v[136:139], v[124:127], v[180:183]
  ds_read_b64_tr_b16 v[158:159], v6 offset:6400
  v_mfma_f32_16x16x32_bf16 v[192:195], v[140:143], v[120:123], v[192:195]
  ds_read_b64_tr_b16 v[160:161], v6 offset:5152
  v_mfma_f32_16x16x32_bf16 v[196:199], v[140:143], v[124:127], v[196:199]
  ds_read_b64_tr_b16 v[162:163], v6 offset:6432
  s_waitcnt lgkmcnt(6)
  v_mfma_f32_16x16x32_bf16 v[200:203], v[144:147], v[120:123], v[200:203]
  ds_read_b64_tr_b16 v[164:165], v6 offset:5184
  v_mfma_f32_16x16x32_bf16 v[204:207], v[144:147], v[124:127], v[204:207]
  ds_read_b64_tr_b16 v[166:167], v6 offset:6464
  v_mfma_f32_16x16x32_bf16 v[208:211], v[148:151], v[120:123], v[208:211]
  ds_read_b64_tr_b16 v[168:169], v6 offset:5216
  v_mfma_f32_16x16x32_bf16 v[212:215], v[148:151], v[124:127], v[212:215]
  ds_read_b64_tr_b16 v[170:171], v6 offset:6496
  s_waitcnt lgkmcnt(8)
  v_mfma_f32_16x16x32_bf16 v[216:219], v[152:155], v[120:123], v[216:219]
  ds_read_b64_tr_b16 v[172:173], v6 offset:5248
  v_mfma_f32_16x16x32_bf16 v[220:223], v[152:155], v[124:127], v[220:223]
  ds_read_b64_tr_b16 v[174:175], v6 offset:6528
  s_barrier
  s_waitcnt lgkmcnt(6)
  s_waitcnt vmcnt(3)
  v_mfma_f32_16x16x32_bf16 v[176:179], v[156:159], v[128:131], v[176:179]
  ds_read_b64_tr_b16 v[136:137], v6 offset:20480
  s_waitcnt vmcnt(2)
  v_mfma_f32_16x16x32_bf16 v[180:183], v[156:159], v[132:135], v[180:183]
  ds_read_b64_tr_b16 v[138:139], v6 offset:21760
  v_mfma_f32_16x16x32_bf16 v[192:195], v[160:163], v[128:131], v[192:195]
  ds_read_b64_tr_b16 v[140:141], v6 offset:20512
  v_mfma_f32_16x16x32_bf16 v[196:199], v[160:163], v[132:135], v[196:199]
  ds_read_b64_tr_b16 v[142:143], v6 offset:21792
  s_waitcnt lgkmcnt(6)
  v_mfma_f32_16x16x32_bf16 v[200:203], v[164:167], v[128:131], v[200:203]
  ds_read_b64_tr_b16 v[144:145], v6 offset:20544
  v_mfma_f32_16x16x32_bf16 v[204:207], v[164:167], v[132:135], v[204:207]
  ds_read_b64_tr_b16 v[146:147], v6 offset:21824
  v_mfma_f32_16x16x32_bf16 v[208:211], v[168:171], v[128:131], v[208:211]
  ds_read_b64_tr_b16 v[148:149], v6 offset:20576
  v_mfma_f32_16x16x32_bf16 v[212:215], v[168:171], v[132:135], v[212:215]
  ds_read_b64_tr_b16 v[150:151], v6 offset:21856
  s_waitcnt lgkmcnt(8)
  v_mfma_f32_16x16x32_bf16 v[216:219], v[172:175], v[128:131], v[216:219]
  ds_read_b64_tr_b16 v[152:153], v6 offset:20608
  v_mfma_f32_16x16x32_bf16 v[220:223], v[172:175], v[132:135], v[220:223]
  ds_read_b64_tr_b16 v[154:155], v6 offset:21888
  s_waitcnt lgkmcnt(6)
  s_waitcnt vmcnt(1)
  v_mfma_f32_16x16x32_bf16 v[176:179], v[136:139], v[26:29], v[176:179]
  s_waitcnt vmcnt(0)
  v_mfma_f32_16x16x32_bf16 v[180:183], v[136:139], v[30:33], v[180:183]
  v_mfma_f32_16x16x32_bf16 v[192:195], v[140:143], v[26:29], v[192:195]
  v_mfma_f32_16x16x32_bf16 v[196:199], v[140:143], v[30:33], v[196:199]
  s_waitcnt lgkmcnt(2)
  v_mfma_f32_16x16x32_bf16 v[200:203], v[144:147], v[26:29], v[200:203]
  v_mfma_f32_16x16x32_bf16 v[204:207], v[144:147], v[30:33], v[204:207]
  v_mfma_f32_16x16x32_bf16 v[208:211], v[148:151], v[26:29], v[208:211]
  v_mfma_f32_16x16x32_bf16 v[212:215], v[148:151], v[30:33], v[212:215]
  s_waitcnt lgkmcnt(0)
  v_mfma_f32_16x16x32_bf16 v[216:219], v[152:155], v[26:29], v[216:219]
  v_mfma_f32_16x16x32_bf16 v[220:223], v[152:155], v[30:33], v[220:223]
  s_mul_i32 s69, s6, 0x1400
  s_add_u32 s69, s69, 0
  v_lshl_add_u32 v8, v1, 4, s69
  s_xor_b32 s69, s6, 2
  s_mul_i32 s69, s69, 0x1400
  s_add_u32 s69, s69, 0
  v_lshl_add_u32 v9, v1, 4, s69
  ds_write_b128 v8, v[180:183] offset:0
  ds_write_b128 v8, v[196:199] offset:1024
  ds_write_b128 v8, v[204:207] offset:2048
  ds_write_b128 v8, v[212:215] offset:3072
  ds_write_b128 v8, v[220:223] offset:4096
  s_waitcnt lgkmcnt(0)
  s_barrier
  ds_read_b128 v[180:183], v9 offset:0
  ds_read_b128 v[196:199], v9 offset:1024
  ds_read_b128 v[204:207], v9 offset:2048
  ds_read_b128 v[212:215], v9 offset:3072
  ds_read_b128 v[220:223], v9 offset:4096
  s_waitcnt lgkmcnt(4)
  v_pk_add_f32 v[176:177], v[176:177], v[180:181]
  v_pk_add_f32 v[178:179], v[178:179], v[182:183]
  s_waitcnt lgkmcnt(3)
  v_pk_add_f32 v[192:193], v[192:193], v[196:197]
  v_pk_add_f32 v[194:195], v[194:195], v[198:199]
  s_waitcnt lgkmcnt(2)
  v_pk_add_f32 v[200:201], v[200:201], v[204:205]
  v_pk_add_f32 v[202:203], v[202:203], v[206:207]
  s_waitcnt lgkmcnt(1)
  v_pk_add_f32 v[208:209], v[208:209], v[212:213]
  v_pk_add_f32 v[210:211], v[210:211], v[214:215]
  s_waitcnt lgkmcnt(0)
  v_pk_add_f32 v[216:217], v[216:217], v[220:221]
  v_pk_add_f32 v[218:219], v[218:219], v[222:223]
  v_pk_add_f32 v[176:177], v[176:177], v[14:15]
  v_cvt_pk_bf16_f32 v8, v176, v177
  v_pk_add_f32 v[178:179], v[178:179], v[16:17]
  v_cvt_pk_bf16_f32 v9, v178, v179
  ds_write_b64 v24, v[8:9] offset:0
  v_pk_add_f32 v[192:193], v[192:193], v[18:19]
  v_cvt_pk_bf16_f32 v26, v192, v193
  v_pk_add_f32 v[194:195], v[194:195], v[20:21]
  v_cvt_pk_bf16_f32 v27, v194, v195
  ds_write_b64 v24, v[26:27] offset:32
  v_pk_add_f32 v[200:201], v[200:201], v[40:41]
  v_cvt_pk_bf16_f32 v28, v200, v201
  v_pk_add_f32 v[202:203], v[202:203], v[42:43]
  v_cvt_pk_bf16_f32 v29, v202, v203
  ds_write_b64 v24, v[28:29] offset:64
  v_pk_add_f32 v[208:209], v[208:209], v[44:45]
  v_cvt_pk_bf16_f32 v30, v208, v209
  v_pk_add_f32 v[210:211], v[210:211], v[46:47]
  v_cvt_pk_bf16_f32 v31, v210, v211
  ds_write_b64 v24, v[30:31] offset:96
  v_pk_add_f32 v[216:217], v[216:217], v[48:49]
  v_cvt_pk_bf16_f32 v32, v216, v217
  v_pk_add_f32 v[218:219], v[218:219], v[50:51]
  v_cvt_pk_bf16_f32 v33, v218, v219
  ds_write_b64 v24, v[32:33] offset:128
  v_lshl_add_u32 v11, v1, 4, s8
  ds_read_b128 v[34:37], v11 offset:0
  ds_read_b128 v[52:55], v11 offset:1024
  ds_read_b128 v[56:59], v11 offset:2048
  s_waitcnt lgkmcnt(2)
  buffer_store_dwordx4 v[34:37], v12, s[40:43], 0 offen
  s_waitcnt lgkmcnt(1)
  buffer_store_dwordx4 v[52:55], v13, s[40:43], 0 offen
  s_waitcnt lgkmcnt(0)
  buffer_store_dwordx4 v[56:59], v184, s[40:43], 0 offen
  s_waitcnt vmcnt(0) lgkmcnt(0)
L_exit:
  s_endpgm
L_code_end:

.section .rodata,"a"
.p2align 6
.amdhsa_kernel parallel_sum__linear_kernel_hedgehog__mixer_s_mlp__prompt_kernel
  .amdhsa_next_free_vgpr 256
  .amdhsa_next_free_sgpr 102
  .amdhsa_accum_offset 256
  .amdhsa_group_segment_fixed_size 0
  .amdhsa_kernarg_size 96
  .amdhsa_user_sgpr_count 2
  .amdhsa_user_sgpr_kernarg_segment_ptr 1
  .amdhsa_system_sgpr_workgroup_id_x 1
.end_amdhsa_kernel
```
